```python
import torch

def _softmax(x, axis=-1):
    return torch.softmax(x, dim=axis)

def _gelu(x):
    return torch.nn.functional.gelu(x, approximate='tanh')

def _silu(x):
    return torch.nn.functional.silu(x)

def _sigmoid(x):
    return torch.sigmoid(x)

def _layernorm(x, axis=-1, eps=1e-05):
    m = x.mean(dim=axis, keepdim=True)
    v = x.var(dim=axis, keepdim=True, unbiased=False)
    return (x - m) / torch.sqrt(v + eps)

def _scatter_add(tgt, idx, src, axis=0):
    return tgt.clone().index_add_(axis, idx, src)

def _segment_sum(src, seg, n):
    out = torch.zeros((n,) + src.shape[1:], dtype=src.dtype)
    return out.index_add_(0, seg, src)

def _pad(x, pw):
    flat = tuple((v for pair in reversed(pw) for v in pair))
    return torch.nn.functional.pad(x, flat)
kernel_name = 'standalone__conformer_family_branchformer__speech'

def setup_inputs():

    _w = lambda a: (lambda t: t.to(torch.bfloat16) if t.is_floating_point() else t)(torch.as_tensor(a))
    B, T, D, K = (2, 4000, 256, 5)
    s = float(D) ** (-0.5)
    return {'x': _w((lambda *s: torch.randn(*s, dtype=torch.bfloat16) * 0.05)(B, T, D)), 'w_q': _w((lambda *s: torch.randn(*s, dtype=torch.bfloat16) * 1.6)(D, D) * s), 'w_k': _w((lambda *s: torch.randn(*s, dtype=torch.bfloat16) * 1.6)(D, D) * s), 'w_v': _w((lambda *s: torch.randn(*s, dtype=torch.bfloat16) * 0.4)(D, D) * s), 'w_ao': _w((lambda *s: torch.randn(*s, dtype=torch.bfloat16) * 0.4)(D, D) * s), 'w_up': _w((lambda *s: torch.randn(*s, dtype=torch.bfloat16) * 0.8)(D, 2 * D) * s), 'dw': _w((lambda *s: torch.randn(*s, dtype=torch.bfloat16) * 0.8)(K, D) * (1.0 / K)), 'w_dn': _w((lambda *s: torch.randn(*s, dtype=torch.bfloat16) * 0.4)(D, D) * s), 'w_merge': _w((lambda *s: torch.randn(*s, dtype=torch.bfloat16) * 0.4)(2 * D, D) * s)}

def reference(x, w_q, w_k, w_v, w_ao, w_up, dw, w_dn, w_merge):
    B, T, D = x.shape
    K = dw.shape[0]
    xa = _layernorm(x, axis=-1)
    q = torch.einsum('btd,de->bte', xa, w_q)
    k = torch.einsum('btd,de->bte', xa, w_k)
    v = torch.einsum('btd,de->bte', xa, w_v)
    logits = torch.einsum('btd,bsd->bts', q, k) * float(D) ** (-0.5)
    attn = _softmax(logits, axis=-1)
    ya = torch.einsum('bts,bsd->btd', attn, v)
    ya = torch.einsum('btd,de->bte', ya, w_ao)
    xc = _layernorm(x, axis=-1)
    h = _gelu(torch.einsum('btd,de->bte', xc, w_up))
    u = h[..., :D].clone()
    g = _layernorm(h[..., D:], axis=-1)
    pad = K // 2
    gp = _pad(g, ((0, 0), (pad, pad), (0, 0)))
    conv = torch.zeros_like(g)
    for i in range(K):
        conv = conv + gp[:, i:i + T, :] * dw[i][None, None, :]
    yc = torch.einsum('btd,de->bte', u * conv, w_dn)
    merged = torch.concatenate([ya, yc], axis=-1)
    out = torch.einsum('btf,fd->btd', merged, w_merge)
    return x + out
```

```asm
; @launch kernel=k1_kernel grid=(254,1,1) block=(512,1,1) lds=163840
; @launch kernel=k2_kernel grid=(256,1,1) block=(256,1,1) lds=163840
.amdgcn_target "amdgcn-amd-amdhsa--gfx950"
.text
.p2align 8
.type k1_kernel,@function
k1_kernel:
    s_lshr_b32 s26, s2, 4
    s_lshl_b32 s26, s26, 3
    s_and_b32 s25, s2, 7
    s_add_u32 s26, s26, s25
    s_cmp_ge_u32 s26, 126
    s_cbranch_scc1 K1_END
    s_bfe_u32 s25, s2, 0x10003
    s_load_dwordx2 s[4:5], s[0:1], 0
    s_load_dwordx4 s[40:43], s[0:1], 8
    s_load_dwordx2 s[44:45], s[0:1], 40
    s_load_dwordx2 s[6:7], s[0:1], 88
    v_lshrrev_b32 v20, 6, v0
    s_nop 0
    v_readfirstlane_b32 s24, v20
    v_and_b32 v0, 63, v0
    v_lshlrev_b32 v19, 4, v0
    s_lshr_b32 s30, s2, 3
    s_lshl_b32 s31, s30, 3
    s_add_u32 s31, s31, s24
    s_cmp_eq_u32 s24, 7
    s_cselect_b32 s31, s30, 15
    s_cmp_lt_u32 s31, 3
    s_cbranch_scc0 K1_NOEPF
    s_lshl_b32 s30, s30, 13
    v_lshlrev_b32 v30, 7, v0
    s_getpc_b64 s[48:49]
K1_PC0:
    s_sub_u32 s48, s48, K1_PC0-k1_kernel
    s_subb_u32 s49, s49, 0
    s_mov_b32 s50, K1_END-k1_kernel
    s_mov_b32 s51, 0x00020000
    buffer_load_dword v29, v30, s[48:51], s30 offen
K1_NOEPF:
    s_cmp_ge_u32 s26, 63
    s_cselect_b32 s27, 1, 0
    s_mul_i32 s30, s27, 63
    s_sub_u32 s28, s26, s30
    s_cmp_eq_u32 s28, 62
    s_cselect_b32 s36, 1, 0
    s_mul_i32 s30, s27, 4000
    s_lshl_b32 s31, s28, 6
    s_add_u32 s30, s30, s31
    s_lshl_b32 s31, s24, 3
    s_add_u32 s30, s30, s31
    s_lshl_b32 s30, s30, 9
    s_lshl_b32 s35, s24, 12
    s_add_u32 m0, s35, 131072
    s_lshr_b32 s29, s2, 4
    s_lshl_b32 s29, s29, 3
    s_add_u32 s29, s29, s24
    s_waitcnt lgkmcnt(0)
    s_mov_b32 s8, s4
    s_mov_b32 s9, s5
    s_mov_b32 s10, 0x3e8000
    s_mov_b32 s11, 0x00020000
    buffer_load_dwordx4 v19, s[8:11], s30 offen nt lds
    buffer_load_dwordx4 v19, s[8:11], s30 offen offset:1024 nt lds
    buffer_load_dwordx4 v19, s[8:11], s30 offen offset:2048 nt lds
    buffer_load_dwordx4 v19, s[8:11], s30 offen offset:3072 nt lds
    s_mov_b32 s20, s6
    s_mov_b32 s21, s7
    s_mov_b32 s22, 0x4000000
    s_mov_b32 s23, 0x00020000
    s_cmp_eq_u32 s25, 0
    s_cbranch_scc0 K1_C
    s_mov_b32 s12, s40
    s_mov_b32 s13, s41
    s_mov_b32 s14, 0x20000
    s_mov_b32 s15, 0x00020000
    s_mov_b32 s16, s42
    s_mov_b32 s17, s43
    s_mov_b32 s18, 0x20000
    s_mov_b32 s19, 0x00020000
    s_lshl_b32 s29, s29, 10
    buffer_load_dwordx4 v[64:67], v19, s[12:15], s29 offen
    buffer_load_dwordx4 v[68:71], v19, s[16:19], s29 offen
    v_lshrrev_b32 v20, 5, v0
    v_bfe_u32 v21, v0, 1, 4
    v_and_b32 v22, 1, v0
    v_lshlrev_b32 v22, 4, v22
    v_lshl_add_u32 v22, v20, 9, v22
    v_add_u32 v23, 0, v20
    v_xor_b32 v23, v23, v21
    v_lshl_add_u32 v1, v23, 5, v22
    v_add_u32 v23, 2, v20
    v_xor_b32 v23, v23, v21
    v_lshl_add_u32 v2, v23, 5, v22
    v_add_u32 v23, 4, v20
    v_xor_b32 v23, v23, v21
    v_lshl_add_u32 v3, v23, 5, v22
    v_add_u32 v23, 6, v20
    v_xor_b32 v23, v23, v21
    v_lshl_add_u32 v4, v23, 5, v22
    s_lshl_b32 s34, s24, 12
    v_lshrrev_b32 v20, 4, v0
    v_bfe_u32 v21, v0, 2, 2
    v_and_b32 v22, 3, v0
    v_lshl_add_u32 v9, v20, 2, v21
    v_and_b32 v10, 7, v9
    s_lshl_b32 s30, s24, 1
    v_xor_b32 v10, s30, v10
    v_lshlrev_b32 v10, 5, v10
    v_lshl_add_u32 v9, v9, 9, v10
    v_lshl_add_u32 v9, v22, 3, v9
    v_add_u32 v9, 32768, v9
    v_xor_b32 v10, 32, v9
    v_add_u32 v11, 65536, v9
    v_add_u32 v12, 65536, v10
    v_and_b32 v21, 15, v0
    v_and_b32 v17, 1, v20
    v_mul_u32_u24 v17, 12, v17
    v_xor_b32 v17, v17, v21
    v_lshlrev_b32 v17, 4, v17
    v_lshl_add_u32 v17, v20, 9, v17
    v_lshrrev_b32 v20, 4, v0
    v_and_b32 v21, 7, v0
    v_lshrrev_b32 v22, 3, v0
    v_lshlrev_b32 v22, 9, v22
    v_add_u32 v23, 0, v20
    v_xor_b32 v23, v23, v21
    v_and_b32 v23, 7, v23
    v_lshl_add_u32 v5, v23, 4, v22
    v_add_u32 v23, 4, v20
    v_xor_b32 v23, v23, v21
    v_and_b32 v23, 7, v23
    v_lshl_add_u32 v6, v23, 4, v22
    v_add_u32 v6, 3072, v6
    v_add_u32 v23, 0, v20
    v_xor_b32 v23, v23, v21
    v_and_b32 v23, 7, v23
    v_lshl_add_u32 v7, v23, 4, v22
    v_add_u32 v7, 6144, v7
    v_add_u32 v23, 4, v20
    v_xor_b32 v23, v23, v21
    v_and_b32 v23, 7, v23
    v_lshl_add_u32 v8, v23, 4, v22
    v_add_u32 v8, 9216, v8
    s_lshl_b32 s37, s24, 14
    v_and_b32 v14, 15, v0
    v_lshrrev_b32 v13, 1, v14
    v_xor_b32 v13, v13, v20
    v_lshlrev_b32 v13, 4, v13
    v_lshl_add_u32 v13, v14, 7, v13
    s_lshl_b32 s30, s24, 12
    s_add_u32 s30, s30, 32768
    v_add_u32 v13, s30, v13
    v_xor_b32 v14, 64, v13
    v_add_u32 v15, 65536, v13
    v_add_u32 v16, 65536, v14
    v_and_b32 v18, 15, v0
    v_lshrrev_b32 v22, 1, v20
    v_mul_u32_u24 v23, 12, v22
    v_xor_b32 v18, v18, v23
    v_lshlrev_b32 v18, 4, v18
    v_lshl_add_u32 v18, v22, 9, v18
    v_and_b32 v23, 1, v20
    v_lshl_add_u32 v18, v23, 3, v18
    s_lshl_b32 s30, s24, 11
    v_add_u32 v18, s30, v18
    v_and_b32 v20, 7, v0
    v_lshrrev_b32 v21, 3, v0
    v_lshrrev_b32 v22, 1, v21
    v_and_b32 v23, 1, v21
    v_lshlrev_b32 v24, 9, v20
    v_lshl_add_u32 v24, v22, 6, v24
    v_lshl_add_u32 v24, v23, 4, v24
    v_add_u32 v24, s35, v24
    v_add_u32 v24, 0x20000, v24
    s_lshl_b32 s30, s24, 3
    s_and_b32 s30, s30, 31
    v_add_u32 v25, s30, v20
    v_lshlrev_b32 v26, 10, v21
    s_lshr_b32 s31, s24, 2
    s_lshl_b32 s31, s31, 14
    v_add_u32 v26, s31, v26
    v_xor_b32 v27, 12, v25
    v_lshl_add_u32 v27, v27, 4, v26
    v_add_u32 v27, 512, v27
    v_lshl_add_u32 v26, v25, 4, v26
    s_waitcnt vmcnt(2)
    ds_read_b128 v[32:35], v24
    ds_read_b128 v[36:39], v24 offset:32
    ds_read_b128 v[40:43], v24 offset:256
    ds_read_b128 v[44:47], v24 offset:288
    s_waitcnt lgkmcnt(3)
    v_lshlrev_b32 v96, 16, v32
    v_and_b32 v97, 0xffff0000, v32
    v_lshlrev_b32 v98, 16, v33
    v_and_b32 v99, 0xffff0000, v33
    v_lshlrev_b32 v100, 16, v34
    v_and_b32 v101, 0xffff0000, v34
    v_lshlrev_b32 v102, 16, v35
    v_and_b32 v103, 0xffff0000, v35
    s_waitcnt lgkmcnt(2)
    v_lshlrev_b32 v104, 16, v36
    v_and_b32 v105, 0xffff0000, v36
    v_lshlrev_b32 v106, 16, v37
    v_and_b32 v107, 0xffff0000, v37
    v_lshlrev_b32 v108, 16, v38
    v_and_b32 v109, 0xffff0000, v38
    v_lshlrev_b32 v110, 16, v39
    v_and_b32 v111, 0xffff0000, v39
    s_waitcnt lgkmcnt(1)
    v_lshlrev_b32 v112, 16, v40
    v_and_b32 v113, 0xffff0000, v40
    v_lshlrev_b32 v114, 16, v41
    v_and_b32 v115, 0xffff0000, v41
    v_lshlrev_b32 v116, 16, v42
    s_add_u32 m0, s35, 32768
    s_add_u32 s33, s34, 0
    buffer_load_dwordx4 v1, s[12:15], s33 offen lds
    v_and_b32 v117, 0xffff0000, v42
    v_lshlrev_b32 v118, 16, v43
    v_and_b32 v119, 0xffff0000, v43
    s_waitcnt lgkmcnt(0)
    v_lshlrev_b32 v120, 16, v44
    v_and_b32 v121, 0xffff0000, v44
    v_lshlrev_b32 v122, 16, v45
    v_and_b32 v123, 0xffff0000, v45
    v_lshlrev_b32 v124, 16, v46
    v_and_b32 v125, 0xffff0000, v46
    v_lshlrev_b32 v126, 16, v47
    v_and_b32 v127, 0xffff0000, v47
    v_pk_add_f32 v[48:49], v[96:97], v[98:99]
    buffer_load_dwordx4 v2, s[12:15], s33 offen offset:1024 lds
    v_pk_add_f32 v[50:51], v[100:101], v[102:103]
    v_pk_add_f32 v[48:49], v[48:49], v[104:105]
    v_pk_add_f32 v[50:51], v[50:51], v[106:107]
    v_pk_add_f32 v[48:49], v[48:49], v[108:109]
    v_pk_add_f32 v[50:51], v[50:51], v[110:111]
    v_pk_add_f32 v[48:49], v[48:49], v[112:113]
    v_pk_add_f32 v[50:51], v[50:51], v[114:115]
    v_pk_add_f32 v[48:49], v[48:49], v[116:117]
    v_pk_add_f32 v[50:51], v[50:51], v[118:119]
    v_pk_add_f32 v[48:49], v[48:49], v[120:121]
    v_pk_add_f32 v[50:51], v[50:51], v[122:123]
    v_pk_add_f32 v[48:49], v[48:49], v[124:125]
    buffer_load_dwordx4 v3, s[12:15], s33 offen offset:2048 lds
    v_pk_add_f32 v[50:51], v[50:51], v[126:127]
    v_pk_add_f32 v[48:49], v[48:49], v[50:51]
    v_add_f32 v48, v48, v49
    s_nop 1
    v_add_f32_dpp v48, v48, v48 row_ror:8 row_mask:0xf bank_mask:0xf
    v_mov_b32 v52, v48
    s_nop 1
    v_permlane16_swap_b32 v52, v48
    v_add_f32 v48, v48, v52
    v_mov_b32 v52, v48
    s_nop 1
    v_permlane32_swap_b32 v52, v48
    v_add_f32 v48, v48, v52
    v_mul_f32 v48, 0xbb800000, v48
    v_pk_add_f32 v[96:97], v[96:97], v[48:49] op_sel_hi:[1,0]
    buffer_load_dwordx4 v4, s[12:15], s33 offen offset:3072 lds
    v_pk_add_f32 v[98:99], v[98:99], v[48:49] op_sel_hi:[1,0]
    v_pk_add_f32 v[100:101], v[100:101], v[48:49] op_sel_hi:[1,0]
    v_pk_add_f32 v[102:103], v[102:103], v[48:49] op_sel_hi:[1,0]
    v_pk_add_f32 v[104:105], v[104:105], v[48:49] op_sel_hi:[1,0]
    v_pk_add_f32 v[106:107], v[106:107], v[48:49] op_sel_hi:[1,0]
    v_pk_add_f32 v[108:109], v[108:109], v[48:49] op_sel_hi:[1,0]
    v_pk_add_f32 v[110:111], v[110:111], v[48:49] op_sel_hi:[1,0]
    v_pk_add_f32 v[112:113], v[112:113], v[48:49] op_sel_hi:[1,0]
    v_pk_add_f32 v[114:115], v[114:115], v[48:49] op_sel_hi:[1,0]
    v_pk_add_f32 v[116:117], v[116:117], v[48:49] op_sel_hi:[1,0]
    v_pk_add_f32 v[118:119], v[118:119], v[48:49] op_sel_hi:[1,0]
    v_pk_add_f32 v[120:121], v[120:121], v[48:49] op_sel_hi:[1,0]
    s_add_u32 m0, s35, 65536
    s_add_u32 s33, s34, 32768
    buffer_load_dwordx4 v1, s[12:15], s33 offen lds
    v_pk_add_f32 v[122:123], v[122:123], v[48:49] op_sel_hi:[1,0]
    v_pk_add_f32 v[124:125], v[124:125], v[48:49] op_sel_hi:[1,0]
    v_pk_add_f32 v[126:127], v[126:127], v[48:49] op_sel_hi:[1,0]
    v_pk_mul_f32 v[54:55], v[96:97], v[96:97]
    v_pk_mul_f32 v[56:57], v[98:99], v[98:99]
    v_pk_fma_f32 v[54:55], v[100:101], v[100:101], v[54:55]
    v_pk_fma_f32 v[56:57], v[102:103], v[102:103], v[56:57]
    v_pk_fma_f32 v[54:55], v[104:105], v[104:105], v[54:55]
    v_pk_fma_f32 v[56:57], v[106:107], v[106:107], v[56:57]
    v_pk_fma_f32 v[54:55], v[108:109], v[108:109], v[54:55]
    v_pk_fma_f32 v[56:57], v[110:111], v[110:111], v[56:57]
    v_pk_fma_f32 v[54:55], v[112:113], v[112:113], v[54:55]
    buffer_load_dwordx4 v2, s[12:15], s33 offen offset:1024 lds
    v_pk_fma_f32 v[56:57], v[114:115], v[114:115], v[56:57]
    v_pk_fma_f32 v[54:55], v[116:117], v[116:117], v[54:55]
    v_pk_fma_f32 v[56:57], v[118:119], v[118:119], v[56:57]
    v_pk_fma_f32 v[54:55], v[120:121], v[120:121], v[54:55]
    v_pk_fma_f32 v[56:57], v[122:123], v[122:123], v[56:57]
    v_pk_fma_f32 v[54:55], v[124:125], v[124:125], v[54:55]
    v_pk_fma_f32 v[56:57], v[126:127], v[126:127], v[56:57]
    v_pk_add_f32 v[54:55], v[54:55], v[56:57]
    v_add_f32 v54, v54, v55
    s_nop 1
    v_add_f32_dpp v54, v54, v54 row_ror:8 row_mask:0xf bank_mask:0xf
    v_mov_b32 v52, v54
    s_nop 1
    v_permlane16_swap_b32 v52, v54
    buffer_load_dwordx4 v3, s[12:15], s33 offen offset:2048 lds
    v_add_f32 v54, v54, v52
    v_mov_b32 v52, v54
    s_nop 1
    v_permlane32_swap_b32 v52, v54
    v_add_f32 v54, v54, v52
    v_mov_b32 v58, 0x3727c5ac
    v_fmac_f32 v58, 0x3b800000, v54
    v_rsq_f32 v58, v58
    s_nop 0
    v_pk_mul_f32 v[96:97], v[96:97], v[58:59] op_sel_hi:[1,0]
    v_pk_mul_f32 v[98:99], v[98:99], v[58:59] op_sel_hi:[1,0]
    v_pk_mul_f32 v[100:101], v[100:101], v[58:59] op_sel_hi:[1,0]
    v_pk_mul_f32 v[102:103], v[102:103], v[58:59] op_sel_hi:[1,0]
    v_pk_mul_f32 v[104:105], v[104:105], v[58:59] op_sel_hi:[1,0]
    buffer_load_dwordx4 v4, s[12:15], s33 offen offset:3072 lds
    v_pk_mul_f32 v[106:107], v[106:107], v[58:59] op_sel_hi:[1,0]
    v_pk_mul_f32 v[108:109], v[108:109], v[58:59] op_sel_hi:[1,0]
    v_pk_mul_f32 v[110:111], v[110:111], v[58:59] op_sel_hi:[1,0]
    v_pk_mul_f32 v[112:113], v[112:113], v[58:59] op_sel_hi:[1,0]
    v_pk_mul_f32 v[114:115], v[114:115], v[58:59] op_sel_hi:[1,0]
    v_pk_mul_f32 v[116:117], v[116:117], v[58:59] op_sel_hi:[1,0]
    v_pk_mul_f32 v[118:119], v[118:119], v[58:59] op_sel_hi:[1,0]
    v_pk_mul_f32 v[120:121], v[120:121], v[58:59] op_sel_hi:[1,0]
    v_pk_mul_f32 v[122:123], v[122:123], v[58:59] op_sel_hi:[1,0]
    v_pk_mul_f32 v[124:125], v[124:125], v[58:59] op_sel_hi:[1,0]
    v_pk_mul_f32 v[126:127], v[126:127], v[58:59] op_sel_hi:[1,0]
    v_cvt_pk_bf16_f32 v32, v96, v97
    s_add_u32 m0, s35, 98304
    s_add_u32 s33, s34, 65536
    buffer_load_dwordx4 v1, s[12:15], s33 offen lds
    v_cvt_pk_bf16_f32 v33, v98, v99
    v_cvt_pk_bf16_f32 v34, v104, v105
    v_cvt_pk_bf16_f32 v35, v106, v107
    v_cvt_pk_bf16_f32 v36, v100, v101
    v_cvt_pk_bf16_f32 v37, v102, v103
    v_cvt_pk_bf16_f32 v38, v108, v109
    v_cvt_pk_bf16_f32 v39, v110, v111
    v_cvt_pk_bf16_f32 v40, v112, v113
    v_cvt_pk_bf16_f32 v41, v114, v115
    v_cvt_pk_bf16_f32 v42, v120, v121
    v_cvt_pk_bf16_f32 v43, v122, v123
    v_cvt_pk_bf16_f32 v44, v116, v117
    buffer_load_dwordx4 v2, s[12:15], s33 offen offset:1024 lds
    v_cvt_pk_bf16_f32 v45, v118, v119
    v_cvt_pk_bf16_f32 v46, v124, v125
    v_cvt_pk_bf16_f32 v47, v126, v127
    ds_write_b128 v26, v[32:35]
    ds_write_b128 v27, v[36:39]
    ds_write_b128 v26, v[40:43] offset:8192
    ds_write_b128 v27, v[44:47] offset:8192
    buffer_load_dwordx4 v3, s[12:15], s33 offen offset:2048 lds
    buffer_load_dwordx4 v4, s[12:15], s33 offen offset:3072 lds
    s_mul_i32 s30, s27, 125
    s_lshl_b32 s31, s28, 1
    s_add_u32 s30, s30, s31
    s_lshl_b32 s30, s30, 14
    s_add_u32 s30, s30, 0x0
    s_lshr_b32 s31, s24, 2
    s_and_b32 s31, s31, s36
    s_cmp_eq_u32 s31, 0
    s_cselect_b32 s30, s30, 0x7fff0000
    s_add_u32 s31, s30, 8192
    buffer_store_dwordx4 v[32:35], v26, s[20:23], s30 offen sc1
    buffer_store_dwordx4 v[36:39], v27, s[20:23], s30 offen sc1
    buffer_store_dwordx4 v[40:43], v26, s[20:23], s31 offen sc1
    buffer_store_dwordx4 v[44:47], v27, s[20:23], s31 offen sc1
    s_waitcnt vmcnt(12)
    s_waitcnt lgkmcnt(0)
    s_barrier
    ds_read_b64_tr_b16 v[32:33], v9
    ds_read_b64_tr_b16 v[34:35], v9 offset:8192
    ds_read_b64_tr_b16 v[36:37], v10
    ds_read_b64_tr_b16 v[38:39], v10 offset:8192
    ds_read_b64_tr_b16 v[40:41], v9 offset:16384
    ds_read_b64_tr_b16 v[42:43], v9 offset:24576
    ds_read_b64_tr_b16 v[44:45], v10 offset:16384
    ds_read_b64_tr_b16 v[46:47], v10 offset:24576
    ds_read_b128 v[128:131], v17
    ds_read_b128 v[132:135], v17 offset:256
    ds_read_b128 v[136:139], v17 offset:16384
    ds_read_b128 v[140:143], v17 offset:16640
    ds_read_b128 v[144:147], v17 offset:2048
    ds_read_b128 v[148:151], v17 offset:2304
    ds_read_b128 v[152:155], v17 offset:18432
    s_waitcnt lgkmcnt(12)
    ds_read_b128 v[156:159], v17 offset:18688
    s_add_u32 m0, s35, 131072
    s_add_u32 s33, s34, 98304
    buffer_load_dwordx4 v1, s[12:15], s33 offen lds
    buffer_load_dwordx4 v2, s[12:15], s33 offen offset:1024 lds
    buffer_load_dwordx4 v3, s[12:15], s33 offen offset:2048 lds
    buffer_load_dwordx4 v4, s[12:15], s33 offen offset:3072 lds
    v_mov_b32 v24, -1
    v_mov_b32 v25, -1
    v_mov_b32 v26, -1
    v_mov_b32 v27, -1
    s_lshl_b32 s33, s26, 1
    s_add_u32 s33, s33, s25
    s_mul_i32 s30, s33, 17408
    s_add_u32 s30, s30, 0x1100000
    s_lshl_b32 s31, s24, 11
    s_add_u32 s31, s31, s30
    buffer_store_dwordx4 v[24:27], v19, s[20:23], s31 offen sc1
    buffer_store_dwordx4 v[24:27], v19, s[20:23], s31 offen offset:1024 sc1
    s_add_u32 s30, s30, 16384
    s_cmp_eq_u32 s24, 0
    s_cselect_b32 s30, s30, 0x7fff0000
    buffer_store_dwordx4 v[24:27], v19, s[20:23], s30 offen sc1
    s_or_b32 s30, s24, s33
    s_cmp_eq_u32 s30, 0
    s_mov_b32 s31, 0x1a80000
    s_cselect_b32 s30, s31, 0x7fff0000
    v_mov_b32 v28, 0
    v_mov_b32 v29, 0
    v_mov_b32 v30, 0
    v_mov_b32 v31, 0
    buffer_store_dwordx4 v[28:31], v19, s[20:23], s30 offen sc1
    s_waitcnt vmcnt(16)
    s_waitcnt lgkmcnt(0)
    s_barrier
    v_mfma_f32_16x16x32_bf16 v[64:67], v[32:35], v[128:131], 0
    ds_read_b64_tr_b16 v[48:49], v9 offset:32768
    ds_read_b64_tr_b16 v[50:51], v9 offset:40960
    v_mfma_f32_16x16x32_bf16 v[80:83], v[36:39], v[128:131], 0
    ds_read_b64_tr_b16 v[52:53], v10 offset:32768
    ds_read_b64_tr_b16 v[54:55], v10 offset:40960
    v_mfma_f32_16x16x32_bf16 v[68:71], v[32:35], v[132:135], 0
    ds_read_b64_tr_b16 v[56:57], v9 offset:49152
    ds_read_b64_tr_b16 v[58:59], v9 offset:57344
    v_mfma_f32_16x16x32_bf16 v[84:87], v[36:39], v[132:135], 0
    ds_read_b64_tr_b16 v[60:61], v10 offset:49152
    ds_read_b64_tr_b16 v[62:63], v10 offset:57344
    v_mfma_f32_16x16x32_bf16 v[72:75], v[32:35], v[136:139], 0
    ds_read_b128 v[160:163], v17 offset:4096
    ds_read_b128 v[164:167], v17 offset:4352
    v_mfma_f32_16x16x32_bf16 v[88:91], v[36:39], v[136:139], 0
    ds_read_b128 v[168:171], v17 offset:20480
    ds_read_b128 v[172:175], v17 offset:20736
    v_mfma_f32_16x16x32_bf16 v[76:79], v[32:35], v[140:143], 0
    ds_read_b128 v[176:179], v17 offset:6144
    ds_read_b128 v[180:183], v17 offset:6400
    v_mfma_f32_16x16x32_bf16 v[92:95], v[36:39], v[140:143], 0
    ds_read_b128 v[184:187], v17 offset:22528
    s_waitcnt lgkmcnt(12)
    ds_read_b128 v[188:191], v17 offset:22784
    v_mfma_f32_16x16x32_bf16 v[64:67], v[40:43], v[144:147], v[64:67]
    s_add_u32 m0, s35, 32768
    s_add_u32 s33, s37, 0
    buffer_load_dwordx4 v5, s[16:19], s33 offen lds
    v_mfma_f32_16x16x32_bf16 v[80:83], v[44:47], v[144:147], v[80:83]
    v_mfma_f32_16x16x32_bf16 v[68:71], v[40:43], v[148:151], v[68:71]
    buffer_load_dwordx4 v6, s[16:19], s33 offen offset:1024 lds
    v_mfma_f32_16x16x32_bf16 v[84:87], v[44:47], v[148:151], v[84:87]
    v_mfma_f32_16x16x32_bf16 v[72:75], v[40:43], v[152:155], v[72:75]
    buffer_load_dwordx4 v7, s[16:19], s33 offen offset:2048 lds
    v_mfma_f32_16x16x32_bf16 v[88:91], v[44:47], v[152:155], v[88:91]
    v_mfma_f32_16x16x32_bf16 v[76:79], v[40:43], v[156:159], v[76:79]
    buffer_load_dwordx4 v8, s[16:19], s33 offen offset:3072 lds
    v_mfma_f32_16x16x32_bf16 v[92:95], v[44:47], v[156:159], v[92:95]
    s_lshr_b32 s30, s2, 3
    s_lshl_b32 s30, s30, 3
    s_add_u32 s30, s30, s24
    s_lshl_b32 s30, s30, 13
    v_lshlrev_b32 v30, 7, v0
    s_getpc_b64 s[48:49]
K1_PCQ:
    s_add_u32 s48, s48, k2_kernel-K1_PCQ
    s_addc_u32 s49, s49, 0
    s_mov_b32 s50, K2_CODE_END-k2_kernel
    s_mov_b32 s51, 0x00020000
    buffer_load_dword v31, v30, s[48:51], s30 offen
    s_waitcnt vmcnt(17)
    s_waitcnt lgkmcnt(0)
    s_barrier
    v_mfma_f32_16x16x32_bf16 v[64:67], v[48:51], v[160:163], v[64:67]
    ds_read_b64_tr_b16 v[32:33], v11
    ds_read_b64_tr_b16 v[34:35], v11 offset:8192
    v_mfma_f32_16x16x32_bf16 v[80:83], v[52:55], v[160:163], v[80:83]
    ds_read_b64_tr_b16 v[36:37], v12
    ds_read_b64_tr_b16 v[38:39], v12 offset:8192
    v_mfma_f32_16x16x32_bf16 v[68:71], v[48:51], v[164:167], v[68:71]
    ds_read_b64_tr_b16 v[40:41], v11 offset:16384
    ds_read_b64_tr_b16 v[42:43], v11 offset:24576
    v_mfma_f32_16x16x32_bf16 v[84:87], v[52:55], v[164:167], v[84:87]
    ds_read_b64_tr_b16 v[44:45], v12 offset:16384
    ds_read_b64_tr_b16 v[46:47], v12 offset:24576
    v_mfma_f32_16x16x32_bf16 v[72:75], v[48:51], v[168:171], v[72:75]
    ds_read_b128 v[128:131], v17 offset:8192
    ds_read_b128 v[132:135], v17 offset:8448
    v_mfma_f32_16x16x32_bf16 v[88:91], v[52:55], v[168:171], v[88:91]
    ds_read_b128 v[136:139], v17 offset:24576
    ds_read_b128 v[140:143], v17 offset:24832
    v_mfma_f32_16x16x32_bf16 v[76:79], v[48:51], v[172:175], v[76:79]
    ds_read_b128 v[144:147], v17 offset:10240
    ds_read_b128 v[148:151], v17 offset:10496
    v_mfma_f32_16x16x32_bf16 v[92:95], v[52:55], v[172:175], v[92:95]
    ds_read_b128 v[152:155], v17 offset:26624
    s_waitcnt lgkmcnt(12)
    ds_read_b128 v[156:159], v17 offset:26880
    v_mfma_f32_16x16x32_bf16 v[64:67], v[56:59], v[176:179], v[64:67]
    s_add_u32 m0, s35, 65536
    s_add_u32 s33, s37, 128
    buffer_load_dwordx4 v5, s[16:19], s33 offen lds
    v_mfma_f32_16x16x32_bf16 v[80:83], v[60:63], v[176:179], v[80:83]
    v_mfma_f32_16x16x32_bf16 v[68:71], v[56:59], v[180:183], v[68:71]
    buffer_load_dwordx4 v6, s[16:19], s33 offen offset:1024 lds
    v_mfma_f32_16x16x32_bf16 v[84:87], v[60:63], v[180:183], v[84:87]
    v_mfma_f32_16x16x32_bf16 v[72:75], v[56:59], v[184:187], v[72:75]
    buffer_load_dwordx4 v7, s[16:19], s33 offen offset:2048 lds
    v_mfma_f32_16x16x32_bf16 v[88:91], v[60:63], v[184:187], v[88:91]
    v_mfma_f32_16x16x32_bf16 v[76:79], v[56:59], v[188:191], v[76:79]
    buffer_load_dwordx4 v8, s[16:19], s33 offen offset:3072 lds
    v_mfma_f32_16x16x32_bf16 v[92:95], v[60:63], v[188:191], v[92:95]
    s_waitcnt vmcnt(13)
    s_waitcnt lgkmcnt(0)
    s_barrier
    v_mfma_f32_16x16x32_bf16 v[64:67], v[32:35], v[128:131], v[64:67]
    ds_read_b64_tr_b16 v[48:49], v11 offset:32768
    ds_read_b64_tr_b16 v[50:51], v11 offset:40960
    v_mfma_f32_16x16x32_bf16 v[80:83], v[36:39], v[128:131], v[80:83]
    ds_read_b64_tr_b16 v[52:53], v12 offset:32768
    ds_read_b64_tr_b16 v[54:55], v12 offset:40960
    v_mfma_f32_16x16x32_bf16 v[68:71], v[32:35], v[132:135], v[68:71]
    ds_read_b64_tr_b16 v[56:57], v11 offset:49152
    ds_read_b64_tr_b16 v[58:59], v11 offset:57344
    v_mfma_f32_16x16x32_bf16 v[84:87], v[36:39], v[132:135], v[84:87]
    ds_read_b64_tr_b16 v[60:61], v12 offset:49152
    ds_read_b64_tr_b16 v[62:63], v12 offset:57344
    v_mfma_f32_16x16x32_bf16 v[72:75], v[32:35], v[136:139], v[72:75]
    ds_read_b128 v[160:163], v17 offset:12288
    ds_read_b128 v[164:167], v17 offset:12544
    v_mfma_f32_16x16x32_bf16 v[88:91], v[36:39], v[136:139], v[88:91]
    ds_read_b128 v[168:171], v17 offset:28672
    ds_read_b128 v[172:175], v17 offset:28928
    v_mfma_f32_16x16x32_bf16 v[76:79], v[32:35], v[140:143], v[76:79]
    ds_read_b128 v[176:179], v17 offset:14336
    ds_read_b128 v[180:183], v17 offset:14592
    v_mfma_f32_16x16x32_bf16 v[92:95], v[36:39], v[140:143], v[92:95]
    ds_read_b128 v[184:187], v17 offset:30720
    s_waitcnt lgkmcnt(12)
    ds_read_b128 v[188:191], v17 offset:30976
    v_mfma_f32_16x16x32_bf16 v[64:67], v[40:43], v[144:147], v[64:67]
    s_add_u32 m0, s35, 98304
    s_add_u32 s33, s37, 256
    buffer_load_dwordx4 v5, s[16:19], s33 offen lds
    v_mfma_f32_16x16x32_bf16 v[80:83], v[44:47], v[144:147], v[80:83]
    v_mfma_f32_16x16x32_bf16 v[68:71], v[40:43], v[148:151], v[68:71]
    buffer_load_dwordx4 v6, s[16:19], s33 offen offset:1024 lds
    v_mfma_f32_16x16x32_bf16 v[84:87], v[44:47], v[148:151], v[84:87]
    v_mfma_f32_16x16x32_bf16 v[72:75], v[40:43], v[152:155], v[72:75]
    buffer_load_dwordx4 v7, s[16:19], s33 offen offset:2048 lds
    v_mfma_f32_16x16x32_bf16 v[88:91], v[44:47], v[152:155], v[88:91]
    v_mfma_f32_16x16x32_bf16 v[76:79], v[40:43], v[156:159], v[76:79]
    buffer_load_dwordx4 v8, s[16:19], s33 offen offset:3072 lds
    v_mfma_f32_16x16x32_bf16 v[92:95], v[44:47], v[156:159], v[92:95]
    s_waitcnt vmcnt(9)
    s_waitcnt lgkmcnt(0)
    s_barrier
    v_mfma_f32_16x16x32_bf16 v[64:67], v[48:51], v[160:163], v[64:67]
    v_mfma_f32_16x16x32_bf16 v[80:83], v[52:55], v[160:163], v[80:83]
    v_mfma_f32_16x16x32_bf16 v[68:71], v[48:51], v[164:167], v[68:71]
    v_mfma_f32_16x16x32_bf16 v[84:87], v[52:55], v[164:167], v[84:87]
    v_mfma_f32_16x16x32_bf16 v[72:75], v[48:51], v[168:171], v[72:75]
    v_mfma_f32_16x16x32_bf16 v[88:91], v[52:55], v[168:171], v[88:91]
    v_mfma_f32_16x16x32_bf16 v[76:79], v[48:51], v[172:175], v[76:79]
    v_mfma_f32_16x16x32_bf16 v[92:95], v[52:55], v[172:175], v[92:95]
    v_mfma_f32_16x16x32_bf16 v[64:67], v[56:59], v[176:179], v[64:67]
    s_add_u32 m0, s35, 131072
    s_add_u32 s33, s37, 384
    buffer_load_dwordx4 v5, s[16:19], s33 offen lds
    v_mfma_f32_16x16x32_bf16 v[80:83], v[60:63], v[176:179], v[80:83]
    v_mfma_f32_16x16x32_bf16 v[68:71], v[56:59], v[180:183], v[68:71]
    buffer_load_dwordx4 v6, s[16:19], s33 offen offset:1024 lds
    v_mfma_f32_16x16x32_bf16 v[84:87], v[60:63], v[180:183], v[84:87]
    v_mfma_f32_16x16x32_bf16 v[72:75], v[56:59], v[184:187], v[72:75]
    buffer_load_dwordx4 v7, s[16:19], s33 offen offset:2048 lds
    v_mfma_f32_16x16x32_bf16 v[88:91], v[60:63], v[184:187], v[88:91]
    v_mfma_f32_16x16x32_bf16 v[76:79], v[56:59], v[188:191], v[76:79]
    buffer_load_dwordx4 v8, s[16:19], s33 offen offset:3072 lds
    v_mfma_f32_16x16x32_bf16 v[92:95], v[60:63], v[188:191], v[92:95]
    v_cvt_pk_bf16_f32 v64, v64, v65
    v_cvt_pk_bf16_f32 v65, v66, v67
    ds_write_b64 v18, v[64:65]
    v_cvt_pk_bf16_f32 v68, v68, v69
    v_cvt_pk_bf16_f32 v69, v70, v71
    ds_write_b64 v18, v[68:69] offset:256
    v_cvt_pk_bf16_f32 v72, v72, v73
    v_cvt_pk_bf16_f32 v73, v74, v75
    ds_write_b64 v18, v[72:73] offset:16384
    v_cvt_pk_bf16_f32 v76, v76, v77
    v_cvt_pk_bf16_f32 v77, v78, v79
    ds_write_b64 v18, v[76:77] offset:16640
    v_cvt_pk_bf16_f32 v80, v80, v81
    v_cvt_pk_bf16_f32 v81, v82, v83
    ds_write_b64 v18, v[80:81] offset:1024
    v_cvt_pk_bf16_f32 v84, v84, v85
    v_cvt_pk_bf16_f32 v85, v86, v87
    ds_write_b64 v18, v[84:85] offset:1280
    v_cvt_pk_bf16_f32 v88, v88, v89
    v_cvt_pk_bf16_f32 v89, v90, v91
    ds_write_b64 v18, v[88:89] offset:17408
    v_cvt_pk_bf16_f32 v92, v92, v93
    v_cvt_pk_bf16_f32 v93, v94, v95
    ds_write_b64 v18, v[92:93] offset:17664
    ds_read_b128 v[32:35], v13
    ds_read_b128 v[36:39], v13 offset:2048
    ds_read_b128 v[40:43], v14
    ds_read_b128 v[44:47], v14 offset:2048
    s_waitcnt lgkmcnt(0)
    s_barrier
    ds_read_b128 v[128:131], v17
    ds_read_b128 v[132:135], v17 offset:256
    ds_read_b128 v[136:139], v17 offset:16384
    ds_read_b128 v[140:143], v17 offset:16640
    ds_read_b128 v[144:147], v17 offset:2048
    ds_read_b128 v[148:151], v17 offset:2304
    ds_read_b128 v[152:155], v17 offset:18432
    ds_read_b128 v[156:159], v17 offset:18688
    s_waitcnt vmcnt(8)
    s_waitcnt lgkmcnt(0)
    s_barrier
    v_mfma_f32_16x16x32_bf16 v[96:99], v[32:35], v[128:131], 0
    ds_read_b128 v[48:51], v13 offset:32768
    ds_read_b128 v[52:55], v13 offset:34816
    v_mfma_f32_16x16x32_bf16 v[112:115], v[36:39], v[128:131], 0
    ds_read_b128 v[56:59], v14 offset:32768
    ds_read_b128 v[60:63], v14 offset:34816
    v_mfma_f32_16x16x32_bf16 v[100:103], v[32:35], v[132:135], 0
    ds_read_b128 v[160:163], v17 offset:4096
    ds_read_b128 v[164:167], v17 offset:4352
    v_mfma_f32_16x16x32_bf16 v[116:119], v[36:39], v[132:135], 0
    ds_read_b128 v[168:171], v17 offset:20480
    ds_read_b128 v[172:175], v17 offset:20736
    v_mfma_f32_16x16x32_bf16 v[104:107], v[32:35], v[136:139], 0
    ds_read_b128 v[176:179], v17 offset:6144
    ds_read_b128 v[180:183], v17 offset:6400
    v_mfma_f32_16x16x32_bf16 v[120:123], v[36:39], v[136:139], 0
    ds_read_b128 v[184:187], v17 offset:22528
    ds_read_b128 v[188:191], v17 offset:22784
    v_mfma_f32_16x16x32_bf16 v[108:111], v[32:35], v[140:143], 0
    v_mfma_f32_16x16x32_bf16 v[124:127], v[36:39], v[140:143], 0
    v_mfma_f32_16x16x32_bf16 v[96:99], v[40:43], v[144:147], v[96:99]
    v_mfma_f32_16x16x32_bf16 v[112:115], v[44:47], v[144:147], v[112:115]
    v_mfma_f32_16x16x32_bf16 v[100:103], v[40:43], v[148:151], v[100:103]
    v_mfma_f32_16x16x32_bf16 v[116:119], v[44:47], v[148:151], v[116:119]
    v_mfma_f32_16x16x32_bf16 v[104:107], v[40:43], v[152:155], v[104:107]
    v_mfma_f32_16x16x32_bf16 v[120:123], v[44:47], v[152:155], v[120:123]
    v_mfma_f32_16x16x32_bf16 v[108:111], v[40:43], v[156:159], v[108:111]
    v_mfma_f32_16x16x32_bf16 v[124:127], v[44:47], v[156:159], v[124:127]
    s_waitcnt vmcnt(4)
    s_waitcnt lgkmcnt(0)
    s_barrier
    v_mfma_f32_16x16x32_bf16 v[96:99], v[48:51], v[160:163], v[96:99]
    ds_read_b128 v[32:35], v15
    ds_read_b128 v[36:39], v15 offset:2048
    v_mfma_f32_16x16x32_bf16 v[112:115], v[52:55], v[160:163], v[112:115]
    ds_read_b128 v[40:43], v16
    ds_read_b128 v[44:47], v16 offset:2048
    v_mfma_f32_16x16x32_bf16 v[100:103], v[48:51], v[164:167], v[100:103]
    ds_read_b128 v[128:131], v17 offset:8192
    ds_read_b128 v[132:135], v17 offset:8448
    v_mfma_f32_16x16x32_bf16 v[116:119], v[52:55], v[164:167], v[116:119]
    ds_read_b128 v[136:139], v17 offset:24576
    ds_read_b128 v[140:143], v17 offset:24832
    v_mfma_f32_16x16x32_bf16 v[104:107], v[48:51], v[168:171], v[104:107]
    ds_read_b128 v[144:147], v17 offset:10240
    ds_read_b128 v[148:151], v17 offset:10496
    v_mfma_f32_16x16x32_bf16 v[120:123], v[52:55], v[168:171], v[120:123]
    ds_read_b128 v[152:155], v17 offset:26624
    ds_read_b128 v[156:159], v17 offset:26880
    v_mfma_f32_16x16x32_bf16 v[108:111], v[48:51], v[172:175], v[108:111]
    v_mfma_f32_16x16x32_bf16 v[124:127], v[52:55], v[172:175], v[124:127]
    v_mfma_f32_16x16x32_bf16 v[96:99], v[56:59], v[176:179], v[96:99]
    v_mfma_f32_16x16x32_bf16 v[112:115], v[60:63], v[176:179], v[112:115]
    v_mfma_f32_16x16x32_bf16 v[100:103], v[56:59], v[180:183], v[100:103]
    v_mfma_f32_16x16x32_bf16 v[116:119], v[60:63], v[180:183], v[116:119]
    v_mfma_f32_16x16x32_bf16 v[104:107], v[56:59], v[184:187], v[104:107]
    v_mfma_f32_16x16x32_bf16 v[120:123], v[60:63], v[184:187], v[120:123]
    v_mfma_f32_16x16x32_bf16 v[108:111], v[56:59], v[188:191], v[108:111]
    v_mfma_f32_16x16x32_bf16 v[124:127], v[60:63], v[188:191], v[124:127]
    s_waitcnt vmcnt(0)
    s_waitcnt lgkmcnt(0)
    s_barrier
    v_mfma_f32_16x16x32_bf16 v[96:99], v[32:35], v[128:131], v[96:99]
    ds_read_b128 v[48:51], v15 offset:32768
    ds_read_b128 v[52:55], v15 offset:34816
    v_mfma_f32_16x16x32_bf16 v[112:115], v[36:39], v[128:131], v[112:115]
    ds_read_b128 v[56:59], v16 offset:32768
    ds_read_b128 v[60:63], v16 offset:34816
    v_mfma_f32_16x16x32_bf16 v[100:103], v[32:35], v[132:135], v[100:103]
    ds_read_b128 v[160:163], v17 offset:12288
    ds_read_b128 v[164:167], v17 offset:12544
    v_mfma_f32_16x16x32_bf16 v[116:119], v[36:39], v[132:135], v[116:119]
    ds_read_b128 v[168:171], v17 offset:28672
    ds_read_b128 v[172:175], v17 offset:28928
    v_mfma_f32_16x16x32_bf16 v[104:107], v[32:35], v[136:139], v[104:107]
    ds_read_b128 v[176:179], v17 offset:14336
    ds_read_b128 v[180:183], v17 offset:14592
    v_mfma_f32_16x16x32_bf16 v[120:123], v[36:39], v[136:139], v[120:123]
    ds_read_b128 v[184:187], v17 offset:30720
    ds_read_b128 v[188:191], v17 offset:30976
    v_mfma_f32_16x16x32_bf16 v[108:111], v[32:35], v[140:143], v[108:111]
    v_mfma_f32_16x16x32_bf16 v[124:127], v[36:39], v[140:143], v[124:127]
    v_mfma_f32_16x16x32_bf16 v[96:99], v[40:43], v[144:147], v[96:99]
    v_mfma_f32_16x16x32_bf16 v[112:115], v[44:47], v[144:147], v[112:115]
    v_mfma_f32_16x16x32_bf16 v[100:103], v[40:43], v[148:151], v[100:103]
    v_mfma_f32_16x16x32_bf16 v[116:119], v[44:47], v[148:151], v[116:119]
    v_mfma_f32_16x16x32_bf16 v[104:107], v[40:43], v[152:155], v[104:107]
    v_mfma_f32_16x16x32_bf16 v[120:123], v[44:47], v[152:155], v[120:123]
    v_mfma_f32_16x16x32_bf16 v[108:111], v[40:43], v[156:159], v[108:111]
    v_mfma_f32_16x16x32_bf16 v[124:127], v[44:47], v[156:159], v[124:127]
    s_waitcnt lgkmcnt(7)
    v_mfma_f32_16x16x32_bf16 v[96:99], v[48:51], v[160:163], v[96:99]
    v_mfma_f32_16x16x32_bf16 v[112:115], v[52:55], v[160:163], v[112:115]
    s_waitcnt lgkmcnt(6)
    v_mfma_f32_16x16x32_bf16 v[100:103], v[48:51], v[164:167], v[100:103]
    v_mfma_f32_16x16x32_bf16 v[116:119], v[52:55], v[164:167], v[116:119]
    s_waitcnt lgkmcnt(5)
    v_mfma_f32_16x16x32_bf16 v[104:107], v[48:51], v[168:171], v[104:107]
    v_mfma_f32_16x16x32_bf16 v[120:123], v[52:55], v[168:171], v[120:123]
    s_waitcnt lgkmcnt(4)
    v_mfma_f32_16x16x32_bf16 v[108:111], v[48:51], v[172:175], v[108:111]
    v_mfma_f32_16x16x32_bf16 v[124:127], v[52:55], v[172:175], v[124:127]
    s_waitcnt lgkmcnt(3)
    v_mfma_f32_16x16x32_bf16 v[96:99], v[56:59], v[176:179], v[96:99]
    v_mfma_f32_16x16x32_bf16 v[112:115], v[60:63], v[176:179], v[112:115]
    s_waitcnt lgkmcnt(2)
    v_mfma_f32_16x16x32_bf16 v[100:103], v[56:59], v[180:183], v[100:103]
    v_mfma_f32_16x16x32_bf16 v[116:119], v[60:63], v[180:183], v[116:119]
    s_waitcnt lgkmcnt(1)
    v_mfma_f32_16x16x32_bf16 v[104:107], v[56:59], v[184:187], v[104:107]
    v_mfma_f32_16x16x32_bf16 v[120:123], v[60:63], v[184:187], v[120:123]
    s_waitcnt lgkmcnt(0)
    v_mfma_f32_16x16x32_bf16 v[108:111], v[56:59], v[188:191], v[108:111]
    v_mfma_f32_16x16x32_bf16 v[124:127], v[60:63], v[188:191], v[124:127]
    s_mov_b32 s32, 0x3db8aa3b
    v_mul_f32 v96, s32, v96
    v_mul_f32 v97, s32, v97
    v_mul_f32 v98, s32, v98
    v_mul_f32 v99, s32, v99
    v_mul_f32 v100, s32, v100
    v_mul_f32 v101, s32, v101
    v_mul_f32 v102, s32, v102
    v_mul_f32 v103, s32, v103
    v_mul_f32 v104, s32, v104
    v_mul_f32 v105, s32, v105
    v_mul_f32 v106, s32, v106
    v_mul_f32 v107, s32, v107
    v_mul_f32 v108, s32, v108
    v_mul_f32 v109, s32, v109
    v_mul_f32 v110, s32, v110
    v_mul_f32 v111, s32, v111
    v_mul_f32 v112, s32, v112
    v_mul_f32 v113, s32, v113
    v_mul_f32 v114, s32, v114
    v_mul_f32 v115, s32, v115
    v_mul_f32 v116, s32, v116
    v_mul_f32 v117, s32, v117
    v_mul_f32 v118, s32, v118
    v_mul_f32 v119, s32, v119
    v_mul_f32 v120, s32, v120
    v_mul_f32 v121, s32, v121
    v_mul_f32 v122, s32, v122
    v_mul_f32 v123, s32, v123
    v_mul_f32 v124, s32, v124
    v_mul_f32 v125, s32, v125
    v_mul_f32 v126, s32, v126
    v_mul_f32 v127, s32, v127
    v_cvt_pk_bf16_f32 v96, v96, v97
    v_cvt_pk_bf16_f32 v97, v98, v99
    v_cvt_pk_bf16_f32 v98, v112, v113
    v_cvt_pk_bf16_f32 v99, v114, v115
    v_cvt_pk_bf16_f32 v100, v100, v101
    v_cvt_pk_bf16_f32 v101, v102, v103
    v_cvt_pk_bf16_f32 v102, v116, v117
    v_cvt_pk_bf16_f32 v103, v118, v119
    v_cvt_pk_bf16_f32 v104, v104, v105
    v_cvt_pk_bf16_f32 v105, v106, v107
    v_cvt_pk_bf16_f32 v106, v120, v121
    v_cvt_pk_bf16_f32 v107, v122, v123
    v_cvt_pk_bf16_f32 v108, v108, v109
    v_cvt_pk_bf16_f32 v109, v110, v111
    v_cvt_pk_bf16_f32 v110, v124, v125
    v_cvt_pk_bf16_f32 v111, v126, v127
    s_lshl_b32 s30, s26, 15
    s_lshl_b32 s31, s24, 12
    s_add_u32 s30, s30, s31
    s_add_u32 s30, s30, 0x400000
    buffer_store_dwordx4 v[96:99], v19, s[20:23], s30 offen sc1
    buffer_store_dwordx4 v[100:103], v19, s[20:23], s30 offen offset:1024 sc1
    buffer_store_dwordx4 v[104:107], v19, s[20:23], s30 offen offset:2048 sc1
    buffer_store_dwordx4 v[108:111], v19, s[20:23], s30 offen offset:3072 sc1
    s_endpgm
K1_C:
    s_mov_b32 s12, s44
    s_mov_b32 s13, s45
    s_mov_b32 s14, 0x40000
    s_mov_b32 s15, 0x00020000
    s_lshl_b32 s29, s29, 11
    buffer_load_dwordx4 v[64:67], v19, s[12:15], s29 offen
    buffer_load_dwordx4 v[68:71], v19, s[12:15], s29 offen offset:1024
    v_lshrrev_b32 v20, 5, v0
    v_bfe_u32 v21, v0, 1, 4
    v_and_b32 v22, 1, v0
    v_lshlrev_b32 v22, 4, v22
    v_lshl_add_u32 v22, v20, 10, v22
    v_add_u32 v23, 0, v20
    v_xor_b32 v23, v23, v21
    v_lshl_add_u32 v1, v23, 5, v22
    v_add_u32 v23, 2, v20
    v_xor_b32 v23, v23, v21
    v_lshl_add_u32 v2, v23, 5, v22
    v_add_u32 v2, 1024, v2
    v_add_u32 v23, 4, v20
    v_xor_b32 v23, v23, v21
    v_lshl_add_u32 v3, v23, 5, v22
    v_add_u32 v3, 2048, v3
    v_add_u32 v23, 6, v20
    v_xor_b32 v23, v23, v21
    v_lshl_add_u32 v4, v23, 5, v22
    v_add_u32 v4, 3072, v4
    s_lshl_b32 s34, s24, 13
    v_lshrrev_b32 v20, 4, v0
    v_bfe_u32 v21, v0, 2, 2
    v_and_b32 v22, 3, v0
    v_lshl_add_u32 v9, v20, 2, v21
    v_and_b32 v10, 7, v9
    s_lshl_b32 s30, s24, 1
    v_xor_b32 v10, s30, v10
    v_lshlrev_b32 v10, 5, v10
    v_lshl_add_u32 v9, v9, 9, v10
    v_lshl_add_u32 v9, v22, 3, v9
    v_add_u32 v9, 32768, v9
    v_xor_b32 v10, 32, v9
    v_add_u32 v11, 65536, v9
    v_add_u32 v12, 65536, v10
    v_and_b32 v21, 15, v0
    v_and_b32 v17, 1, v20
    v_mul_u32_u24 v17, 12, v17
    v_xor_b32 v17, v17, v21
    v_lshlrev_b32 v17, 4, v17
    v_lshl_add_u32 v17, v20, 9, v17
    v_and_b32 v20, 7, v0
    v_lshrrev_b32 v21, 3, v0
    v_lshrrev_b32 v22, 1, v21
    v_and_b32 v23, 1, v21
    v_lshlrev_b32 v24, 9, v20
    v_lshl_add_u32 v24, v22, 6, v24
    v_lshl_add_u32 v24, v23, 4, v24
    v_add_u32 v24, s35, v24
    v_add_u32 v24, 0x20000, v24
    s_lshl_b32 s30, s24, 3
    s_and_b32 s30, s30, 31
    v_add_u32 v25, s30, v20
    v_lshlrev_b32 v26, 10, v21
    s_lshr_b32 s31, s24, 2
    s_lshl_b32 s31, s31, 14
    v_add_u32 v26, s31, v26
    v_xor_b32 v27, 12, v25
    v_lshl_add_u32 v27, v27, 4, v26
    v_add_u32 v27, 512, v27
    v_lshl_add_u32 v26, v25, 4, v26
    s_waitcnt vmcnt(2)
    ds_read_b128 v[32:35], v24
    ds_read_b128 v[36:39], v24 offset:32
    ds_read_b128 v[40:43], v24 offset:256
    ds_read_b128 v[44:47], v24 offset:288
    s_waitcnt lgkmcnt(3)
    v_lshlrev_b32 v96, 16, v32
    v_and_b32 v97, 0xffff0000, v32
    v_lshlrev_b32 v98, 16, v33
    v_and_b32 v99, 0xffff0000, v33
    v_lshlrev_b32 v100, 16, v34
    v_and_b32 v101, 0xffff0000, v34
    v_lshlrev_b32 v102, 16, v35
    v_and_b32 v103, 0xffff0000, v35
    s_waitcnt lgkmcnt(2)
    v_lshlrev_b32 v104, 16, v36
    v_and_b32 v105, 0xffff0000, v36
    v_lshlrev_b32 v106, 16, v37
    v_and_b32 v107, 0xffff0000, v37
    v_lshlrev_b32 v108, 16, v38
    v_and_b32 v109, 0xffff0000, v38
    v_lshlrev_b32 v110, 16, v39
    v_and_b32 v111, 0xffff0000, v39
    s_waitcnt lgkmcnt(1)
    v_lshlrev_b32 v112, 16, v40
    v_and_b32 v113, 0xffff0000, v40
    v_lshlrev_b32 v114, 16, v41
    v_and_b32 v115, 0xffff0000, v41
    v_lshlrev_b32 v116, 16, v42
    s_add_u32 m0, s35, 32768
    s_add_u32 s33, s34, 512
    buffer_load_dwordx4 v1, s[12:15], s33 offen lds
    v_and_b32 v117, 0xffff0000, v42
    v_lshlrev_b32 v118, 16, v43
    v_and_b32 v119, 0xffff0000, v43
    s_waitcnt lgkmcnt(0)
    v_lshlrev_b32 v120, 16, v44
    v_and_b32 v121, 0xffff0000, v44
    v_lshlrev_b32 v122, 16, v45
    v_and_b32 v123, 0xffff0000, v45
    v_lshlrev_b32 v124, 16, v46
    v_and_b32 v125, 0xffff0000, v46
    v_lshlrev_b32 v126, 16, v47
    v_and_b32 v127, 0xffff0000, v47
    v_pk_add_f32 v[48:49], v[96:97], v[98:99]
    buffer_load_dwordx4 v2, s[12:15], s33 offen offset:1024 lds
    v_pk_add_f32 v[50:51], v[100:101], v[102:103]
    v_pk_add_f32 v[48:49], v[48:49], v[104:105]
    v_pk_add_f32 v[50:51], v[50:51], v[106:107]
    v_pk_add_f32 v[48:49], v[48:49], v[108:109]
    v_pk_add_f32 v[50:51], v[50:51], v[110:111]
    v_pk_add_f32 v[48:49], v[48:49], v[112:113]
    v_pk_add_f32 v[50:51], v[50:51], v[114:115]
    v_pk_add_f32 v[48:49], v[48:49], v[116:117]
    v_pk_add_f32 v[50:51], v[50:51], v[118:119]
    v_pk_add_f32 v[48:49], v[48:49], v[120:121]
    v_pk_add_f32 v[50:51], v[50:51], v[122:123]
    v_pk_add_f32 v[48:49], v[48:49], v[124:125]
    buffer_load_dwordx4 v3, s[12:15], s33 offen offset:2048 lds
    v_pk_add_f32 v[50:51], v[50:51], v[126:127]
    v_pk_add_f32 v[48:49], v[48:49], v[50:51]
    v_add_f32 v48, v48, v49
    s_nop 1
    v_add_f32_dpp v48, v48, v48 row_ror:8 row_mask:0xf bank_mask:0xf
    v_mov_b32 v52, v48
    s_nop 1
    v_permlane16_swap_b32 v52, v48
    v_add_f32 v48, v48, v52
    v_mov_b32 v52, v48
    s_nop 1
    v_permlane32_swap_b32 v52, v48
    v_add_f32 v48, v48, v52
    v_mul_f32 v48, 0xbb800000, v48
    v_pk_add_f32 v[96:97], v[96:97], v[48:49] op_sel_hi:[1,0]
    buffer_load_dwordx4 v4, s[12:15], s33 offen offset:3072 lds
    v_pk_add_f32 v[98:99], v[98:99], v[48:49] op_sel_hi:[1,0]
    v_pk_add_f32 v[100:101], v[100:101], v[48:49] op_sel_hi:[1,0]
    v_pk_add_f32 v[102:103], v[102:103], v[48:49] op_sel_hi:[1,0]
    v_pk_add_f32 v[104:105], v[104:105], v[48:49] op_sel_hi:[1,0]
    v_pk_add_f32 v[106:107], v[106:107], v[48:49] op_sel_hi:[1,0]
    v_pk_add_f32 v[108:109], v[108:109], v[48:49] op_sel_hi:[1,0]
    v_pk_add_f32 v[110:111], v[110:111], v[48:49] op_sel_hi:[1,0]
    v_pk_add_f32 v[112:113], v[112:113], v[48:49] op_sel_hi:[1,0]
    v_pk_add_f32 v[114:115], v[114:115], v[48:49] op_sel_hi:[1,0]
    v_pk_add_f32 v[116:117], v[116:117], v[48:49] op_sel_hi:[1,0]
    v_pk_add_f32 v[118:119], v[118:119], v[48:49] op_sel_hi:[1,0]
    v_pk_add_f32 v[120:121], v[120:121], v[48:49] op_sel_hi:[1,0]
    s_add_u32 m0, s35, 65536
    s_add_u32 s33, s34, 66048
    buffer_load_dwordx4 v1, s[12:15], s33 offen lds
    v_pk_add_f32 v[122:123], v[122:123], v[48:49] op_sel_hi:[1,0]
    v_pk_add_f32 v[124:125], v[124:125], v[48:49] op_sel_hi:[1,0]
    v_pk_add_f32 v[126:127], v[126:127], v[48:49] op_sel_hi:[1,0]
    v_pk_mul_f32 v[54:55], v[96:97], v[96:97]
    v_pk_mul_f32 v[56:57], v[98:99], v[98:99]
    v_pk_fma_f32 v[54:55], v[100:101], v[100:101], v[54:55]
    v_pk_fma_f32 v[56:57], v[102:103], v[102:103], v[56:57]
    v_pk_fma_f32 v[54:55], v[104:105], v[104:105], v[54:55]
    v_pk_fma_f32 v[56:57], v[106:107], v[106:107], v[56:57]
    v_pk_fma_f32 v[54:55], v[108:109], v[108:109], v[54:55]
    v_pk_fma_f32 v[56:57], v[110:111], v[110:111], v[56:57]
    v_pk_fma_f32 v[54:55], v[112:113], v[112:113], v[54:55]
    buffer_load_dwordx4 v2, s[12:15], s33 offen offset:1024 lds
    v_pk_fma_f32 v[56:57], v[114:115], v[114:115], v[56:57]
    v_pk_fma_f32 v[54:55], v[116:117], v[116:117], v[54:55]
    v_pk_fma_f32 v[56:57], v[118:119], v[118:119], v[56:57]
    v_pk_fma_f32 v[54:55], v[120:121], v[120:121], v[54:55]
    v_pk_fma_f32 v[56:57], v[122:123], v[122:123], v[56:57]
    v_pk_fma_f32 v[54:55], v[124:125], v[124:125], v[54:55]
    v_pk_fma_f32 v[56:57], v[126:127], v[126:127], v[56:57]
    v_pk_add_f32 v[54:55], v[54:55], v[56:57]
    v_add_f32 v54, v54, v55
    s_nop 1
    v_add_f32_dpp v54, v54, v54 row_ror:8 row_mask:0xf bank_mask:0xf
    v_mov_b32 v52, v54
    s_nop 1
    v_permlane16_swap_b32 v52, v54
    buffer_load_dwordx4 v3, s[12:15], s33 offen offset:2048 lds
    v_add_f32 v54, v54, v52
    v_mov_b32 v52, v54
    s_nop 1
    v_permlane32_swap_b32 v52, v54
    v_add_f32 v54, v54, v52
    v_mov_b32 v58, 0x3727c5ac
    v_fmac_f32 v58, 0x3b800000, v54
    v_rsq_f32 v58, v58
    s_nop 0
    v_pk_mul_f32 v[96:97], v[96:97], v[58:59] op_sel_hi:[1,0]
    v_pk_mul_f32 v[98:99], v[98:99], v[58:59] op_sel_hi:[1,0]
    v_pk_mul_f32 v[100:101], v[100:101], v[58:59] op_sel_hi:[1,0]
    v_pk_mul_f32 v[102:103], v[102:103], v[58:59] op_sel_hi:[1,0]
    v_pk_mul_f32 v[104:105], v[104:105], v[58:59] op_sel_hi:[1,0]
    buffer_load_dwordx4 v4, s[12:15], s33 offen offset:3072 lds
    v_pk_mul_f32 v[106:107], v[106:107], v[58:59] op_sel_hi:[1,0]
    v_pk_mul_f32 v[108:109], v[108:109], v[58:59] op_sel_hi:[1,0]
    v_pk_mul_f32 v[110:111], v[110:111], v[58:59] op_sel_hi:[1,0]
    v_pk_mul_f32 v[112:113], v[112:113], v[58:59] op_sel_hi:[1,0]
    v_pk_mul_f32 v[114:115], v[114:115], v[58:59] op_sel_hi:[1,0]
    v_pk_mul_f32 v[116:117], v[116:117], v[58:59] op_sel_hi:[1,0]
    v_pk_mul_f32 v[118:119], v[118:119], v[58:59] op_sel_hi:[1,0]
    v_pk_mul_f32 v[120:121], v[120:121], v[58:59] op_sel_hi:[1,0]
    v_pk_mul_f32 v[122:123], v[122:123], v[58:59] op_sel_hi:[1,0]
    v_pk_mul_f32 v[124:125], v[124:125], v[58:59] op_sel_hi:[1,0]
    v_pk_mul_f32 v[126:127], v[126:127], v[58:59] op_sel_hi:[1,0]
    v_cvt_pk_bf16_f32 v32, v96, v97
    s_add_u32 m0, s35, 98304
    s_add_u32 s33, s34, 131584
    buffer_load_dwordx4 v1, s[12:15], s33 offen lds
    v_cvt_pk_bf16_f32 v33, v98, v99
    v_cvt_pk_bf16_f32 v34, v104, v105
    v_cvt_pk_bf16_f32 v35, v106, v107
    v_cvt_pk_bf16_f32 v36, v100, v101
    v_cvt_pk_bf16_f32 v37, v102, v103
    v_cvt_pk_bf16_f32 v38, v108, v109
    v_cvt_pk_bf16_f32 v39, v110, v111
    v_cvt_pk_bf16_f32 v40, v112, v113
    v_cvt_pk_bf16_f32 v41, v114, v115
    v_cvt_pk_bf16_f32 v42, v120, v121
    v_cvt_pk_bf16_f32 v43, v122, v123
    v_cvt_pk_bf16_f32 v44, v116, v117
    buffer_load_dwordx4 v2, s[12:15], s33 offen offset:1024 lds
    v_cvt_pk_bf16_f32 v45, v118, v119
    v_cvt_pk_bf16_f32 v46, v124, v125
    v_cvt_pk_bf16_f32 v47, v126, v127
    ds_write_b128 v26, v[32:35]
    ds_write_b128 v27, v[36:39]
    ds_write_b128 v26, v[40:43] offset:8192
    ds_write_b128 v27, v[44:47] offset:8192
    buffer_load_dwordx4 v3, s[12:15], s33 offen offset:2048 lds
    buffer_load_dwordx4 v4, s[12:15], s33 offen offset:3072 lds
    s_mov_b32 s39, 0xbdd2d3e8
    s_mov_b32 s38, 0xbdd2d3e8
    s_waitcnt vmcnt(8)
    s_waitcnt lgkmcnt(0)
    s_barrier
    ds_read_b64_tr_b16 v[32:33], v9
    ds_read_b64_tr_b16 v[34:35], v9 offset:8192
    ds_read_b64_tr_b16 v[36:37], v10
    ds_read_b64_tr_b16 v[38:39], v10 offset:8192
    ds_read_b64_tr_b16 v[40:41], v9 offset:16384
    ds_read_b64_tr_b16 v[42:43], v9 offset:24576
    ds_read_b64_tr_b16 v[44:45], v10 offset:16384
    ds_read_b64_tr_b16 v[46:47], v10 offset:24576
    ds_read_b128 v[128:131], v17
    ds_read_b128 v[132:135], v17 offset:256
    ds_read_b128 v[136:139], v17 offset:16384
    ds_read_b128 v[140:143], v17 offset:16640
    ds_read_b128 v[144:147], v17 offset:2048
    ds_read_b128 v[148:151], v17 offset:2304
    ds_read_b128 v[152:155], v17 offset:18432
    s_waitcnt lgkmcnt(12)
    ds_read_b128 v[156:159], v17 offset:18688
    s_add_u32 m0, s35, 131072
    s_add_u32 s33, s34, 197120
    buffer_load_dwordx4 v1, s[12:15], s33 offen lds
    buffer_load_dwordx4 v2, s[12:15], s33 offen offset:1024 lds
    buffer_load_dwordx4 v3, s[12:15], s33 offen offset:2048 lds
    buffer_load_dwordx4 v4, s[12:15], s33 offen offset:3072 lds
    v_mov_b32 v24, -1
    v_mov_b32 v25, -1
    v_mov_b32 v26, -1
    v_mov_b32 v27, -1
    s_lshl_b32 s33, s26, 1
    s_add_u32 s33, s33, s25
    s_mul_i32 s30, s33, 17408
    s_add_u32 s30, s30, 0x1100000
    s_lshl_b32 s31, s24, 11
    s_add_u32 s31, s31, s30
    buffer_store_dwordx4 v[24:27], v19, s[20:23], s31 offen sc1
    buffer_store_dwordx4 v[24:27], v19, s[20:23], s31 offen offset:1024 sc1
    s_add_u32 s30, s30, 16384
    s_cmp_eq_u32 s24, 0
    s_cselect_b32 s30, s30, 0x7fff0000
    buffer_store_dwordx4 v[24:27], v19, s[20:23], s30 offen sc1
    s_or_b32 s30, s24, s33
    s_cmp_eq_u32 s30, 0
    s_mov_b32 s31, 0x1a80000
    s_cselect_b32 s30, s31, 0x7fff0000
    v_mov_b32 v28, 0
    v_mov_b32 v29, 0
    v_mov_b32 v30, 0
    v_mov_b32 v31, 0
    buffer_store_dwordx4 v[28:31], v19, s[20:23], s30 offen sc1
    s_nop 1
    v_mov_b32 v28, 0xc0135761
    s_waitcnt vmcnt(12)
    s_waitcnt lgkmcnt(0)
    s_barrier
    v_mfma_f32_16x16x32_bf16 v[64:67], v[32:35], v[128:131], 0
    ds_read_b64_tr_b16 v[48:49], v9 offset:32768
    ds_read_b64_tr_b16 v[50:51], v9 offset:40960
    v_mfma_f32_16x16x32_bf16 v[80:83], v[36:39], v[128:131], 0
    ds_read_b64_tr_b16 v[52:53], v10 offset:32768
    ds_read_b64_tr_b16 v[54:55], v10 offset:40960
    v_mfma_f32_16x16x32_bf16 v[68:71], v[32:35], v[132:135], 0
    ds_read_b64_tr_b16 v[56:57], v9 offset:49152
    ds_read_b64_tr_b16 v[58:59], v9 offset:57344
    v_mfma_f32_16x16x32_bf16 v[84:87], v[36:39], v[132:135], 0
    ds_read_b64_tr_b16 v[60:61], v10 offset:49152
    ds_read_b64_tr_b16 v[62:63], v10 offset:57344
    v_mfma_f32_16x16x32_bf16 v[72:75], v[32:35], v[136:139], 0
    ds_read_b128 v[160:163], v17 offset:4096
    ds_read_b128 v[164:167], v17 offset:4352
    v_mfma_f32_16x16x32_bf16 v[88:91], v[36:39], v[136:139], 0
    ds_read_b128 v[168:171], v17 offset:20480
    ds_read_b128 v[172:175], v17 offset:20736
    v_mfma_f32_16x16x32_bf16 v[76:79], v[32:35], v[140:143], 0
    ds_read_b128 v[176:179], v17 offset:6144
    ds_read_b128 v[180:183], v17 offset:6400
    v_mfma_f32_16x16x32_bf16 v[92:95], v[36:39], v[140:143], 0
    ds_read_b128 v[184:187], v17 offset:22528
    s_waitcnt lgkmcnt(12)
    ds_read_b128 v[188:191], v17 offset:22784
    v_mfma_f32_16x16x32_bf16 v[64:67], v[40:43], v[144:147], v[64:67]
    s_add_u32 m0, s35, 32768
    s_add_u32 s33, s34, 0
    buffer_load_dwordx4 v1, s[12:15], s33 offen lds
    v_mfma_f32_16x16x32_bf16 v[80:83], v[44:47], v[144:147], v[80:83]
    v_mfma_f32_16x16x32_bf16 v[68:71], v[40:43], v[148:151], v[68:71]
    buffer_load_dwordx4 v2, s[12:15], s33 offen offset:1024 lds
    v_mfma_f32_16x16x32_bf16 v[84:87], v[44:47], v[148:151], v[84:87]
    v_mfma_f32_16x16x32_bf16 v[72:75], v[40:43], v[152:155], v[72:75]
    buffer_load_dwordx4 v3, s[12:15], s33 offen offset:2048 lds
    v_mfma_f32_16x16x32_bf16 v[88:91], v[44:47], v[152:155], v[88:91]
    v_mfma_f32_16x16x32_bf16 v[76:79], v[40:43], v[156:159], v[76:79]
    buffer_load_dwordx4 v4, s[12:15], s33 offen offset:3072 lds
    v_mfma_f32_16x16x32_bf16 v[92:95], v[44:47], v[156:159], v[92:95]
    s_lshr_b32 s30, s2, 3
    s_lshl_b32 s30, s30, 3
    s_add_u32 s30, s30, s24
    s_lshl_b32 s30, s30, 13
    v_lshlrev_b32 v30, 7, v0
    s_getpc_b64 s[48:49]
K1_PCC:
    s_add_u32 s48, s48, k2_kernel-K1_PCC
    s_addc_u32 s49, s49, 0
    s_mov_b32 s50, K2_CODE_END-k2_kernel
    s_mov_b32 s51, 0x00020000
    buffer_load_dword v31, v30, s[48:51], s30 offen
    s_waitcnt vmcnt(13)
    s_waitcnt lgkmcnt(0)
    s_barrier
    v_mfma_f32_16x16x32_bf16 v[64:67], v[48:51], v[160:163], v[64:67]
    ds_read_b64_tr_b16 v[32:33], v11
    ds_read_b64_tr_b16 v[34:35], v11 offset:8192
    v_mfma_f32_16x16x32_bf16 v[80:83], v[52:55], v[160:163], v[80:83]
    ds_read_b64_tr_b16 v[36:37], v12
    ds_read_b64_tr_b16 v[38:39], v12 offset:8192
    v_mfma_f32_16x16x32_bf16 v[68:71], v[48:51], v[164:167], v[68:71]
    ds_read_b64_tr_b16 v[40:41], v11 offset:16384
    ds_read_b64_tr_b16 v[42:43], v11 offset:24576
    v_mfma_f32_16x16x32_bf16 v[84:87], v[52:55], v[164:167], v[84:87]
    ds_read_b64_tr_b16 v[44:45], v12 offset:16384
    ds_read_b64_tr_b16 v[46:47], v12 offset:24576
    v_mfma_f32_16x16x32_bf16 v[72:75], v[48:51], v[168:171], v[72:75]
    ds_read_b128 v[192:195], v17 offset:8192
    ds_read_b128 v[196:199], v17 offset:8448
    v_mfma_f32_16x16x32_bf16 v[88:91], v[52:55], v[168:171], v[88:91]
    ds_read_b128 v[200:203], v17 offset:24576
    ds_read_b128 v[204:207], v17 offset:24832
    v_mfma_f32_16x16x32_bf16 v[76:79], v[48:51], v[172:175], v[76:79]
    ds_read_b128 v[208:211], v17 offset:10240
    ds_read_b128 v[212:215], v17 offset:10496
    v_mfma_f32_16x16x32_bf16 v[92:95], v[52:55], v[172:175], v[92:95]
    ds_read_b128 v[216:219], v17 offset:26624
    s_waitcnt lgkmcnt(12)
    ds_read_b128 v[220:223], v17 offset:26880
    v_mfma_f32_16x16x32_bf16 v[64:67], v[56:59], v[176:179], v[64:67]
    s_add_u32 m0, s35, 65536
    s_add_u32 s33, s34, 65536
    buffer_load_dwordx4 v1, s[12:15], s33 offen lds
    v_mfma_f32_16x16x32_bf16 v[80:83], v[60:63], v[176:179], v[80:83]
    v_mfma_f32_16x16x32_bf16 v[68:71], v[56:59], v[180:183], v[68:71]
    buffer_load_dwordx4 v2, s[12:15], s33 offen offset:1024 lds
    v_mfma_f32_16x16x32_bf16 v[84:87], v[60:63], v[180:183], v[84:87]
    v_mfma_f32_16x16x32_bf16 v[72:75], v[56:59], v[184:187], v[72:75]
    buffer_load_dwordx4 v3, s[12:15], s33 offen offset:2048 lds
    v_mfma_f32_16x16x32_bf16 v[88:91], v[60:63], v[184:187], v[88:91]
    v_mfma_f32_16x16x32_bf16 v[76:79], v[56:59], v[188:191], v[76:79]
    buffer_load_dwordx4 v4, s[12:15], s33 offen offset:3072 lds
    v_mfma_f32_16x16x32_bf16 v[92:95], v[60:63], v[188:191], v[92:95]
    s_waitcnt vmcnt(13)
    s_waitcnt lgkmcnt(0)
    s_barrier
    v_mfma_f32_16x16x32_bf16 v[64:67], v[32:35], v[192:195], v[64:67]
    ds_read_b64_tr_b16 v[48:49], v11 offset:32768
    ds_read_b64_tr_b16 v[50:51], v11 offset:40960
    v_mfma_f32_16x16x32_bf16 v[80:83], v[36:39], v[192:195], v[80:83]
    ds_read_b64_tr_b16 v[52:53], v12 offset:32768
    ds_read_b64_tr_b16 v[54:55], v12 offset:40960
    v_mfma_f32_16x16x32_bf16 v[68:71], v[32:35], v[196:199], v[68:71]
    ds_read_b64_tr_b16 v[56:57], v11 offset:49152
    ds_read_b64_tr_b16 v[58:59], v11 offset:57344
    v_mfma_f32_16x16x32_bf16 v[84:87], v[36:39], v[196:199], v[84:87]
    ds_read_b64_tr_b16 v[60:61], v12 offset:49152
    ds_read_b64_tr_b16 v[62:63], v12 offset:57344
    v_mfma_f32_16x16x32_bf16 v[72:75], v[32:35], v[200:203], v[72:75]
    ds_read_b128 v[224:227], v17 offset:12288
    ds_read_b128 v[228:231], v17 offset:12544
    v_mfma_f32_16x16x32_bf16 v[88:91], v[36:39], v[200:203], v[88:91]
    ds_read_b128 v[232:235], v17 offset:28672
    ds_read_b128 v[236:239], v17 offset:28928
    v_mfma_f32_16x16x32_bf16 v[76:79], v[32:35], v[204:207], v[76:79]
    ds_read_b128 v[240:243], v17 offset:14336
    ds_read_b128 v[244:247], v17 offset:14592
    v_mfma_f32_16x16x32_bf16 v[92:95], v[36:39], v[204:207], v[92:95]
    ds_read_b128 v[248:251], v17 offset:30720
    s_waitcnt lgkmcnt(12)
    ds_read_b128 v[252:255], v17 offset:30976
    v_mfma_f32_16x16x32_bf16 v[64:67], v[40:43], v[208:211], v[64:67]
    s_add_u32 m0, s35, 98304
    s_add_u32 s33, s34, 131072
    buffer_load_dwordx4 v1, s[12:15], s33 offen lds
    v_mfma_f32_16x16x32_bf16 v[80:83], v[44:47], v[208:211], v[80:83]
    v_mfma_f32_16x16x32_bf16 v[68:71], v[40:43], v[212:215], v[68:71]
    buffer_load_dwordx4 v2, s[12:15], s33 offen offset:1024 lds
    v_mfma_f32_16x16x32_bf16 v[84:87], v[44:47], v[212:215], v[84:87]
    v_mfma_f32_16x16x32_bf16 v[72:75], v[40:43], v[216:219], v[72:75]
    buffer_load_dwordx4 v3, s[12:15], s33 offen offset:2048 lds
    v_mfma_f32_16x16x32_bf16 v[88:91], v[44:47], v[216:219], v[88:91]
    v_mfma_f32_16x16x32_bf16 v[76:79], v[40:43], v[220:223], v[76:79]
    buffer_load_dwordx4 v4, s[12:15], s33 offen offset:3072 lds
    v_mfma_f32_16x16x32_bf16 v[92:95], v[44:47], v[220:223], v[92:95]
    s_waitcnt vmcnt(9)
    s_waitcnt lgkmcnt(0)
    s_barrier
    v_mfma_f32_16x16x32_bf16 v[64:67], v[48:51], v[224:227], v[64:67]
    ds_read_b64_tr_b16 v[32:33], v9
    ds_read_b64_tr_b16 v[34:35], v9 offset:8192
    v_mfma_f32_16x16x32_bf16 v[80:83], v[52:55], v[224:227], v[80:83]
    ds_read_b64_tr_b16 v[36:37], v10
    ds_read_b64_tr_b16 v[38:39], v10 offset:8192
    v_mfma_f32_16x16x32_bf16 v[68:71], v[48:51], v[228:231], v[68:71]
    ds_read_b64_tr_b16 v[40:41], v9 offset:16384
    ds_read_b64_tr_b16 v[42:43], v9 offset:24576
    v_mfma_f32_16x16x32_bf16 v[84:87], v[52:55], v[228:231], v[84:87]
    ds_read_b64_tr_b16 v[44:45], v10 offset:16384
    ds_read_b64_tr_b16 v[46:47], v10 offset:24576
    v_mfma_f32_16x16x32_bf16 v[72:75], v[48:51], v[232:235], v[72:75]
    v_mfma_f32_16x16x32_bf16 v[88:91], v[52:55], v[232:235], v[88:91]
    v_mfma_f32_16x16x32_bf16 v[76:79], v[48:51], v[236:239], v[76:79]
    v_mfma_f32_16x16x32_bf16 v[92:95], v[52:55], v[236:239], v[92:95]
    v_mfma_f32_16x16x32_bf16 v[64:67], v[56:59], v[240:243], v[64:67]
    s_add_u32 m0, s35, 131072
    s_add_u32 s33, s34, 196608
    buffer_load_dwordx4 v1, s[12:15], s33 offen lds
    v_mfma_f32_16x16x32_bf16 v[80:83], v[60:63], v[240:243], v[80:83]
    v_mfma_f32_16x16x32_bf16 v[68:71], v[56:59], v[244:247], v[68:71]
    buffer_load_dwordx4 v2, s[12:15], s33 offen offset:1024 lds
    v_mfma_f32_16x16x32_bf16 v[84:87], v[60:63], v[244:247], v[84:87]
    v_mfma_f32_16x16x32_bf16 v[72:75], v[56:59], v[248:251], v[72:75]
    buffer_load_dwordx4 v3, s[12:15], s33 offen offset:2048 lds
    v_mfma_f32_16x16x32_bf16 v[88:91], v[60:63], v[248:251], v[88:91]
    v_mfma_f32_16x16x32_bf16 v[76:79], v[56:59], v[252:255], v[76:79]
    buffer_load_dwordx4 v4, s[12:15], s33 offen offset:3072 lds
    v_mfma_f32_16x16x32_bf16 v[92:95], v[60:63], v[252:255], v[92:95]
    s_waitcnt vmcnt(8)
    s_waitcnt lgkmcnt(0)
    s_barrier
    v_mfma_f32_16x16x32_bf16 v[96:99], v[32:35], v[128:131], 0
    ds_read_b64_tr_b16 v[48:49], v9 offset:32768
    ds_read_b64_tr_b16 v[50:51], v9 offset:40960
    v_pk_mul_f32 v[20:21], v[64:65], v[64:65]
    v_pk_mul_f32 v[22:23], v[66:67], v[66:67]
    v_pk_fma_f32 v[20:21], v[20:21], s[38:39], v[28:29] op_sel_hi:[1,1,0]
    v_pk_fma_f32 v[22:23], v[22:23], s[38:39], v[28:29] op_sel_hi:[1,1,0]
    v_pk_mul_f32 v[20:21], v[20:21], v[64:65]
    v_mfma_f32_16x16x32_bf16 v[112:115], v[36:39], v[128:131], 0
    ds_read_b64_tr_b16 v[52:53], v10 offset:32768
    ds_read_b64_tr_b16 v[54:55], v10 offset:40960
    v_pk_mul_f32 v[22:23], v[22:23], v[66:67]
    v_exp_f32 v20, v20
    v_exp_f32 v21, v21
    v_exp_f32 v22, v22
    v_exp_f32 v23, v23
    v_mfma_f32_16x16x32_bf16 v[100:103], v[32:35], v[132:135], 0
    ds_read_b64_tr_b16 v[56:57], v9 offset:49152
    ds_read_b64_tr_b16 v[58:59], v9 offset:57344
    v_pk_add_f32 v[20:21], v[20:21], 1.0 op_sel_hi:[1,0]
    v_pk_add_f32 v[22:23], v[22:23], 1.0 op_sel_hi:[1,0]
    v_rcp_f32 v20, v20
    v_rcp_f32 v21, v21
    v_rcp_f32 v22, v22
    v_mfma_f32_16x16x32_bf16 v[116:119], v[36:39], v[132:135], 0
    ds_read_b64_tr_b16 v[60:61], v10 offset:49152
    ds_read_b64_tr_b16 v[62:63], v10 offset:57344
    v_rcp_f32 v23, v23
    v_pk_mul_f32 v[64:65], v[64:65], v[20:21]
    v_pk_mul_f32 v[66:67], v[66:67], v[22:23]
    v_pk_mul_f32 v[20:21], v[68:69], v[68:69]
    v_pk_mul_f32 v[22:23], v[70:71], v[70:71]
    v_mfma_f32_16x16x32_bf16 v[104:107], v[32:35], v[136:139], 0
    v_pk_fma_f32 v[20:21], v[20:21], s[38:39], v[28:29] op_sel_hi:[1,1,0]
    v_pk_fma_f32 v[22:23], v[22:23], s[38:39], v[28:29] op_sel_hi:[1,1,0]
    v_pk_mul_f32 v[20:21], v[20:21], v[68:69]
    v_pk_mul_f32 v[22:23], v[22:23], v[70:71]
    v_exp_f32 v20, v20
    v_mfma_f32_16x16x32_bf16 v[120:123], v[36:39], v[136:139], 0
    v_exp_f32 v21, v21
    v_exp_f32 v22, v22
    v_exp_f32 v23, v23
    v_pk_add_f32 v[20:21], v[20:21], 1.0 op_sel_hi:[1,0]
    v_pk_add_f32 v[22:23], v[22:23], 1.0 op_sel_hi:[1,0]
    v_mfma_f32_16x16x32_bf16 v[108:111], v[32:35], v[140:143], 0
    v_rcp_f32 v20, v20
    v_rcp_f32 v21, v21
    v_rcp_f32 v22, v22
    v_rcp_f32 v23, v23
    v_pk_mul_f32 v[68:69], v[68:69], v[20:21]
    v_mfma_f32_16x16x32_bf16 v[124:127], v[36:39], v[140:143], 0
    v_pk_mul_f32 v[70:71], v[70:71], v[22:23]
    v_pk_mul_f32 v[20:21], v[72:73], v[72:73]
    v_pk_mul_f32 v[22:23], v[74:75], v[74:75]
    v_pk_fma_f32 v[20:21], v[20:21], s[38:39], v[28:29] op_sel_hi:[1,1,0]
    v_pk_fma_f32 v[22:23], v[22:23], s[38:39], v[28:29] op_sel_hi:[1,1,0]
    v_mfma_f32_16x16x32_bf16 v[96:99], v[40:43], v[144:147], v[96:99]
    v_pk_mul_f32 v[20:21], v[20:21], v[72:73]
    v_pk_mul_f32 v[22:23], v[22:23], v[74:75]
    v_exp_f32 v20, v20
    v_exp_f32 v21, v21
    v_exp_f32 v22, v22
    v_mfma_f32_16x16x32_bf16 v[112:115], v[44:47], v[144:147], v[112:115]
    v_exp_f32 v23, v23
    v_pk_add_f32 v[20:21], v[20:21], 1.0 op_sel_hi:[1,0]
    v_pk_add_f32 v[22:23], v[22:23], 1.0 op_sel_hi:[1,0]
    v_rcp_f32 v20, v20
    v_rcp_f32 v21, v21
    v_mfma_f32_16x16x32_bf16 v[100:103], v[40:43], v[148:151], v[100:103]
    v_rcp_f32 v22, v22
    v_rcp_f32 v23, v23
    v_pk_mul_f32 v[72:73], v[72:73], v[20:21]
    v_pk_mul_f32 v[74:75], v[74:75], v[22:23]
    v_pk_mul_f32 v[20:21], v[76:77], v[76:77]
    v_mfma_f32_16x16x32_bf16 v[116:119], v[44:47], v[148:151], v[116:119]
    v_pk_mul_f32 v[22:23], v[78:79], v[78:79]
    v_pk_fma_f32 v[20:21], v[20:21], s[38:39], v[28:29] op_sel_hi:[1,1,0]
    v_pk_fma_f32 v[22:23], v[22:23], s[38:39], v[28:29] op_sel_hi:[1,1,0]
    v_pk_mul_f32 v[20:21], v[20:21], v[76:77]
    v_pk_mul_f32 v[22:23], v[22:23], v[78:79]
    v_mfma_f32_16x16x32_bf16 v[104:107], v[40:43], v[152:155], v[104:107]
    v_exp_f32 v20, v20
    v_exp_f32 v21, v21
    v_exp_f32 v22, v22
    v_exp_f32 v23, v23
    v_pk_add_f32 v[20:21], v[20:21], 1.0 op_sel_hi:[1,0]
    v_mfma_f32_16x16x32_bf16 v[120:123], v[44:47], v[152:155], v[120:123]
    v_pk_add_f32 v[22:23], v[22:23], 1.0 op_sel_hi:[1,0]
    v_rcp_f32 v20, v20
    v_rcp_f32 v21, v21
    v_rcp_f32 v22, v22
    v_rcp_f32 v23, v23
    v_mfma_f32_16x16x32_bf16 v[108:111], v[40:43], v[156:159], v[108:111]
    v_pk_mul_f32 v[76:77], v[76:77], v[20:21]
    v_pk_mul_f32 v[78:79], v[78:79], v[22:23]
    v_pk_mul_f32 v[20:21], v[80:81], v[80:81]
    v_pk_mul_f32 v[22:23], v[82:83], v[82:83]
    v_pk_fma_f32 v[20:21], v[20:21], s[38:39], v[28:29] op_sel_hi:[1,1,0]
    v_mfma_f32_16x16x32_bf16 v[124:127], v[44:47], v[156:159], v[124:127]
    v_pk_fma_f32 v[22:23], v[22:23], s[38:39], v[28:29] op_sel_hi:[1,1,0]
    v_pk_mul_f32 v[20:21], v[20:21], v[80:81]
    v_pk_mul_f32 v[22:23], v[22:23], v[82:83]
    v_exp_f32 v20, v20
    v_exp_f32 v21, v21
    v_exp_f32 v22, v22
    s_waitcnt vmcnt(4)
    s_waitcnt lgkmcnt(0)
    s_barrier
    v_mfma_f32_16x16x32_bf16 v[96:99], v[48:51], v[160:163], v[96:99]
    ds_read_b64_tr_b16 v[32:33], v11
    ds_read_b64_tr_b16 v[34:35], v11 offset:8192
    v_exp_f32 v23, v23
    v_pk_add_f32 v[20:21], v[20:21], 1.0 op_sel_hi:[1,0]
    v_pk_add_f32 v[22:23], v[22:23], 1.0 op_sel_hi:[1,0]
    v_rcp_f32 v20, v20
    v_rcp_f32 v21, v21
    v_rcp_f32 v22, v22
    v_rcp_f32 v23, v23
    v_pk_mul_f32 v[80:81], v[80:81], v[20:21]
    v_mfma_f32_16x16x32_bf16 v[112:115], v[52:55], v[160:163], v[112:115]
    ds_read_b64_tr_b16 v[36:37], v12
    ds_read_b64_tr_b16 v[38:39], v12 offset:8192
    v_pk_mul_f32 v[82:83], v[82:83], v[22:23]
    v_pk_mul_f32 v[20:21], v[84:85], v[84:85]
    v_pk_mul_f32 v[22:23], v[86:87], v[86:87]
    v_pk_fma_f32 v[20:21], v[20:21], s[38:39], v[28:29] op_sel_hi:[1,1,0]
    v_pk_fma_f32 v[22:23], v[22:23], s[38:39], v[28:29] op_sel_hi:[1,1,0]
    v_pk_mul_f32 v[20:21], v[20:21], v[84:85]
    v_pk_mul_f32 v[22:23], v[22:23], v[86:87]
    v_exp_f32 v20, v20
    v_exp_f32 v21, v21
    v_mfma_f32_16x16x32_bf16 v[100:103], v[48:51], v[164:167], v[100:103]
    ds_read_b64_tr_b16 v[40:41], v11 offset:16384
    ds_read_b64_tr_b16 v[42:43], v11 offset:24576
    v_exp_f32 v22, v22
    v_exp_f32 v23, v23
    v_pk_add_f32 v[20:21], v[20:21], 1.0 op_sel_hi:[1,0]
    v_pk_add_f32 v[22:23], v[22:23], 1.0 op_sel_hi:[1,0]
    v_rcp_f32 v20, v20
    v_rcp_f32 v21, v21
    v_rcp_f32 v22, v22
    v_rcp_f32 v23, v23
    v_pk_mul_f32 v[84:85], v[84:85], v[20:21]
    v_mfma_f32_16x16x32_bf16 v[116:119], v[52:55], v[164:167], v[116:119]
    ds_read_b64_tr_b16 v[44:45], v12 offset:16384
    ds_read_b64_tr_b16 v[46:47], v12 offset:24576
    v_pk_mul_f32 v[86:87], v[86:87], v[22:23]
    v_pk_mul_f32 v[20:21], v[88:89], v[88:89]
    v_pk_mul_f32 v[22:23], v[90:91], v[90:91]
    v_pk_fma_f32 v[20:21], v[20:21], s[38:39], v[28:29] op_sel_hi:[1,1,0]
    v_pk_fma_f32 v[22:23], v[22:23], s[38:39], v[28:29] op_sel_hi:[1,1,0]
    v_pk_mul_f32 v[20:21], v[20:21], v[88:89]
    v_pk_mul_f32 v[22:23], v[22:23], v[90:91]
    v_exp_f32 v20, v20
    v_exp_f32 v21, v21
    v_mfma_f32_16x16x32_bf16 v[104:107], v[48:51], v[168:171], v[104:107]
    v_exp_f32 v22, v22
    v_exp_f32 v23, v23
    v_pk_add_f32 v[20:21], v[20:21], 1.0 op_sel_hi:[1,0]
    v_pk_add_f32 v[22:23], v[22:23], 1.0 op_sel_hi:[1,0]
    v_rcp_f32 v20, v20
    v_rcp_f32 v21, v21
    v_rcp_f32 v22, v22
    v_rcp_f32 v23, v23
    v_mfma_f32_16x16x32_bf16 v[120:123], v[52:55], v[168:171], v[120:123]
    v_pk_mul_f32 v[88:89], v[88:89], v[20:21]
    v_pk_mul_f32 v[90:91], v[90:91], v[22:23]
    v_pk_mul_f32 v[20:21], v[92:93], v[92:93]
    v_pk_mul_f32 v[22:23], v[94:95], v[94:95]
    v_pk_fma_f32 v[20:21], v[20:21], s[38:39], v[28:29] op_sel_hi:[1,1,0]
    v_pk_fma_f32 v[22:23], v[22:23], s[38:39], v[28:29] op_sel_hi:[1,1,0]
    v_pk_mul_f32 v[20:21], v[20:21], v[92:93]
    v_pk_mul_f32 v[22:23], v[22:23], v[94:95]
    v_exp_f32 v20, v20
    v_mfma_f32_16x16x32_bf16 v[108:111], v[48:51], v[172:175], v[108:111]
    v_exp_f32 v21, v21
    v_exp_f32 v22, v22
    v_exp_f32 v23, v23
    v_pk_add_f32 v[20:21], v[20:21], 1.0 op_sel_hi:[1,0]
    v_pk_add_f32 v[22:23], v[22:23], 1.0 op_sel_hi:[1,0]
    v_rcp_f32 v20, v20
    v_rcp_f32 v21, v21
    v_rcp_f32 v22, v22
    v_rcp_f32 v23, v23
    v_mfma_f32_16x16x32_bf16 v[124:127], v[52:55], v[172:175], v[124:127]
    v_pk_mul_f32 v[92:93], v[92:93], v[20:21]
    v_pk_mul_f32 v[94:95], v[94:95], v[22:23]
    v_add_f32 v20, v64, v65
    v_mul_f32 v24, v64, v64
    v_fmac_f32 v24, v65, v65
    v_add_f32 v20, v20, v66
    v_fmac_f32 v24, v66, v66
    v_add_f32 v20, v20, v67
    v_fmac_f32 v24, v67, v67
    v_mfma_f32_16x16x32_bf16 v[96:99], v[56:59], v[176:179], v[96:99]
    v_add_f32 v20, v20, v80
    v_fmac_f32 v24, v80, v80
    v_add_f32 v20, v20, v81
    v_fmac_f32 v24, v81, v81
    v_add_f32 v20, v20, v82
    v_fmac_f32 v24, v82, v82
    v_add_f32 v20, v20, v83
    v_fmac_f32 v24, v83, v83
    v_mfma_f32_16x16x32_bf16 v[112:115], v[60:63], v[176:179], v[112:115]
    v_add_f32 v21, v68, v69
    v_mul_f32 v25, v68, v68
    v_fmac_f32 v25, v69, v69
    v_add_f32 v21, v21, v70
    v_fmac_f32 v25, v70, v70
    v_add_f32 v21, v21, v71
    v_fmac_f32 v25, v71, v71
    v_add_f32 v21, v21, v84
    v_fmac_f32 v25, v84, v84
    v_mfma_f32_16x16x32_bf16 v[100:103], v[56:59], v[180:183], v[100:103]
    v_add_f32 v21, v21, v85
    v_fmac_f32 v25, v85, v85
    v_add_f32 v21, v21, v86
    v_fmac_f32 v25, v86, v86
    v_add_f32 v21, v21, v87
    v_fmac_f32 v25, v87, v87
    v_add_f32 v22, v72, v73
    v_mul_f32 v26, v72, v72
    v_fmac_f32 v26, v73, v73
    v_mfma_f32_16x16x32_bf16 v[116:119], v[60:63], v[180:183], v[116:119]
    v_add_f32 v22, v22, v74
    v_fmac_f32 v26, v74, v74
    v_add_f32 v22, v22, v75
    v_fmac_f32 v26, v75, v75
    v_add_f32 v22, v22, v88
    v_fmac_f32 v26, v88, v88
    v_add_f32 v22, v22, v89
    v_fmac_f32 v26, v89, v89
    v_add_f32 v22, v22, v90
    v_mfma_f32_16x16x32_bf16 v[104:107], v[56:59], v[184:187], v[104:107]
    v_fmac_f32 v26, v90, v90
    v_add_f32 v22, v22, v91
    v_fmac_f32 v26, v91, v91
    v_add_f32 v23, v76, v77
    v_mul_f32 v27, v76, v76
    v_fmac_f32 v27, v77, v77
    v_add_f32 v23, v23, v78
    v_fmac_f32 v27, v78, v78
    v_mfma_f32_16x16x32_bf16 v[120:123], v[60:63], v[184:187], v[120:123]
    v_add_f32 v23, v23, v79
    v_fmac_f32 v27, v79, v79
    v_add_f32 v23, v23, v92
    v_fmac_f32 v27, v92, v92
    v_add_f32 v23, v23, v93
    v_fmac_f32 v27, v93, v93
    v_add_f32 v23, v23, v94
    v_fmac_f32 v27, v94, v94
    v_add_f32 v23, v23, v95
    v_mfma_f32_16x16x32_bf16 v[108:111], v[56:59], v[188:191], v[108:111]
    v_fmac_f32 v27, v95, v95
    v_permlane16_swap_b32 v20, v21
    v_permlane16_swap_b32 v22, v23
    v_add_f32 v20, v20, v21
    v_add_f32 v22, v22, v23
    s_nop 1
    v_permlane32_swap_b32 v20, v22
    v_add_f32 v20, v20, v22
    v_permlane16_swap_b32 v24, v25
    v_permlane16_swap_b32 v26, v27
    v_mfma_f32_16x16x32_bf16 v[124:127], v[60:63], v[188:191], v[124:127]
    v_add_f32 v24, v24, v25
    v_add_f32 v26, v26, v27
    s_nop 1
    v_permlane32_swap_b32 v24, v26
    v_add_f32 v24, v24, v26
    v_mov_b32 v21, v24
    v_lshlrev_b32 v29, 3, v0
    s_lshl_b32 s30, s24, 9
    v_add_u32 v22, s30, v29
    ds_write_b64 v22, v[20:21]
    s_waitcnt vmcnt(0)
    s_waitcnt lgkmcnt(0)
    s_barrier
    v_mfma_f32_16x16x32_bf16 v[96:99], v[32:35], v[192:195], v[96:99]
    ds_read_b64_tr_b16 v[48:49], v11 offset:32768
    ds_read_b64_tr_b16 v[50:51], v11 offset:40960
    ds_read_b64 v[2:3], v29
    ds_read_b64 v[4:5], v29 offset:512
    ds_read_b64 v[6:7], v29 offset:1024
    ds_read_b64 v[14:15], v29 offset:1536
    ds_read_b64 v[20:21], v29 offset:2048
    ds_read_b64 v[22:23], v29 offset:2560
    v_mfma_f32_16x16x32_bf16 v[112:115], v[36:39], v[192:195], v[112:115]
    ds_read_b64_tr_b16 v[52:53], v12 offset:32768
    ds_read_b64_tr_b16 v[54:55], v12 offset:40960
    ds_read_b64 v[24:25], v29 offset:3072
    ds_read_b64 v[26:27], v29 offset:3584
    s_waitcnt lgkmcnt(8)
    v_add_f32 v2, v2, v4
    v_add_f32 v3, v3, v5
    s_waitcnt lgkmcnt(7)
    v_add_f32 v2, v2, v6
    v_add_f32 v3, v3, v7
    s_waitcnt lgkmcnt(6)
    v_add_f32 v2, v2, v14
    v_mfma_f32_16x16x32_bf16 v[100:103], v[32:35], v[196:199], v[100:103]
    ds_read_b64_tr_b16 v[56:57], v11 offset:49152
    ds_read_b64_tr_b16 v[58:59], v11 offset:57344
    v_add_f32 v3, v3, v15
    s_waitcnt lgkmcnt(7)
    v_add_f32 v2, v2, v20
    v_add_f32 v3, v3, v21
    s_waitcnt lgkmcnt(6)
    v_add_f32 v2, v2, v22
    v_add_f32 v3, v3, v23
    s_waitcnt lgkmcnt(3)
    v_add_f32 v2, v2, v24
    v_add_f32 v3, v3, v25
    v_mfma_f32_16x16x32_bf16 v[116:119], v[36:39], v[196:199], v[116:119]
    ds_read_b64_tr_b16 v[60:61], v12 offset:49152
    ds_read_b64_tr_b16 v[62:63], v12 offset:57344
    s_waitcnt lgkmcnt(4)
    v_add_f32 v2, v2, v26
    v_add_f32 v3, v3, v27
    v_mul_f32 v2, 0x3b800000, v2
    v_mul_f32 v4, v2, v2
    v_mul_f32 v3, 0x3b800000, v3
    v_sub_f32 v3, v3, v4
    v_max_f32 v3, 0, v3
    v_mfma_f32_16x16x32_bf16 v[104:107], v[32:35], v[200:203], v[104:107]
    v_add_f32 v3, 0x3727c5ac, v3
    v_rsq_f32 v3, v3
    s_nop 0
    v_mul_f32 v2, v2, v3
    v_sub_f32 v2, 0, v2
    v_mov_b32 v20, v2
    v_mov_b32 v21, v2
    s_nop 1
    v_permlane16_swap_b32 v20, v21
    v_mfma_f32_16x16x32_bf16 v[120:123], v[36:39], v[200:203], v[120:123]
    v_mov_b32 v22, v20
    v_mov_b32 v23, v21
    s_nop 0
    v_permlane32_swap_b32 v20, v22
    v_permlane32_swap_b32 v21, v23
    v_mov_b32 v24, v3
    v_mov_b32 v25, v3
    v_mfma_f32_16x16x32_bf16 v[108:111], v[32:35], v[204:207], v[108:111]
    s_nop 0
    v_permlane16_swap_b32 v24, v25
    v_mov_b32 v26, v24
    v_mov_b32 v27, v25
    s_nop 0
    v_permlane32_swap_b32 v24, v26
    v_permlane32_swap_b32 v25, v27
    v_fma_f32 v64, v64, v24, v20
    v_fma_f32 v65, v65, v24, v20
    v_mfma_f32_16x16x32_bf16 v[124:127], v[36:39], v[204:207], v[124:127]
    v_fma_f32 v66, v66, v24, v20
    v_fma_f32 v67, v67, v24, v20
    v_fma_f32 v80, v80, v24, v20
    v_fma_f32 v81, v81, v24, v20
    v_fma_f32 v82, v82, v24, v20
    v_fma_f32 v83, v83, v24, v20
    v_fma_f32 v68, v68, v25, v21
    v_mfma_f32_16x16x32_bf16 v[96:99], v[40:43], v[208:211], v[96:99]
    v_fma_f32 v69, v69, v25, v21
    v_fma_f32 v70, v70, v25, v21
    v_fma_f32 v71, v71, v25, v21
    v_fma_f32 v84, v84, v25, v21
    v_fma_f32 v85, v85, v25, v21
    v_fma_f32 v86, v86, v25, v21
    v_fma_f32 v87, v87, v25, v21
    v_mfma_f32_16x16x32_bf16 v[112:115], v[44:47], v[208:211], v[112:115]
    v_fma_f32 v72, v72, v26, v22
    v_fma_f32 v73, v73, v26, v22
    v_fma_f32 v74, v74, v26, v22
    v_fma_f32 v75, v75, v26, v22
    v_fma_f32 v88, v88, v26, v22
    v_fma_f32 v89, v89, v26, v22
    v_fma_f32 v90, v90, v26, v22
    v_mfma_f32_16x16x32_bf16 v[100:103], v[40:43], v[212:215], v[100:103]
    v_fma_f32 v91, v91, v26, v22
    v_fma_f32 v76, v76, v27, v23
    v_fma_f32 v77, v77, v27, v23
    v_fma_f32 v78, v78, v27, v23
    v_fma_f32 v79, v79, v27, v23
    v_fma_f32 v92, v92, v27, v23
    v_mfma_f32_16x16x32_bf16 v[116:119], v[44:47], v[212:215], v[116:119]
    v_fma_f32 v93, v93, v27, v23
    v_fma_f32 v94, v94, v27, v23
    v_fma_f32 v95, v95, v27, v23
    v_cvt_pk_bf16_f32 v64, v64, v65
    v_cvt_pk_bf16_f32 v65, v66, v67
    v_cvt_pk_bf16_f32 v66, v80, v81
    v_cvt_pk_bf16_f32 v67, v82, v83
    v_mfma_f32_16x16x32_bf16 v[104:107], v[40:43], v[216:219], v[104:107]
    v_cvt_pk_bf16_f32 v68, v68, v69
    v_cvt_pk_bf16_f32 v69, v70, v71
    v_cvt_pk_bf16_f32 v70, v84, v85
    v_cvt_pk_bf16_f32 v71, v86, v87
    v_cvt_pk_bf16_f32 v72, v72, v73
    v_cvt_pk_bf16_f32 v73, v74, v75
    v_cvt_pk_bf16_f32 v74, v88, v89
    v_mfma_f32_16x16x32_bf16 v[120:123], v[44:47], v[216:219], v[120:123]
    v_cvt_pk_bf16_f32 v75, v90, v91
    v_cvt_pk_bf16_f32 v76, v76, v77
    v_cvt_pk_bf16_f32 v77, v78, v79
    v_cvt_pk_bf16_f32 v78, v92, v93
    v_cvt_pk_bf16_f32 v79, v94, v95
    s_mul_i32 s30, s27, 250
    s_lshl_b32 s31, s28, 2
    v_mfma_f32_16x16x32_bf16 v[108:111], v[40:43], v[220:223], v[108:111]
    s_add_u32 s30, s30, s31
    s_lshl_b32 s30, s30, 3
    s_add_u32 s30, s30, s24
    s_lshl_b32 s30, s30, 10
    s_add_u32 s30, s30, 0xc00000
    s_cmp_eq_u32 s36, 0
    s_cselect_b32 s31, s30, 0x7fff0000
    v_mfma_f32_16x16x32_bf16 v[124:127], v[44:47], v[220:223], v[124:127]
    buffer_store_dwordx4 v[64:67], v19, s[20:23], s30 offen sc1
    s_add_u32 s30, s30, 8192
    buffer_store_dwordx4 v[68:71], v19, s[20:23], s30 offen sc1
    s_add_u32 s31, s31, 16384
    buffer_store_dwordx4 v[72:75], v19, s[20:23], s31 offen sc1
    s_add_u32 s31, s31, 8192
    buffer_store_dwordx4 v[76:79], v19, s[20:23], s31 offen sc1
    v_mfma_f32_16x16x32_bf16 v[96:99], v[48:51], v[224:227], v[96:99]
    v_mfma_f32_16x16x32_bf16 v[112:115], v[52:55], v[224:227], v[112:115]
    v_mfma_f32_16x16x32_bf16 v[100:103], v[48:51], v[228:231], v[100:103]
    v_mfma_f32_16x16x32_bf16 v[116:119], v[52:55], v[228:231], v[116:119]
    v_mfma_f32_16x16x32_bf16 v[104:107], v[48:51], v[232:235], v[104:107]
    v_mfma_f32_16x16x32_bf16 v[120:123], v[52:55], v[232:235], v[120:123]
    v_mfma_f32_16x16x32_bf16 v[108:111], v[48:51], v[236:239], v[108:111]
    v_mfma_f32_16x16x32_bf16 v[124:127], v[52:55], v[236:239], v[124:127]
    s_waitcnt lgkmcnt(2)
    v_mfma_f32_16x16x32_bf16 v[96:99], v[56:59], v[240:243], v[96:99]
    s_waitcnt lgkmcnt(0)
    v_mfma_f32_16x16x32_bf16 v[112:115], v[60:63], v[240:243], v[112:115]
    v_mfma_f32_16x16x32_bf16 v[100:103], v[56:59], v[244:247], v[100:103]
    v_mfma_f32_16x16x32_bf16 v[116:119], v[60:63], v[244:247], v[116:119]
    v_mfma_f32_16x16x32_bf16 v[104:107], v[56:59], v[248:251], v[104:107]
    v_mfma_f32_16x16x32_bf16 v[120:123], v[60:63], v[248:251], v[120:123]
    v_mfma_f32_16x16x32_bf16 v[108:111], v[56:59], v[252:255], v[108:111]
    v_mfma_f32_16x16x32_bf16 v[124:127], v[60:63], v[252:255], v[124:127]
    v_cvt_pk_bf16_f32 v96, v96, v97
    v_cvt_pk_bf16_f32 v97, v98, v99
    v_cvt_pk_bf16_f32 v98, v112, v113
    v_cvt_pk_bf16_f32 v99, v114, v115
    v_cvt_pk_bf16_f32 v100, v100, v101
    v_cvt_pk_bf16_f32 v101, v102, v103
    v_cvt_pk_bf16_f32 v102, v116, v117
    v_cvt_pk_bf16_f32 v103, v118, v119
    v_cvt_pk_bf16_f32 v104, v104, v105
    v_cvt_pk_bf16_f32 v105, v106, v107
    v_cvt_pk_bf16_f32 v106, v120, v121
    v_cvt_pk_bf16_f32 v107, v122, v123
    v_cvt_pk_bf16_f32 v108, v108, v109
    v_cvt_pk_bf16_f32 v109, v110, v111
    v_cvt_pk_bf16_f32 v110, v124, v125
    v_cvt_pk_bf16_f32 v111, v126, v127
    s_mul_i32 s30, s27, 250
    s_lshl_b32 s31, s28, 2
    s_add_u32 s30, s30, s31
    s_lshl_b32 s30, s30, 3
    s_add_u32 s30, s30, s24
    s_lshl_b32 s30, s30, 10
    s_add_u32 s30, s30, 0x800000
    s_cmp_eq_u32 s36, 0
    s_cselect_b32 s31, s30, 0x7fff0000
    buffer_store_dwordx4 v[96:99], v19, s[20:23], s30 offen sc1
    s_add_u32 s30, s30, 8192
    buffer_store_dwordx4 v[100:103], v19, s[20:23], s30 offen sc1
    s_add_u32 s31, s31, 16384
    buffer_store_dwordx4 v[104:107], v19, s[20:23], s31 offen sc1
    s_add_u32 s31, s31, 8192
    buffer_store_dwordx4 v[108:111], v19, s[20:23], s31 offen sc1
    s_endpgm
K1_END:
    s_endpgm
.p2align 8
.type k2_kernel,@function
k2_kernel:
    s_cmp_lt_u32 s2, 4
    s_cbranch_scc1 K2_WPREP
    s_sub_u32 s2, s2, 4
    s_cmp_ge_u32 s2, 252
    s_cbranch_scc1 K2_WEND
    s_load_dwordx2 s[4:5], s[0:1], 88
    s_load_dwordx2 s[6:7], s[0:1], 0
    s_load_dwordx2 s[12:13], s[0:1], 72
    v_lshrrev_b32 v9, 6, v0
    s_nop 0
    v_readfirstlane_b32 s30, v9
    v_and_b32 v0, 63, v0
    v_lshlrev_b32 v1, 4, v0
    s_mul_i32 s26, s30, 40960
    s_and_b32 s31, s2, 1
    s_bfe_u32 s32, s2, 0x10001
    s_lshr_b32 s33, s2, 2
    s_mul_i32 s35, s31, 63
    s_add_u32 s35, s35, s33
    s_sub_u32 s34, 3, s32
    s_cmp_ge_u32 s30, s34
    s_cselect_b32 s27, 15, 16
    s_mul_i32 s17, s32, 63
    s_lshl_b32 s34, s30, 4
    s_add_u32 s17, s17, s34
    s_cmp_eq_u32 s30, 3
    s_cselect_b32 s34, s32, 0
    s_sub_u32 s17, s17, s34
    s_mul_i32 s34, s31, 125
    s_add_u32 s17, s17, s34
    s_and_b32 s33, s33, 7
    s_lshl_b32 s33, s33, 1
    s_add_u32 s16, s17, s33
    s_add_u32 s18, s17, s27
    s_lshl_b32 s16, s16, 14
    s_lshl_b32 s17, s17, 14
    s_lshl_b32 s18, s18, 14
    s_mov_b32 s22, 8192
    s_mov_b32 s23, -32768
    s_mov_b32 s24, 40960
    s_add_u32 s29, s26, 40960
    s_waitcnt lgkmcnt(0)
    s_mov_b32 s8, s4
    s_mov_b32 s9, s5
    s_mov_b32 s10, 0x4000000
    s_mov_b32 s11, 0x00020000
    s_mov_b32 s44, s6
    s_mov_b32 s45, s7
    s_mov_b32 s46, 0x3e8000
    s_mov_b32 s47, 0x00020000
    s_mov_b32 s48, s12
    s_mov_b32 s49, s13
    s_mov_b32 s50, 0x3e8000
    s_mov_b32 s51, 0x00020000
    s_mov_b32 s21, 0x1a80000
    s_mov_b32 s67, 0
    s_lshl_b32 s31, s35, 15
    s_lshl_b32 s32, s30, 13
    s_add_u32 s31, s31, s32
    s_add_u32 s31, s31, 0x400000
    s_add_u32 m0, s26, 32768
    s_nop 0
    buffer_load_dwordx4 v1, s[8:11], s31 offen lds
    buffer_load_dwordx4 v1, s[8:11], s31 offen offset:1024 lds
    buffer_load_dwordx4 v1, s[8:11], s31 offen offset:2048 lds
    buffer_load_dwordx4 v1, s[8:11], s31 offen offset:3072 lds
    s_add_u32 s31, s31, 4096
    s_add_u32 m0, s26, 36864
    s_nop 0
    buffer_load_dwordx4 v1, s[8:11], s31 offen lds
    buffer_load_dwordx4 v1, s[8:11], s31 offen offset:1024 lds
    buffer_load_dwordx4 v1, s[8:11], s31 offen offset:2048 lds
    buffer_load_dwordx4 v1, s[8:11], s31 offen offset:3072 lds
    s_add_u32 s31, s31, 4096
    v_accvgpr_write_b32 a0, 0
    v_mov_b32 v128, 0
    v_accvgpr_write_b32 a1, 0
    v_mov_b32 v129, 0
    v_accvgpr_write_b32 a2, 0
    v_mov_b32 v130, 0
    v_accvgpr_write_b32 a3, 0
    v_mov_b32 v131, 0
    v_accvgpr_write_b32 a4, 0
    v_mov_b32 v132, 0
    v_accvgpr_write_b32 a5, 0
    v_mov_b32 v133, 0
    s_add_u32 m0, s26, 0
    s_nop 0
    buffer_load_dwordx4 v1, s[8:11], s16 offen lds
    v_accvgpr_write_b32 a6, 0
    v_mov_b32 v134, 0
    v_accvgpr_write_b32 a7, 0
    v_mov_b32 v135, 0
    v_accvgpr_write_b32 a8, 0
    v_mov_b32 v136, 0
    v_accvgpr_write_b32 a9, 0
    v_mov_b32 v137, 0
    v_accvgpr_write_b32 a10, 0
    v_mov_b32 v138, 0
    v_accvgpr_write_b32 a11, 0
    v_mov_b32 v139, 0
    buffer_load_dwordx4 v1, s[8:11], s16 offen offset:1024 lds
    v_accvgpr_write_b32 a12, 0
    v_mov_b32 v140, 0
    v_accvgpr_write_b32 a13, 0
    v_mov_b32 v141, 0
    v_accvgpr_write_b32 a14, 0
    v_mov_b32 v142, 0
    v_accvgpr_write_b32 a15, 0
    v_mov_b32 v143, 0
    v_accvgpr_write_b32 a16, 0
    v_mov_b32 v144, 0
    v_accvgpr_write_b32 a17, 0
    v_mov_b32 v145, 0
    buffer_load_dwordx4 v1, s[8:11], s16 offen offset:2048 lds
    v_accvgpr_write_b32 a18, 0
    v_mov_b32 v146, 0
    v_accvgpr_write_b32 a19, 0
    v_mov_b32 v147, 0
    v_accvgpr_write_b32 a20, 0
    v_mov_b32 v148, 0
    v_accvgpr_write_b32 a21, 0
    v_mov_b32 v149, 0
    v_accvgpr_write_b32 a22, 0
    v_mov_b32 v150, 0
    v_accvgpr_write_b32 a23, 0
    v_mov_b32 v151, 0
    buffer_load_dwordx4 v1, s[8:11], s16 offen offset:3072 lds
    s_add_u32 s16, s16, 4096
    v_accvgpr_write_b32 a24, 0
    v_mov_b32 v152, 0
    v_accvgpr_write_b32 a25, 0
    v_mov_b32 v153, 0
    v_accvgpr_write_b32 a26, 0
    v_mov_b32 v154, 0
    v_accvgpr_write_b32 a27, 0
    v_mov_b32 v155, 0
    v_accvgpr_write_b32 a28, 0
    v_mov_b32 v156, 0
    v_accvgpr_write_b32 a29, 0
    v_mov_b32 v157, 0
    s_add_u32 m0, s26, 4096
    s_nop 0
    buffer_load_dwordx4 v1, s[8:11], s16 offen lds
    v_accvgpr_write_b32 a30, 0
    v_mov_b32 v158, 0
    v_accvgpr_write_b32 a31, 0
    v_mov_b32 v159, 0
    v_accvgpr_write_b32 a32, 0
    v_mov_b32 v160, 0
    v_accvgpr_write_b32 a33, 0
    v_mov_b32 v161, 0
    v_accvgpr_write_b32 a34, 0
    v_mov_b32 v162, 0
    v_accvgpr_write_b32 a35, 0
    v_mov_b32 v163, 0
    buffer_load_dwordx4 v1, s[8:11], s16 offen offset:1024 lds
    v_accvgpr_write_b32 a36, 0
    v_mov_b32 v164, 0
    v_accvgpr_write_b32 a37, 0
    v_mov_b32 v165, 0
    v_accvgpr_write_b32 a38, 0
    v_mov_b32 v166, 0
    v_accvgpr_write_b32 a39, 0
    v_mov_b32 v167, 0
    v_accvgpr_write_b32 a40, 0
    v_mov_b32 v168, 0
    v_accvgpr_write_b32 a41, 0
    v_mov_b32 v169, 0
    buffer_load_dwordx4 v1, s[8:11], s16 offen offset:2048 lds
    v_accvgpr_write_b32 a42, 0
    v_mov_b32 v170, 0
    v_accvgpr_write_b32 a43, 0
    v_mov_b32 v171, 0
    v_accvgpr_write_b32 a44, 0
    v_mov_b32 v172, 0
    v_accvgpr_write_b32 a45, 0
    v_mov_b32 v173, 0
    v_accvgpr_write_b32 a46, 0
    v_mov_b32 v174, 0
    v_accvgpr_write_b32 a47, 0
    v_mov_b32 v175, 0
    buffer_load_dwordx4 v1, s[8:11], s16 offen offset:3072 lds
    s_add_u32 s16, s16, 4096
    v_accvgpr_write_b32 a48, 0
    v_mov_b32 v176, 0
    v_accvgpr_write_b32 a49, 0
    v_mov_b32 v177, 0
    v_accvgpr_write_b32 a50, 0
    v_mov_b32 v178, 0
    v_accvgpr_write_b32 a51, 0
    v_mov_b32 v179, 0
    v_accvgpr_write_b32 a52, 0
    v_mov_b32 v180, 0
    v_accvgpr_write_b32 a53, 0
    v_mov_b32 v181, 0
    s_add_u32 m0, s26, 8192
    s_nop 0
    buffer_load_dwordx4 v1, s[8:11], s16 offen lds
    v_accvgpr_write_b32 a54, 0
    v_mov_b32 v182, 0
    v_accvgpr_write_b32 a55, 0
    v_mov_b32 v183, 0
    v_accvgpr_write_b32 a56, 0
    v_mov_b32 v184, 0
    v_accvgpr_write_b32 a57, 0
    v_mov_b32 v185, 0
    v_accvgpr_write_b32 a58, 0
    v_mov_b32 v186, 0
    v_accvgpr_write_b32 a59, 0
    v_mov_b32 v187, 0
    buffer_load_dwordx4 v1, s[8:11], s16 offen offset:1024 lds
    v_accvgpr_write_b32 a60, 0
    v_mov_b32 v188, 0
    v_accvgpr_write_b32 a61, 0
    v_mov_b32 v189, 0
    v_accvgpr_write_b32 a62, 0
    v_mov_b32 v190, 0
    v_accvgpr_write_b32 a63, 0
    v_mov_b32 v191, 0
    v_accvgpr_write_b32 a64, 0
    v_mov_b32 v192, 0
    v_accvgpr_write_b32 a65, 0
    v_mov_b32 v193, 0
    buffer_load_dwordx4 v1, s[8:11], s16 offen offset:2048 lds
    v_accvgpr_write_b32 a66, 0
    v_mov_b32 v194, 0
    v_accvgpr_write_b32 a67, 0
    v_mov_b32 v195, 0
    v_accvgpr_write_b32 a68, 0
    v_mov_b32 v196, 0
    v_accvgpr_write_b32 a69, 0
    v_mov_b32 v197, 0
    v_accvgpr_write_b32 a70, 0
    v_mov_b32 v198, 0
    v_accvgpr_write_b32 a71, 0
    v_mov_b32 v199, 0
    buffer_load_dwordx4 v1, s[8:11], s16 offen offset:3072 lds
    s_add_u32 s16, s16, 4096
    v_accvgpr_write_b32 a72, 0
    v_mov_b32 v200, 0
    v_accvgpr_write_b32 a73, 0
    v_mov_b32 v201, 0
    v_accvgpr_write_b32 a74, 0
    v_mov_b32 v202, 0
    v_accvgpr_write_b32 a75, 0
    v_mov_b32 v203, 0
    v_accvgpr_write_b32 a76, 0
    v_mov_b32 v204, 0
    v_accvgpr_write_b32 a77, 0
    v_mov_b32 v205, 0
    s_add_u32 m0, s26, 12288
    s_nop 0
    buffer_load_dwordx4 v1, s[8:11], s16 offen lds
    v_accvgpr_write_b32 a78, 0
    v_mov_b32 v206, 0
    v_accvgpr_write_b32 a79, 0
    v_mov_b32 v207, 0
    v_accvgpr_write_b32 a80, 0
    v_mov_b32 v208, 0
    v_accvgpr_write_b32 a81, 0
    v_mov_b32 v209, 0
    v_accvgpr_write_b32 a82, 0
    v_mov_b32 v210, 0
    v_accvgpr_write_b32 a83, 0
    v_mov_b32 v211, 0
    buffer_load_dwordx4 v1, s[8:11], s16 offen offset:1024 lds
    v_accvgpr_write_b32 a84, 0
    v_mov_b32 v212, 0
    v_accvgpr_write_b32 a85, 0
    v_mov_b32 v213, 0
    v_accvgpr_write_b32 a86, 0
    v_mov_b32 v214, 0
    v_accvgpr_write_b32 a87, 0
    v_mov_b32 v215, 0
    v_accvgpr_write_b32 a88, 0
    v_mov_b32 v216, 0
    v_accvgpr_write_b32 a89, 0
    v_mov_b32 v217, 0
    buffer_load_dwordx4 v1, s[8:11], s16 offen offset:2048 lds
    v_accvgpr_write_b32 a90, 0
    v_mov_b32 v218, 0
    v_accvgpr_write_b32 a91, 0
    v_mov_b32 v219, 0
    v_accvgpr_write_b32 a92, 0
    v_mov_b32 v220, 0
    v_accvgpr_write_b32 a93, 0
    v_mov_b32 v221, 0
    v_accvgpr_write_b32 a94, 0
    v_mov_b32 v222, 0
    v_accvgpr_write_b32 a95, 0
    v_mov_b32 v223, 0
    buffer_load_dwordx4 v1, s[8:11], s16 offen offset:3072 lds
    s_add_u32 s16, s16, 4096
    s_cmp_eq_u32 s16, s18
    s_cselect_b32 s16, s17, s16
    s_lshr_b32 s31, s2, 3
    s_lshl_b32 s31, s31, 2
    s_add_u32 s31, s31, s30
    s_lshl_b32 s31, s31, 13
    v_lshlrev_b32 v8, 7, v0
    s_getpc_b64 s[68:69]
K2_PC:
    s_add_u32 s68, s68, K2_LOOP-K2_PC
    s_addc_u32 s69, s69, 0
    s_mov_b32 s70, K2_CODE_END-K2_LOOP
    s_mov_b32 s71, 0x00020000
    buffer_load_dword v63, v8, s[68:71], s31 offen
    s_and_b32 s37, s2, 1
    s_bfe_u32 s36, s2, 0x10001
    s_lshr_b32 s38, s2, 2
    s_lshl_b32 s92, s38, 2
    s_lshl_b32 s93, s36, 1
    s_add_u32 s92, s92, s93
    s_mul_i32 s94, s37, 250
    s_lshl_b32 s95, s30, 11
    s_add_u32 s76, s92, s94
    s_lshl_b32 s76, s76, 13
    s_add_u32 s76, s76, s95
    s_add_u32 s76, s76, 0x800000
    s_add_u32 s93, s92, 0
    s_sub_u32 s93, s93, 1
    s_add_u32 s72, s93, s94
    s_lshl_b32 s72, s72, 13
    s_add_u32 s72, s72, s95
    s_add_u32 s72, s72, 0xc00000
    s_cmp_lt_u32 s93, 250
    s_cselect_b32 s72, s72, 0x7fff0000
    s_add_u32 s93, s92, 1
    s_sub_u32 s93, s93, 1
    s_add_u32 s73, s93, s94
    s_lshl_b32 s73, s73, 13
    s_add_u32 s73, s73, s95
    s_add_u32 s73, s73, 0xc00000
    s_cmp_lt_u32 s93, 250
    s_cselect_b32 s73, s73, 0x7fff0000
    s_add_u32 s93, s92, 2
    s_sub_u32 s93, s93, 1
    s_add_u32 s74, s93, s94
    s_lshl_b32 s74, s74, 13
    s_add_u32 s74, s74, s95
    s_add_u32 s74, s74, 0xc00000
    s_cmp_lt_u32 s93, 250
    s_cselect_b32 s74, s74, 0x7fff0000
    s_add_u32 s93, s92, 3
    s_sub_u32 s93, s93, 1
    s_add_u32 s75, s93, s94
    s_lshl_b32 s75, s75, 13
    s_add_u32 s75, s75, s95
    s_add_u32 s75, s75, 0xc00000
    s_cmp_lt_u32 s93, 250
    s_cselect_b32 s75, s75, 0x7fff0000
    s_lshl_b32 s92, s38, 6
    s_lshl_b32 s93, s36, 5
    s_add_u32 s92, s92, s93
    s_mul_i32 s93, s37, 4000
    s_add_u32 s93, s93, s92
    s_lshl_b32 s93, s93, 9
    s_lshl_b32 s94, s30, 7
    s_add_u32 s77, s93, s94
    s_cmp_lt_u32 s92, 4000
    s_cselect_b32 s77, s77, 0x7fff0000
    s_add_u32 s78, s77, 8192
    s_lshl_b32 s92, s30, 15
    s_add_u32 s79, s92, 0x1000000
    s_add_u32 s81, s92, 0x1040000
    s_lshl_b32 s80, s30, 8
    s_add_u32 s80, s80, 0x1a90000
    s_lshr_b32 s92, s2, 3
    s_lshl_b32 s92, s92, 2
    s_add_u32 s92, s92, s30
    s_lshl_b32 s92, s92, 10
    s_add_u32 s82, s92, 0x1040000
    s_add_u32 s83, s92, 0x1000000
    s_xor_b32 s92, s2, 2
    s_mul_i32 s92, s92, 17408
    s_add_u32 s92, s92, 0x1100000
    s_mul_i32 s93, s2, 17408
    s_add_u32 s93, s93, 0x1100000
    s_lshl_b32 s94, s30, 12
    s_add_u32 s84, s92, s94
    s_add_u32 s86, s93, s94
    s_add_u32 s85, s92, 16384
    s_cmp_eq_u32 s30, 0
    s_cselect_b32 s85, s85, 0x7fff0000
    s_add_u32 s87, s93, 16384
    s_lshl_b32 s92, s30, 13
    s_lshl_b32 s93, s36, 11
    s_add_u32 s88, s92, s93
    s_sub_u32 s89, s92, s93
    s_cmp_eq_u32 s36, 0
    s_cselect_b64 s[90:91], 0, -1
    v_lshrrev_b32 v9, 4, v0
    v_and_b32 v10, 1, v9
    v_mul_u32_u24 v10, 12, v10
    v_and_b32 v11, 15, v0
    v_xor_b32 v10, v10, v11
    v_lshlrev_b32 v10, 4, v10
    v_lshl_add_u32 v2, v9, 9, v10
    v_add_u32 v2, s26, v2
    v_bfe_u32 v10, v0, 2, 2
    v_bfe_u32 v11, v0, 1, 1
    v_and_b32 v12, 1, v0
    v_lshl_add_u32 v10, v9, 2, v10
    v_mul_u32_u24 v9, 12, v11
    v_xor_b32 v10, v10, v9
    v_lshlrev_b32 v10, 4, v10
    v_lshl_add_u32 v3, v11, 9, v10
    v_lshl_add_u32 v3, v12, 3, v3
    v_add_u32 v3, s26, v3
    v_accvgpr_write_b32 a96, 0
    v_mov_b32 v224, 0
    v_accvgpr_write_b32 a97, 0
    v_mov_b32 v225, 0
    v_accvgpr_write_b32 a98, 0
    v_mov_b32 v226, 0
    v_accvgpr_write_b32 a99, 0
    v_mov_b32 v227, 0
    v_accvgpr_write_b32 a100, 0
    v_mov_b32 v228, 0
    v_accvgpr_write_b32 a101, 0
    v_mov_b32 v229, 0
    v_accvgpr_write_b32 a102, 0
    v_mov_b32 v230, 0
    v_accvgpr_write_b32 a103, 0
    v_mov_b32 v231, 0
    v_accvgpr_write_b32 a104, 0
    v_mov_b32 v232, 0
    v_accvgpr_write_b32 a105, 0
    v_mov_b32 v233, 0
    v_accvgpr_write_b32 a106, 0
    v_mov_b32 v234, 0
    v_accvgpr_write_b32 a107, 0
    v_mov_b32 v235, 0
    v_accvgpr_write_b32 a108, 0
    v_mov_b32 v236, 0
    v_accvgpr_write_b32 a109, 0
    v_mov_b32 v237, 0
    v_accvgpr_write_b32 a110, 0
    v_mov_b32 v238, 0
    v_accvgpr_write_b32 a111, 0
    v_mov_b32 v239, 0
    v_accvgpr_write_b32 a112, 0
    v_mov_b32 v240, 0
    v_accvgpr_write_b32 a113, 0
    v_mov_b32 v241, 0
    v_accvgpr_write_b32 a114, 0
    v_mov_b32 v242, 0
    v_accvgpr_write_b32 a115, 0
    v_mov_b32 v243, 0
    v_accvgpr_write_b32 a116, 0
    v_mov_b32 v244, 0
    v_accvgpr_write_b32 a117, 0
    v_mov_b32 v245, 0
    v_accvgpr_write_b32 a118, 0
    v_mov_b32 v246, 0
    v_accvgpr_write_b32 a119, 0
    v_mov_b32 v247, 0
    v_accvgpr_write_b32 a120, 0
    v_mov_b32 v248, 0
    v_accvgpr_write_b32 a121, 0
    v_mov_b32 v249, 0
    v_accvgpr_write_b32 a122, 0
    v_mov_b32 v250, 0
    v_accvgpr_write_b32 a123, 0
    v_mov_b32 v251, 0
    v_accvgpr_write_b32 a124, 0
    v_mov_b32 v252, 0
    v_accvgpr_write_b32 a125, 0
    v_mov_b32 v253, 0
    v_accvgpr_write_b32 a126, 0
    v_mov_b32 v254, 0
    v_accvgpr_write_b32 a127, 0
    v_mov_b32 v255, 0
    v_mov_b32 v4, 0
    v_mov_b32 v5, 0
    v_mov_b32 v6, 0
    v_mov_b32 v7, 0
    v_add_u32 v15, 8192, v2
    v_add_u32 v13, 32768, v1
    v_add_u32 v14, 114688, v1
    s_waitcnt vmcnt(17)
    s_barrier
    ds_read_b128 a[128:131], v13
    ds_read_b128 a[132:135], v13 offset:1024
    ds_read_b128 a[136:139], v13 offset:2048
    ds_read_b128 a[140:143], v13 offset:3072
    ds_read_b128 a[144:147], v13 offset:4096
    ds_read_b128 a[148:151], v13 offset:5120
    ds_read_b128 a[152:155], v13 offset:6144
    ds_read_b128 a[156:159], v13 offset:7168
    s_waitcnt vmcnt(9)
    ds_read_b128 v[32:35], v2
    ds_read_b128 v[36:39], v2 offset:256
    ds_read_b128 v[40:43], v2 offset:2048
    ds_read_b128 a[160:163], v13 offset:40960
    ds_read_b128 a[164:167], v13 offset:41984
    ds_read_b128 a[168:171], v13 offset:43008
    ds_read_b128 a[172:175], v13 offset:44032
    s_waitcnt lgkmcnt(12)
    ds_read_b128 v[44:47], v2 offset:2304
    s_waitcnt lgkmcnt(7)
    v_mfma_f32_16x16x32_bf16 v[64:67], v[32:35], a[128:131], 0
    v_mfma_f32_16x16x32_bf16 v[68:71], v[32:35], a[132:135], 0
    s_add_u32 m0, s26, 16384
    s_nop 0
    buffer_load_dwordx4 v1, s[8:11], s16 offen lds
    v_mfma_f32_16x16x32_bf16 v[72:75], v[32:35], a[136:139], 0
    v_mfma_f32_16x16x32_bf16 v[76:79], v[32:35], a[140:143], 0
    ds_read_b128 v[32:35], v2 offset:4096
    s_waitcnt lgkmcnt(7)
    v_mfma_f32_16x16x32_bf16 v[80:83], v[36:39], a[128:131], 0
    v_mfma_f32_16x16x32_bf16 v[84:87], v[36:39], a[132:135], 0
    buffer_load_dwordx4 v1, s[8:11], s16 offen offset:1024 lds
    v_mfma_f32_16x16x32_bf16 v[88:91], v[36:39], a[136:139], 0
    v_mfma_f32_16x16x32_bf16 v[92:95], v[36:39], a[140:143], 0
    ds_read_b128 a[176:179], v13 offset:45056
    ds_read_b128 a[180:183], v13 offset:46080
    ds_read_b128 a[184:187], v13 offset:47104
    ds_read_b128 a[188:191], v13 offset:48128
    ds_read_b128 v[36:39], v2 offset:4352
    s_waitcnt lgkmcnt(11)
    v_mfma_f32_16x16x32_bf16 v[64:67], v[40:43], a[144:147], v[64:67]
    v_mfma_f32_16x16x32_bf16 v[68:71], v[40:43], a[148:151], v[68:71]
    buffer_load_dwordx4 v1, s[8:11], s16 offen offset:2048 lds
    v_mfma_f32_16x16x32_bf16 v[72:75], v[40:43], a[152:155], v[72:75]
    v_mfma_f32_16x16x32_bf16 v[76:79], v[40:43], a[156:159], v[76:79]
    ds_read_b128 v[40:43], v2 offset:6144
    s_waitcnt lgkmcnt(7)
    v_mfma_f32_16x16x32_bf16 v[80:83], v[44:47], a[144:147], v[80:83]
    v_mfma_f32_16x16x32_bf16 v[84:87], v[44:47], a[148:151], v[84:87]
    buffer_load_dwordx4 v1, s[8:11], s16 offen offset:3072 lds
    s_add_u32 s16, s16, 4096
    v_mfma_f32_16x16x32_bf16 v[88:91], v[44:47], a[152:155], v[88:91]
    v_mfma_f32_16x16x32_bf16 v[92:95], v[44:47], a[156:159], v[92:95]
    ds_read_b128 a[192:195], v14
    ds_read_b128 a[196:199], v14 offset:1024
    ds_read_b128 a[200:203], v14 offset:2048
    ds_read_b128 a[204:207], v14 offset:3072
    ds_read_b128 v[44:47], v2 offset:6400
    s_waitcnt lgkmcnt(11)
    v_mfma_f32_16x16x32_bf16 v[64:67], v[32:35], a[160:163], v[64:67]
    v_mfma_f32_16x16x32_bf16 v[68:71], v[32:35], a[164:167], v[68:71]
    s_add_u32 m0, s26, 20480
    s_nop 0
    buffer_load_dwordx4 v1, s[8:11], s16 offen lds
    v_mfma_f32_16x16x32_bf16 v[72:75], v[32:35], a[168:171], v[72:75]
    v_mfma_f32_16x16x32_bf16 v[76:79], v[32:35], a[172:175], v[76:79]
    s_waitcnt vmcnt(6)
    ds_read_b128 v[32:35], v15
    s_waitcnt lgkmcnt(7)
    v_mfma_f32_16x16x32_bf16 v[80:83], v[36:39], a[160:163], v[80:83]
    v_mfma_f32_16x16x32_bf16 v[84:87], v[36:39], a[164:167], v[84:87]
    buffer_load_dwordx4 v1, s[8:11], s16 offen offset:1024 lds
    v_mfma_f32_16x16x32_bf16 v[88:91], v[36:39], a[168:171], v[88:91]
    v_mfma_f32_16x16x32_bf16 v[92:95], v[36:39], a[172:175], v[92:95]
    ds_read_b128 a[208:211], v14 offset:4096
    ds_read_b128 a[212:215], v14 offset:5120
    ds_read_b128 a[216:219], v14 offset:6144
    ds_read_b128 a[220:223], v14 offset:7168
    ds_read_b128 v[36:39], v15 offset:256
    s_waitcnt lgkmcnt(11)
    v_mfma_f32_16x16x32_bf16 v[64:67], v[40:43], a[176:179], v[64:67]
    v_mfma_f32_16x16x32_bf16 v[68:71], v[40:43], a[180:183], v[68:71]
    buffer_load_dwordx4 v1, s[8:11], s16 offen offset:2048 lds
    v_mfma_f32_16x16x32_bf16 v[72:75], v[40:43], a[184:187], v[72:75]
    v_mfma_f32_16x16x32_bf16 v[76:79], v[40:43], a[188:191], v[76:79]
    ds_read_b128 v[40:43], v15 offset:2048
    s_waitcnt lgkmcnt(7)
    v_mfma_f32_16x16x32_bf16 v[80:83], v[44:47], a[176:179], v[80:83]
    v_mfma_f32_16x16x32_bf16 v[84:87], v[44:47], a[180:183], v[84:87]
    buffer_load_dwordx4 v1, s[8:11], s16 offen offset:3072 lds
    s_add_u32 s16, s16, 4096
    v_mfma_f32_16x16x32_bf16 v[88:91], v[44:47], a[184:187], v[88:91]
    v_mfma_f32_16x16x32_bf16 v[92:95], v[44:47], a[188:191], v[92:95]
    ds_read_b128 a[224:227], v14 offset:40960
    ds_read_b128 a[228:231], v14 offset:41984
    ds_read_b128 a[232:235], v14 offset:43008
    ds_read_b128 a[236:239], v14 offset:44032
    ds_read_b128 v[44:47], v15 offset:2304
    s_waitcnt lgkmcnt(11)
    v_mfma_f32_16x16x32_bf16 v[64:67], v[32:35], a[192:195], v[64:67]
    v_mfma_f32_16x16x32_bf16 v[68:71], v[32:35], a[196:199], v[68:71]
    s_add_u32 m0, s26, 24576
    s_nop 0
    buffer_load_dwordx4 v1, s[8:11], s16 offen lds
    v_mfma_f32_16x16x32_bf16 v[72:75], v[32:35], a[200:203], v[72:75]
    v_mfma_f32_16x16x32_bf16 v[76:79], v[32:35], a[204:207], v[76:79]
    ds_read_b128 v[32:35], v15 offset:4096
    s_waitcnt lgkmcnt(7)
    v_mfma_f32_16x16x32_bf16 v[80:83], v[36:39], a[192:195], v[80:83]
    v_mfma_f32_16x16x32_bf16 v[84:87], v[36:39], a[196:199], v[84:87]
    buffer_load_dwordx4 v1, s[8:11], s16 offen offset:1024 lds
    v_mfma_f32_16x16x32_bf16 v[88:91], v[36:39], a[200:203], v[88:91]
    v_mfma_f32_16x16x32_bf16 v[92:95], v[36:39], a[204:207], v[92:95]
    ds_read_b128 a[240:243], v14 offset:45056
    ds_read_b128 a[244:247], v14 offset:46080
    ds_read_b128 a[248:251], v14 offset:47104
    ds_read_b128 a[252:255], v14 offset:48128
    ds_read_b128 v[36:39], v15 offset:4352
    s_waitcnt lgkmcnt(11)
    v_mfma_f32_16x16x32_bf16 v[64:67], v[40:43], a[208:211], v[64:67]
    v_mfma_f32_16x16x32_bf16 v[68:71], v[40:43], a[212:215], v[68:71]
    buffer_load_dwordx4 v1, s[8:11], s16 offen offset:2048 lds
    v_mfma_f32_16x16x32_bf16 v[72:75], v[40:43], a[216:219], v[72:75]
    v_mfma_f32_16x16x32_bf16 v[76:79], v[40:43], a[220:223], v[76:79]
    ds_read_b128 v[40:43], v15 offset:6144
    s_waitcnt lgkmcnt(7)
    v_mfma_f32_16x16x32_bf16 v[80:83], v[44:47], a[208:211], v[80:83]
    v_mfma_f32_16x16x32_bf16 v[84:87], v[44:47], a[212:215], v[84:87]
    buffer_load_dwordx4 v1, s[8:11], s16 offen offset:3072 lds
    s_add_u32 s16, s16, 4096
    v_mfma_f32_16x16x32_bf16 v[88:91], v[44:47], a[216:219], v[88:91]
    v_mfma_f32_16x16x32_bf16 v[92:95], v[44:47], a[220:223], v[92:95]
    ds_read_b128 v[44:47], v15 offset:6400
    s_waitcnt lgkmcnt(7)
    v_mfma_f32_16x16x32_bf16 v[64:67], v[32:35], a[224:227], v[64:67]
    v_mfma_f32_16x16x32_bf16 v[68:71], v[32:35], a[228:231], v[68:71]
    s_add_u32 m0, s26, 28672
    s_nop 0
    buffer_load_dwordx4 v1, s[8:11], s16 offen lds
    v_mfma_f32_16x16x32_bf16 v[72:75], v[32:35], a[232:235], v[72:75]
    v_mfma_f32_16x16x32_bf16 v[76:79], v[32:35], a[236:239], v[76:79]
    s_waitcnt lgkmcnt(0)
    s_barrier
    v_mfma_f32_16x16x32_bf16 v[80:83], v[36:39], a[224:227], v[80:83]
    v_mfma_f32_16x16x32_bf16 v[84:87], v[36:39], a[228:231], v[84:87]
    buffer_load_dwordx4 v1, s[8:11], s16 offen offset:1024 lds
    v_mfma_f32_16x16x32_bf16 v[88:91], v[36:39], a[232:235], v[88:91]
    v_mfma_f32_16x16x32_bf16 v[92:95], v[36:39], a[236:239], v[92:95]
    v_mfma_f32_16x16x32_bf16 v[64:67], v[40:43], a[240:243], v[64:67]
    v_mfma_f32_16x16x32_bf16 v[68:71], v[40:43], a[244:247], v[68:71]
    buffer_load_dwordx4 v1, s[8:11], s16 offen offset:2048 lds
    v_mfma_f32_16x16x32_bf16 v[72:75], v[40:43], a[248:251], v[72:75]
    v_mfma_f32_16x16x32_bf16 v[76:79], v[40:43], a[252:255], v[76:79]
    v_mfma_f32_16x16x32_bf16 v[80:83], v[44:47], a[240:243], v[80:83]
    v_mfma_f32_16x16x32_bf16 v[84:87], v[44:47], a[244:247], v[84:87]
    buffer_load_dwordx4 v1, s[8:11], s16 offen offset:3072 lds
    s_add_u32 s16, s16, 4096
    s_cmp_eq_u32 s16, s18
    s_cselect_b32 s16, s17, s16
    s_add_u32 m0, s26, 32768
    v_mfma_f32_16x16x32_bf16 v[88:91], v[44:47], a[248:251], v[88:91]
    v_mfma_f32_16x16x32_bf16 v[92:95], v[44:47], a[252:255], v[92:95]
    v_max3_f32 v9, v64, v65, v66
    v_max3_f32 v9, v9, v67, v80
    v_max3_f32 v9, v9, v81, v82
    v_max_f32 v9, v9, v83
    v_max3_f32 v10, v68, v69, v70
    v_max3_f32 v10, v10, v71, v84
    v_max3_f32 v10, v10, v85, v86
    v_max_f32 v10, v10, v87
    v_max3_f32 v11, v72, v73, v74
    v_max3_f32 v11, v11, v75, v88
    v_max3_f32 v11, v11, v89, v90
    v_max_f32 v11, v11, v91
    v_max3_f32 v12, v76, v77, v78
    v_max3_f32 v12, v12, v79, v92
    v_max3_f32 v12, v12, v93, v94
    v_max_f32 v12, v12, v95
    v_mov_b32 v13, v9
    s_nop 1
    v_permlane16_swap_b32 v13, v9
    v_max_f32 v9, v9, v13
    v_mov_b32 v13, v9
    s_nop 1
    v_permlane32_swap_b32 v13, v9
    v_max_f32 v9, v9, v13
    v_mov_b32 v13, v10
    s_nop 1
    v_permlane16_swap_b32 v13, v10
    v_max_f32 v10, v10, v13
    v_mov_b32 v13, v10
    s_nop 1
    v_permlane32_swap_b32 v13, v10
    v_max_f32 v10, v10, v13
    v_mov_b32 v13, v11
    s_nop 1
    v_permlane16_swap_b32 v13, v11
    v_max_f32 v11, v11, v13
    v_mov_b32 v13, v11
    s_nop 1
    v_permlane32_swap_b32 v13, v11
    v_max_f32 v11, v11, v13
    v_mov_b32 v13, v12
    s_nop 1
    v_permlane16_swap_b32 v13, v12
    v_max_f32 v12, v12, v13
    v_mov_b32 v13, v12
    s_nop 1
    v_permlane32_swap_b32 v13, v12
    v_max_f32 v12, v12, v13
    v_mov_b32 v48, v9
    v_mov_b32 v49, v10
    v_mov_b32 v50, v11
    v_mov_b32 v51, v12
    v_add_u32 v14, s26, v1
    ds_write_b128 v14, v[48:51] offset:32768
    s_waitcnt lgkmcnt(0)
    s_barrier
    v_add_u32 v14, 32768, v1
    ds_read_b128 v[48:51], v14
    v_add_u32 v14, 40960, v14
    ds_read_b128 v[52:55], v14
    v_add_u32 v14, 40960, v14
    ds_read_b128 v[56:59], v14
    v_add_u32 v14, 40960, v14
    s_waitcnt vmcnt(16)
    ds_read_b128 v[60:63], v14
    s_waitcnt lgkmcnt(1)
    v_max3_f32 v9, v48, v52, v56
    s_waitcnt lgkmcnt(0)
    v_max_f32 v9, v9, v60
    v_add_f32 v9, 0x42200000, v9
    v_max3_f32 v10, v49, v53, v57
    v_max_f32 v10, v10, v61
    v_add_f32 v10, 0x42200000, v10
    v_max3_f32 v11, v50, v54, v58
    v_max_f32 v11, v11, v62
    v_add_f32 v11, 0x42200000, v11
    v_max3_f32 v12, v51, v55, v59
    v_max_f32 v12, v12, v63
    v_add_f32 v12, 0x42200000, v12
    v_sub_f32 v16, 0, v9
    v_sub_f32 v17, 0, v9
    v_sub_f32 v18, 0, v9
    v_sub_f32 v19, 0, v9
    v_sub_f32 v64, v64, v9
    v_sub_f32 v65, v65, v9
    v_sub_f32 v66, v66, v9
    v_sub_f32 v67, v67, v9
    v_sub_f32 v80, v80, v9
    v_sub_f32 v81, v81, v9
    v_sub_f32 v82, v82, v9
    v_sub_f32 v83, v83, v9
    v_sub_f32 v20, 0, v10
    v_sub_f32 v21, 0, v10
    v_sub_f32 v22, 0, v10
    v_sub_f32 v23, 0, v10
    v_sub_f32 v68, v68, v10
    v_sub_f32 v69, v69, v10
    v_sub_f32 v70, v70, v10
    v_sub_f32 v71, v71, v10
    v_sub_f32 v84, v84, v10
    v_sub_f32 v85, v85, v10
    v_sub_f32 v86, v86, v10
    v_sub_f32 v87, v87, v10
    v_sub_f32 v24, 0, v11
    v_sub_f32 v25, 0, v11
    v_sub_f32 v26, 0, v11
    v_sub_f32 v27, 0, v11
    v_sub_f32 v72, v72, v11
    v_sub_f32 v73, v73, v11
    v_sub_f32 v74, v74, v11
    v_sub_f32 v75, v75, v11
    v_sub_f32 v88, v88, v11
    v_sub_f32 v89, v89, v11
    v_sub_f32 v90, v90, v11
    v_sub_f32 v91, v91, v11
    v_sub_f32 v28, 0, v12
    v_sub_f32 v29, 0, v12
    v_sub_f32 v30, 0, v12
    v_sub_f32 v31, 0, v12
    v_sub_f32 v76, v76, v12
    v_sub_f32 v77, v77, v12
    v_sub_f32 v78, v78, v12
    v_sub_f32 v79, v79, v12
    v_sub_f32 v92, v92, v12
    v_sub_f32 v93, v93, v12
    v_sub_f32 v94, v94, v12
    v_sub_f32 v95, v95, v12
    v_exp_f32 v64, v64
    v_exp_f32 v65, v65
    v_exp_f32 v66, v66
    v_exp_f32 v67, v67
    v_exp_f32 v68, v68
    v_exp_f32 v69, v69
    v_exp_f32 v70, v70
    v_exp_f32 v71, v71
    v_exp_f32 v72, v72
    v_exp_f32 v73, v73
    v_exp_f32 v74, v74
    v_exp_f32 v75, v75
    v_exp_f32 v76, v76
    v_exp_f32 v77, v77
    v_exp_f32 v78, v78
    v_exp_f32 v79, v79
    v_exp_f32 v80, v80
    v_exp_f32 v81, v81
    v_exp_f32 v82, v82
    v_exp_f32 v83, v83
    v_exp_f32 v84, v84
    v_exp_f32 v85, v85
    s_mov_b32 s20, 0
    s_mov_b32 s19, 16384
    v_add_u32 v2, 16384, v2
    s_addk_i32 s27, -1
    s_waitcnt vmcnt(8)
    v_mov_b32 v15, 0
    s_barrier
    ds_read_b128 v[32:35], v2
    ds_read_b128 v[36:39], v2 offset:2048
    ds_read_b128 v[40:43], v2 offset:256
    s_waitcnt lgkmcnt(1)
.p2align 6
K2_LOOP:
    v_mfma_f32_16x16x32_bf16 v[96:99], v[32:35], a[128:131], v[16:19]
    ds_read_b128 v[44:47], v2 offset:2304
    v_cvt_pk_bf16_f32 v48, v64, v65
    v_mfma_f32_16x16x32_bf16 v[96:99], v[36:39], a[144:147], v[96:99]
    v_exp_f32 v86, v86
    v_mfma_f32_16x16x32_bf16 v[100:103], v[32:35], a[132:135], v[20:23]
    v_exp_f32 v87, v87
    v_mfma_f32_16x16x32_bf16 v[100:103], v[36:39], a[148:151], v[100:103]
    v_cvt_pk_bf16_f32 v49, v66, v67
    v_or_b32 v8, v48, v49
    v_mfma_f32_16x16x32_bf16 v[104:107], v[32:35], a[136:139], v[24:27]
    v_cvt_pk_bf16_f32 v52, v68, v69
    v_cvt_pk_bf16_f32 v53, v70, v71
    v_mfma_f32_16x16x32_bf16 v[104:107], v[36:39], a[152:155], v[104:107]
    v_exp_f32 v88, v88
    v_mfma_f32_16x16x32_bf16 v[108:111], v[32:35], a[140:143], v[28:31]
    ds_read_b128 v[32:35], v2 offset:4096
    v_or3_b32 v8, v52, v53, v8
    v_mfma_f32_16x16x32_bf16 v[108:111], v[36:39], a[156:159], v[108:111]
    s_waitcnt lgkmcnt(1)
    v_cvt_pk_bf16_f32 v56, v72, v73
    v_cvt_pk_bf16_f32 v57, v74, v75
    v_mfma_f32_16x16x32_bf16 v[112:115], v[40:43], a[128:131], v[16:19]
    ds_read_b128 v[36:39], v2 offset:6144
    v_or3_b32 v8, v56, v57, v8
    v_mfma_f32_16x16x32_bf16 v[112:115], v[44:47], a[144:147], v[112:115]
    v_exp_f32 v89, v89
    v_mfma_f32_16x16x32_bf16 v[116:119], v[40:43], a[132:135], v[20:23]
    v_exp_f32 v90, v90
    v_mfma_f32_16x16x32_bf16 v[116:119], v[44:47], a[148:151], v[116:119]
    v_cvt_pk_bf16_f32 v60, v76, v77
    v_cvt_pk_bf16_f32 v61, v78, v79
    v_mfma_f32_16x16x32_bf16 v[120:123], v[40:43], a[136:139], v[24:27]
    v_or3_b32 v8, v60, v61, v8
    v_cvt_pk_bf16_f32 v50, v80, v81
    v_mfma_f32_16x16x32_bf16 v[120:123], v[44:47], a[152:155], v[120:123]
    v_exp_f32 v91, v91
    v_mfma_f32_16x16x32_bf16 v[124:127], v[40:43], a[140:143], v[28:31]
    ds_read_b128 v[40:43], v2 offset:4352
    v_cvt_pk_bf16_f32 v51, v82, v83
    v_mfma_f32_16x16x32_bf16 v[124:127], v[44:47], a[156:159], v[124:127]
    s_waitcnt lgkmcnt(1)
    v_or3_b32 v8, v50, v51, v8
    v_cvt_pk_bf16_f32 v54, v84, v85
    v_mfma_f32_16x16x32_bf16 v[96:99], v[32:35], a[160:163], v[96:99]
    ds_read_b128 v[44:47], v2 offset:6400
    v_cvt_pk_bf16_f32 v55, v86, v87
    v_mfma_f32_16x16x32_bf16 v[96:99], v[36:39], a[176:179], v[96:99]
    v_exp_f32 v92, v92
    v_mfma_f32_16x16x32_bf16 v[100:103], v[32:35], a[164:167], v[100:103]
    v_exp_f32 v93, v93
    v_mfma_f32_16x16x32_bf16 v[100:103], v[36:39], a[180:183], v[100:103]
    v_or3_b32 v8, v54, v55, v8
    v_cvt_pk_bf16_f32 v58, v88, v89
    v_mfma_f32_16x16x32_bf16 v[104:107], v[32:35], a[168:171], v[104:107]
    v_cvt_pk_bf16_f32 v59, v90, v91
    v_or3_b32 v8, v58, v59, v8
    v_mfma_f32_16x16x32_bf16 v[104:107], v[36:39], a[184:187], v[104:107]
    v_exp_f32 v94, v94
    v_mfma_f32_16x16x32_bf16 v[108:111], v[32:35], a[172:175], v[108:111]
    ds_read_b64_tr_b16 v[32:33], v3
    ds_read_b64_tr_b16 v[34:35], v3 offset:256
    v_mfma_f32_16x16x32_bf16 v[108:111], v[36:39], a[188:191], v[108:111]
    s_waitcnt lgkmcnt(2)
    v_cvt_pk_bf16_f32 v62, v92, v93
    v_mfma_f32_16x16x32_bf16 v[112:115], v[40:43], a[160:163], v[112:115]
    ds_read_b64_tr_b16 v[36:37], v3 offset:1024
    ds_read_b64_tr_b16 v[38:39], v3 offset:1280
    v_mfma_f32_16x16x32_bf16 v[112:115], v[44:47], a[176:179], v[112:115]
    v_exp_f32 v95, v95
    v_mfma_f32_16x16x32_bf16 v[116:119], v[40:43], a[164:167], v[116:119]
    v_cvt_pk_bf16_f32 v63, v94, v95
    v_or3_b32 v8, v62, v63, v8
    v_mfma_f32_16x16x32_bf16 v[116:119], v[44:47], a[180:183], v[116:119]
    v_and_b32 v8, 0x40004000, v8
    v_cmp_ne_u32 vcc, 0, v8
    v_mfma_f32_16x16x32_bf16 v[120:123], v[40:43], a[168:171], v[120:123]
    v_mfma_f32_16x16x32_bf16 v[120:123], v[44:47], a[184:187], v[120:123]
    buffer_load_dwordx4 v1, s[8:11], s16 offen lds
    v_mfma_f32_16x16x32_bf16 v[124:127], v[40:43], a[172:175], v[124:127]
    ds_read_b64_tr_b16 v[40:41], v3 offset:2048
    ds_read_b64_tr_b16 v[42:43], v3 offset:2304
    v_mfma_f32_16x16x32_bf16 v[124:127], v[44:47], a[188:191], v[124:127]
    s_waitcnt lgkmcnt(4)
    s_add_u32 s19, s19, s22
    s_cbranch_vccnz K2_STUB_L0
K2_BACK_L0:
    v_mfma_f32_16x16x32_bf16 a[0:3], v[32:35], v[48:51], a[0:3]
    s_cmp_eq_u32 s19, s24
    ds_read_b64_tr_b16 v[44:45], v3 offset:3072
    ds_read_b64_tr_b16 v[46:47], v3 offset:3328
    v_mfma_f32_16x16x32_bf16 a[4:7], v[32:35], v[52:55], a[4:7]
    s_cselect_b32 s25, s23, s22
    buffer_load_dwordx4 v1, s[8:11], s16 offen offset:1024 lds
    v_mfma_f32_16x16x32_bf16 a[8:11], v[32:35], v[56:59], a[8:11]
    s_cselect_b32 s19, 0, s19
    v_add_f32 v4, v4, v64
    v_mfma_f32_16x16x32_bf16 a[12:15], v[32:35], v[60:63], a[12:15]
    s_waitcnt lgkmcnt(4)
    v_add_f32 v5, v5, v68
    v_mfma_f32_16x16x32_bf16 a[16:19], v[36:39], v[48:51], a[16:19]
    ds_read_b64_tr_b16 v[32:33], v3 offset:4096
    ds_read_b64_tr_b16 v[34:35], v3 offset:4352
    v_mfma_f32_16x16x32_bf16 a[20:23], v[36:39], v[52:55], a[20:23]
    buffer_load_dwordx4 v1, s[8:11], s16 offen offset:2048 lds
    v_mfma_f32_16x16x32_bf16 a[24:27], v[36:39], v[56:59], a[24:27]
    v_add_f32 v6, v6, v72
    v_mfma_f32_16x16x32_bf16 a[28:31], v[36:39], v[60:63], a[28:31]
    s_waitcnt lgkmcnt(4)
    v_add_f32 v7, v7, v76
    v_mfma_f32_16x16x32_bf16 a[32:35], v[40:43], v[48:51], a[32:35]
    ds_read_b64_tr_b16 v[36:37], v3 offset:5120
    ds_read_b64_tr_b16 v[38:39], v3 offset:5376
    v_mfma_f32_16x16x32_bf16 a[36:39], v[40:43], v[52:55], a[36:39]
    buffer_load_dwordx4 v1, s[8:11], s16 offen offset:3072 lds
    v_mfma_f32_16x16x32_bf16 a[40:43], v[40:43], v[56:59], a[40:43]
    s_add_u32 m0, m0, 4096
    v_mfma_f32_16x16x32_bf16 a[44:47], v[40:43], v[60:63], a[44:47]
    s_waitcnt lgkmcnt(4)
    s_add_u32 s16, s16, 4096
    v_add_f32 v4, v4, v65
    v_mfma_f32_16x16x32_bf16 a[48:51], v[44:47], v[48:51], a[48:51]
    ds_read_b64_tr_b16 v[40:41], v3 offset:6144
    ds_read_b64_tr_b16 v[42:43], v3 offset:6400
    v_mfma_f32_16x16x32_bf16 a[52:55], v[44:47], v[52:55], a[52:55]
    buffer_load_dwordx4 v1, s[8:11], s16 offen lds
    v_mfma_f32_16x16x32_bf16 a[56:59], v[44:47], v[56:59], a[56:59]
    v_add_f32 v5, v5, v69
    v_mfma_f32_16x16x32_bf16 a[60:63], v[44:47], v[60:63], a[60:63]
    s_waitcnt lgkmcnt(4)
    v_add_f32 v6, v6, v73
    v_mfma_f32_16x16x32_bf16 a[64:67], v[32:35], v[48:51], a[64:67]
    ds_read_b64_tr_b16 v[44:45], v3 offset:7168
    ds_read_b64_tr_b16 v[46:47], v3 offset:7424
    v_mfma_f32_16x16x32_bf16 a[68:71], v[32:35], v[52:55], a[68:71]
    buffer_load_dwordx4 v1, s[8:11], s16 offen offset:1024 lds
    v_mfma_f32_16x16x32_bf16 a[72:75], v[32:35], v[56:59], a[72:75]
    v_add_f32 v7, v7, v77
    v_mfma_f32_16x16x32_bf16 a[76:79], v[32:35], v[60:63], a[76:79]
    s_waitcnt lgkmcnt(4)
    s_waitcnt vmcnt(6)
    v_add_u32 v2, s25, v2
    v_mfma_f32_16x16x32_bf16 a[80:83], v[36:39], v[48:51], a[80:83]
    ds_read_b128 v[32:35], v2
    v_add_f32 v4, v4, v66
    v_mfma_f32_16x16x32_bf16 a[84:87], v[36:39], v[52:55], a[84:87]
    buffer_load_dwordx4 v1, s[8:11], s16 offen offset:2048 lds
    v_mfma_f32_16x16x32_bf16 a[88:91], v[36:39], v[56:59], a[88:91]
    v_add_f32 v5, v5, v70
    v_mfma_f32_16x16x32_bf16 a[92:95], v[36:39], v[60:63], a[92:95]
    s_waitcnt lgkmcnt(3)
    v_add_f32 v6, v6, v74
    v_mfma_f32_16x16x32_bf16 a[96:99], v[40:43], v[48:51], a[96:99]
    ds_read_b128 v[36:39], v2 offset:2048
    v_add_f32 v7, v7, v78
    v_mfma_f32_16x16x32_bf16 a[100:103], v[40:43], v[52:55], a[100:103]
    buffer_load_dwordx4 v1, s[8:11], s16 offen offset:3072 lds
    v_mfma_f32_16x16x32_bf16 a[104:107], v[40:43], v[56:59], a[104:107]
    s_add_u32 m0, m0, 4096
    v_mfma_f32_16x16x32_bf16 a[108:111], v[40:43], v[60:63], a[108:111]
    s_waitcnt lgkmcnt(2)
    s_cmp_eq_u32 m0, s29
    v_add_f32 v4, v4, v67
    v_mfma_f32_16x16x32_bf16 a[112:115], v[44:47], v[48:51], a[112:115]
    s_cselect_b32 m0, s26, m0
    ds_read_b128 v[40:43], v2 offset:256
    v_add_f32 v5, v5, v71
    v_mfma_f32_16x16x32_bf16 a[116:119], v[44:47], v[52:55], a[116:119]
    s_add_u32 s16, s16, 4096
    v_add_f32 v6, v6, v75
    v_mfma_f32_16x16x32_bf16 a[120:123], v[44:47], v[56:59], a[120:123]
    v_add_f32 v7, v7, v79
    v_mfma_f32_16x16x32_bf16 a[124:127], v[44:47], v[60:63], a[124:127]
    s_waitcnt lgkmcnt(1)
    v_mfma_f32_16x16x32_bf16 v[96:99], v[32:35], a[192:195], v[96:99]
    s_add_u32 s20, s20, s22
    ds_read_b128 v[44:47], v2 offset:2304
    v_add_f32 v4, v4, v80
    v_mfma_f32_16x16x32_bf16 v[96:99], v[36:39], a[208:211], v[96:99]
    s_cmp_eq_u32 s20, s24
    buffer_load_dwordx4 v1, s[8:11], s16 offen lds
    v_mfma_f32_16x16x32_bf16 v[100:103], v[32:35], a[196:199], v[100:103]
    s_cselect_b32 s28, s23, s22
    v_add_f32 v5, v5, v84
    v_mfma_f32_16x16x32_bf16 v[100:103], v[36:39], a[212:215], v[100:103]
    s_cselect_b32 s20, 0, s20
    v_add_f32 v6, v6, v88
    v_mfma_f32_16x16x32_bf16 v[104:107], v[32:35], a[200:203], v[104:107]
    v_add_f32 v7, v7, v92
    v_mfma_f32_16x16x32_bf16 v[104:107], v[36:39], a[216:219], v[104:107]
    buffer_load_dwordx4 v1, s[8:11], s16 offen offset:1024 lds
    v_mfma_f32_16x16x32_bf16 v[108:111], v[32:35], a[204:207], v[108:111]
    ds_read_b128 v[32:35], v2 offset:4096
    v_mfma_f32_16x16x32_bf16 v[108:111], v[36:39], a[220:223], v[108:111]
    s_waitcnt lgkmcnt(1)
    v_add_f32 v4, v4, v81
    v_mfma_f32_16x16x32_bf16 v[112:115], v[40:43], a[192:195], v[112:115]
    ds_read_b128 v[36:39], v2 offset:6144
    v_add_f32 v5, v5, v85
    v_mfma_f32_16x16x32_bf16 v[112:115], v[44:47], a[208:211], v[112:115]
    buffer_load_dwordx4 v1, s[8:11], s16 offen offset:2048 lds
    v_mfma_f32_16x16x32_bf16 v[116:119], v[40:43], a[196:199], v[116:119]
    v_add_f32 v6, v6, v89
    v_mfma_f32_16x16x32_bf16 v[116:119], v[44:47], a[212:215], v[116:119]
    v_add_f32 v7, v7, v93
    v_mfma_f32_16x16x32_bf16 v[120:123], v[40:43], a[200:203], v[120:123]
    v_mfma_f32_16x16x32_bf16 v[120:123], v[44:47], a[216:219], v[120:123]
    buffer_load_dwordx4 v1, s[8:11], s16 offen offset:3072 lds
    v_mfma_f32_16x16x32_bf16 v[124:127], v[40:43], a[204:207], v[124:127]
    s_add_u32 m0, m0, 4096
    ds_read_b128 v[40:43], v2 offset:4352
    v_add_f32 v4, v4, v82
    v_mfma_f32_16x16x32_bf16 v[124:127], v[44:47], a[220:223], v[124:127]
    s_waitcnt lgkmcnt(1)
    s_add_u32 s16, s16, 4096
    v_add_f32 v5, v5, v86
    v_mfma_f32_16x16x32_bf16 v[96:99], v[32:35], a[224:227], v[96:99]
    s_add_u32 s19, s19, s22
    ds_read_b128 v[44:47], v2 offset:6400
    v_add_f32 v6, v6, v90
    v_mfma_f32_16x16x32_bf16 v[96:99], v[36:39], a[240:243], v[96:99]
    s_cmp_eq_u32 s19, s24
    buffer_load_dwordx4 v1, s[8:11], s16 offen lds
    v_mfma_f32_16x16x32_bf16 v[100:103], v[32:35], a[228:231], v[100:103]
    s_cselect_b32 s25, s23, s22
    v_add_f32 v7, v7, v94
    v_mfma_f32_16x16x32_bf16 v[100:103], v[36:39], a[244:247], v[100:103]
    s_cselect_b32 s19, 0, s19
    v_mfma_f32_16x16x32_bf16 v[104:107], v[32:35], a[232:235], v[104:107]
    v_add_f32 v4, v4, v83
    v_add_u32 v3, s28, v3
    v_mfma_f32_16x16x32_bf16 v[104:107], v[36:39], a[248:251], v[104:107]
    buffer_load_dwordx4 v1, s[8:11], s16 offen offset:1024 lds
    v_mfma_f32_16x16x32_bf16 v[108:111], v[32:35], a[236:239], v[108:111]
    ds_read_b64_tr_b16 v[32:33], v3
    ds_read_b64_tr_b16 v[34:35], v3 offset:256
    v_mfma_f32_16x16x32_bf16 v[108:111], v[36:39], a[252:255], v[108:111]
    s_waitcnt lgkmcnt(2)
    v_add_f32 v5, v5, v87
    v_mfma_f32_16x16x32_bf16 v[112:115], v[40:43], a[224:227], v[112:115]
    ds_read_b64_tr_b16 v[36:37], v3 offset:1024
    ds_read_b64_tr_b16 v[38:39], v3 offset:1280
    v_mfma_f32_16x16x32_bf16 v[112:115], v[44:47], a[240:243], v[112:115]
    buffer_load_dwordx4 v1, s[8:11], s16 offen offset:2048 lds
    v_mfma_f32_16x16x32_bf16 v[116:119], v[40:43], a[228:231], v[116:119]
    v_add_f32 v6, v6, v91
    v_mfma_f32_16x16x32_bf16 v[116:119], v[44:47], a[244:247], v[116:119]
    v_add_f32 v7, v7, v95
    v_mfma_f32_16x16x32_bf16 v[120:123], v[40:43], a[232:235], v[120:123]
    v_mfma_f32_16x16x32_bf16 v[120:123], v[44:47], a[248:251], v[120:123]
    buffer_load_dwordx4 v1, s[8:11], s16 offen offset:3072 lds
    v_mfma_f32_16x16x32_bf16 v[124:127], v[40:43], a[236:239], v[124:127]
    s_add_u32 m0, m0, 4096
    ds_read_b64_tr_b16 v[40:41], v3 offset:2048
    ds_read_b64_tr_b16 v[42:43], v3 offset:2304
    v_mfma_f32_16x16x32_bf16 v[124:127], v[44:47], a[252:255], v[124:127]
    s_waitcnt lgkmcnt(4)
    s_cmp_eq_u32 m0, s29
    v_mfma_f32_16x16x32_bf16 v[128:131], v[32:35], v[48:51], v[128:131]
    s_cselect_b32 m0, s26, m0
    ds_read_b64_tr_b16 v[44:45], v3 offset:3072
    ds_read_b64_tr_b16 v[46:47], v3 offset:3328
    v_mfma_f32_16x16x32_bf16 v[132:135], v[32:35], v[52:55], v[132:135]
    s_add_u32 s16, s16, 4096
    v_add_u32 v2, s25, v2
    v_mfma_f32_16x16x32_bf16 v[136:139], v[32:35], v[56:59], v[136:139]
    s_cmp_eq_u32 s16, s18
    v_exp_f32 v96, v96
    v_mfma_f32_16x16x32_bf16 v[140:143], v[32:35], v[60:63], v[140:143]
    s_waitcnt lgkmcnt(4)
    v_exp_f32 v97, v97
    v_mfma_f32_16x16x32_bf16 v[144:147], v[36:39], v[48:51], v[144:147]
    s_cselect_b32 s16, s17, s16
    ds_read_b64_tr_b16 v[32:33], v3 offset:4096
    ds_read_b64_tr_b16 v[34:35], v3 offset:4352
    v_mfma_f32_16x16x32_bf16 v[148:151], v[36:39], v[52:55], v[148:151]
    v_exp_f32 v98, v98
    v_mfma_f32_16x16x32_bf16 v[152:155], v[36:39], v[56:59], v[152:155]
    v_exp_f32 v99, v99
    v_mfma_f32_16x16x32_bf16 v[156:159], v[36:39], v[60:63], v[156:159]
    s_waitcnt lgkmcnt(4)
    v_exp_f32 v100, v100
    v_mfma_f32_16x16x32_bf16 v[160:163], v[40:43], v[48:51], v[160:163]
    ds_read_b64_tr_b16 v[36:37], v3 offset:5120
    ds_read_b64_tr_b16 v[38:39], v3 offset:5376
    v_mfma_f32_16x16x32_bf16 v[164:167], v[40:43], v[52:55], v[164:167]
    v_exp_f32 v101, v101
    v_mfma_f32_16x16x32_bf16 v[168:171], v[40:43], v[56:59], v[168:171]
    v_exp_f32 v102, v102
    v_mfma_f32_16x16x32_bf16 v[172:175], v[40:43], v[60:63], v[172:175]
    s_waitcnt lgkmcnt(4)
    v_exp_f32 v103, v103
    v_mfma_f32_16x16x32_bf16 v[176:179], v[44:47], v[48:51], v[176:179]
    s_add_u32 s20, s20, s22
    ds_read_b64_tr_b16 v[40:41], v3 offset:6144
    ds_read_b64_tr_b16 v[42:43], v3 offset:6400
    v_mfma_f32_16x16x32_bf16 v[180:183], v[44:47], v[52:55], v[180:183]
    s_cmp_eq_u32 s20, s24
    v_exp_f32 v104, v104
    v_mfma_f32_16x16x32_bf16 v[184:187], v[44:47], v[56:59], v[184:187]
    s_cselect_b32 s28, s23, s22
    v_exp_f32 v105, v105
    v_mfma_f32_16x16x32_bf16 v[188:191], v[44:47], v[60:63], v[188:191]
    s_waitcnt lgkmcnt(4)
    v_exp_f32 v106, v106
    v_mfma_f32_16x16x32_bf16 v[192:195], v[32:35], v[48:51], v[192:195]
    s_cselect_b32 s20, 0, s20
    ds_read_b64_tr_b16 v[44:45], v3 offset:7168
    ds_read_b64_tr_b16 v[46:47], v3 offset:7424
    v_mfma_f32_16x16x32_bf16 v[196:199], v[32:35], v[52:55], v[196:199]
    s_addk_i32 s27, -1
    v_exp_f32 v107, v107
    v_mfma_f32_16x16x32_bf16 v[200:203], v[32:35], v[56:59], v[200:203]
    s_cmp_eq_u32 s27, 0
    v_exp_f32 v108, v108
    v_mfma_f32_16x16x32_bf16 v[204:207], v[32:35], v[60:63], v[204:207]
    s_waitcnt lgkmcnt(4)
    s_waitcnt vmcnt(8)
    v_exp_f32 v109, v109
    v_mfma_f32_16x16x32_bf16 v[208:211], v[36:39], v[48:51], v[208:211]
    ds_read_b128 v[32:35], v2
    v_mfma_f32_16x16x32_bf16 v[212:215], v[36:39], v[52:55], v[212:215]
    v_exp_f32 v110, v110
    v_mfma_f32_16x16x32_bf16 v[216:219], v[36:39], v[56:59], v[216:219]
    v_exp_f32 v111, v111
    v_mfma_f32_16x16x32_bf16 v[220:223], v[36:39], v[60:63], v[220:223]
    s_waitcnt lgkmcnt(3)
    v_exp_f32 v112, v112
    v_mfma_f32_16x16x32_bf16 v[224:227], v[40:43], v[48:51], v[224:227]
    ds_read_b128 v[36:39], v2 offset:2048
    v_mfma_f32_16x16x32_bf16 v[228:231], v[40:43], v[52:55], v[228:231]
    v_exp_f32 v113, v113
    v_mfma_f32_16x16x32_bf16 v[232:235], v[40:43], v[56:59], v[232:235]
    v_exp_f32 v114, v114
    v_mfma_f32_16x16x32_bf16 v[236:239], v[40:43], v[60:63], v[236:239]
    s_waitcnt lgkmcnt(2)
    v_exp_f32 v115, v115
    v_mfma_f32_16x16x32_bf16 v[240:243], v[44:47], v[48:51], v[240:243]
    ds_read_b128 v[40:43], v2 offset:256
    v_mfma_f32_16x16x32_bf16 v[244:247], v[44:47], v[52:55], v[244:247]
    v_exp_f32 v116, v116
    v_mfma_f32_16x16x32_bf16 v[248:251], v[44:47], v[56:59], v[248:251]
    v_exp_f32 v117, v117
    v_mfma_f32_16x16x32_bf16 v[252:255], v[44:47], v[60:63], v[252:255]
    s_waitcnt lgkmcnt(1)
    v_add_u32 v3, s28, v3
    s_cbranch_scc1 K2_TAIL1
    v_mfma_f32_16x16x32_bf16 v[64:67], v[32:35], a[128:131], v[16:19]
    ds_read_b128 v[44:47], v2 offset:2304
    v_cvt_pk_bf16_f32 v48, v96, v97
    v_mfma_f32_16x16x32_bf16 v[64:67], v[36:39], a[144:147], v[64:67]
    v_exp_f32 v118, v118
    v_mfma_f32_16x16x32_bf16 v[68:71], v[32:35], a[132:135], v[20:23]
    v_exp_f32 v119, v119
    v_mfma_f32_16x16x32_bf16 v[68:71], v[36:39], a[148:151], v[68:71]
    v_cvt_pk_bf16_f32 v49, v98, v99
    v_or_b32 v8, v48, v49
    v_mfma_f32_16x16x32_bf16 v[72:75], v[32:35], a[136:139], v[24:27]
    v_cvt_pk_bf16_f32 v52, v100, v101
    v_cvt_pk_bf16_f32 v53, v102, v103
    v_mfma_f32_16x16x32_bf16 v[72:75], v[36:39], a[152:155], v[72:75]
    v_exp_f32 v120, v120
    v_mfma_f32_16x16x32_bf16 v[76:79], v[32:35], a[140:143], v[28:31]
    ds_read_b128 v[32:35], v2 offset:4096
    v_or3_b32 v8, v52, v53, v8
    v_mfma_f32_16x16x32_bf16 v[76:79], v[36:39], a[156:159], v[76:79]
    s_waitcnt lgkmcnt(1)
    v_cvt_pk_bf16_f32 v56, v104, v105
    v_cvt_pk_bf16_f32 v57, v106, v107
    v_mfma_f32_16x16x32_bf16 v[80:83], v[40:43], a[128:131], v[16:19]
    ds_read_b128 v[36:39], v2 offset:6144
    v_or3_b32 v8, v56, v57, v8
    v_mfma_f32_16x16x32_bf16 v[80:83], v[44:47], a[144:147], v[80:83]
    v_exp_f32 v121, v121
    v_mfma_f32_16x16x32_bf16 v[84:87], v[40:43], a[132:135], v[20:23]
    v_exp_f32 v122, v122
    v_mfma_f32_16x16x32_bf16 v[84:87], v[44:47], a[148:151], v[84:87]
    v_cvt_pk_bf16_f32 v60, v108, v109
    v_cvt_pk_bf16_f32 v61, v110, v111
    v_mfma_f32_16x16x32_bf16 v[88:91], v[40:43], a[136:139], v[24:27]
    v_or3_b32 v8, v60, v61, v8
    v_cvt_pk_bf16_f32 v50, v112, v113
    v_mfma_f32_16x16x32_bf16 v[88:91], v[44:47], a[152:155], v[88:91]
    v_exp_f32 v123, v123
    v_mfma_f32_16x16x32_bf16 v[92:95], v[40:43], a[140:143], v[28:31]
    ds_read_b128 v[40:43], v2 offset:4352
    v_cvt_pk_bf16_f32 v51, v114, v115
    v_mfma_f32_16x16x32_bf16 v[92:95], v[44:47], a[156:159], v[92:95]
    s_waitcnt lgkmcnt(1)
    v_or3_b32 v8, v50, v51, v8
    v_cvt_pk_bf16_f32 v54, v116, v117
    v_mfma_f32_16x16x32_bf16 v[64:67], v[32:35], a[160:163], v[64:67]
    ds_read_b128 v[44:47], v2 offset:6400
    v_cvt_pk_bf16_f32 v55, v118, v119
    v_mfma_f32_16x16x32_bf16 v[64:67], v[36:39], a[176:179], v[64:67]
    v_exp_f32 v124, v124
    v_mfma_f32_16x16x32_bf16 v[68:71], v[32:35], a[164:167], v[68:71]
    v_exp_f32 v125, v125
    v_mfma_f32_16x16x32_bf16 v[68:71], v[36:39], a[180:183], v[68:71]
    v_or3_b32 v8, v54, v55, v8
    v_cvt_pk_bf16_f32 v58, v120, v121
    v_mfma_f32_16x16x32_bf16 v[72:75], v[32:35], a[168:171], v[72:75]
    v_cvt_pk_bf16_f32 v59, v122, v123
    v_or3_b32 v8, v58, v59, v8
    v_mfma_f32_16x16x32_bf16 v[72:75], v[36:39], a[184:187], v[72:75]
    v_exp_f32 v126, v126
    v_mfma_f32_16x16x32_bf16 v[76:79], v[32:35], a[172:175], v[76:79]
    ds_read_b64_tr_b16 v[32:33], v3
    ds_read_b64_tr_b16 v[34:35], v3 offset:256
    v_mfma_f32_16x16x32_bf16 v[76:79], v[36:39], a[188:191], v[76:79]
    s_waitcnt lgkmcnt(2)
    v_cvt_pk_bf16_f32 v62, v124, v125
    v_mfma_f32_16x16x32_bf16 v[80:83], v[40:43], a[160:163], v[80:83]
    ds_read_b64_tr_b16 v[36:37], v3 offset:1024
    ds_read_b64_tr_b16 v[38:39], v3 offset:1280
    v_mfma_f32_16x16x32_bf16 v[80:83], v[44:47], a[176:179], v[80:83]
    v_exp_f32 v127, v127
    v_mfma_f32_16x16x32_bf16 v[84:87], v[40:43], a[164:167], v[84:87]
    v_cvt_pk_bf16_f32 v63, v126, v127
    v_or3_b32 v8, v62, v63, v8
    v_mfma_f32_16x16x32_bf16 v[84:87], v[44:47], a[180:183], v[84:87]
    v_and_b32 v8, 0x40004000, v8
    v_cmp_ne_u32 vcc, 0, v8
    v_mfma_f32_16x16x32_bf16 v[88:91], v[40:43], a[168:171], v[88:91]
    v_mfma_f32_16x16x32_bf16 v[88:91], v[44:47], a[184:187], v[88:91]
    buffer_load_dwordx4 v1, s[8:11], s16 offen lds
    v_mfma_f32_16x16x32_bf16 v[92:95], v[40:43], a[172:175], v[92:95]
    ds_read_b64_tr_b16 v[40:41], v3 offset:2048
    ds_read_b64_tr_b16 v[42:43], v3 offset:2304
    v_mfma_f32_16x16x32_bf16 v[92:95], v[44:47], a[188:191], v[92:95]
    s_waitcnt lgkmcnt(4)
    s_add_u32 s19, s19, s22
    s_cbranch_vccnz K2_STUB_L1
K2_BACK_L1:
    v_mfma_f32_16x16x32_bf16 a[0:3], v[32:35], v[48:51], a[0:3]
    s_cmp_eq_u32 s19, s24
    ds_read_b64_tr_b16 v[44:45], v3 offset:3072
    ds_read_b64_tr_b16 v[46:47], v3 offset:3328
    v_mfma_f32_16x16x32_bf16 a[4:7], v[32:35], v[52:55], a[4:7]
    s_cselect_b32 s25, s23, s22
    buffer_load_dwordx4 v1, s[8:11], s16 offen offset:1024 lds
    v_mfma_f32_16x16x32_bf16 a[8:11], v[32:35], v[56:59], a[8:11]
    s_cselect_b32 s19, 0, s19
    v_add_f32 v4, v4, v96
    v_mfma_f32_16x16x32_bf16 a[12:15], v[32:35], v[60:63], a[12:15]
    s_waitcnt lgkmcnt(4)
    v_add_f32 v5, v5, v100
    v_mfma_f32_16x16x32_bf16 a[16:19], v[36:39], v[48:51], a[16:19]
    ds_read_b64_tr_b16 v[32:33], v3 offset:4096
    ds_read_b64_tr_b16 v[34:35], v3 offset:4352
    v_mfma_f32_16x16x32_bf16 a[20:23], v[36:39], v[52:55], a[20:23]
    buffer_load_dwordx4 v1, s[8:11], s16 offen offset:2048 lds
    v_mfma_f32_16x16x32_bf16 a[24:27], v[36:39], v[56:59], a[24:27]
    v_add_f32 v6, v6, v104
    v_mfma_f32_16x16x32_bf16 a[28:31], v[36:39], v[60:63], a[28:31]
    s_waitcnt lgkmcnt(4)
    v_add_f32 v7, v7, v108
    v_mfma_f32_16x16x32_bf16 a[32:35], v[40:43], v[48:51], a[32:35]
    ds_read_b64_tr_b16 v[36:37], v3 offset:5120
    ds_read_b64_tr_b16 v[38:39], v3 offset:5376
    v_mfma_f32_16x16x32_bf16 a[36:39], v[40:43], v[52:55], a[36:39]
    buffer_load_dwordx4 v1, s[8:11], s16 offen offset:3072 lds
    v_mfma_f32_16x16x32_bf16 a[40:43], v[40:43], v[56:59], a[40:43]
    s_add_u32 m0, m0, 4096
    v_mfma_f32_16x16x32_bf16 a[44:47], v[40:43], v[60:63], a[44:47]
    s_waitcnt lgkmcnt(4)
    s_add_u32 s16, s16, 4096
    v_add_f32 v4, v4, v97
    v_mfma_f32_16x16x32_bf16 a[48:51], v[44:47], v[48:51], a[48:51]
    ds_read_b64_tr_b16 v[40:41], v3 offset:6144
    ds_read_b64_tr_b16 v[42:43], v3 offset:6400
    v_mfma_f32_16x16x32_bf16 a[52:55], v[44:47], v[52:55], a[52:55]
    buffer_load_dwordx4 v1, s[8:11], s16 offen lds
    v_mfma_f32_16x16x32_bf16 a[56:59], v[44:47], v[56:59], a[56:59]
    v_add_f32 v5, v5, v101
    v_mfma_f32_16x16x32_bf16 a[60:63], v[44:47], v[60:63], a[60:63]
    s_waitcnt lgkmcnt(4)
    v_add_f32 v6, v6, v105
    v_mfma_f32_16x16x32_bf16 a[64:67], v[32:35], v[48:51], a[64:67]
    ds_read_b64_tr_b16 v[44:45], v3 offset:7168
    ds_read_b64_tr_b16 v[46:47], v3 offset:7424
    v_mfma_f32_16x16x32_bf16 a[68:71], v[32:35], v[52:55], a[68:71]
    buffer_load_dwordx4 v1, s[8:11], s16 offen offset:1024 lds
    v_mfma_f32_16x16x32_bf16 a[72:75], v[32:35], v[56:59], a[72:75]
    v_add_f32 v7, v7, v109
    v_mfma_f32_16x16x32_bf16 a[76:79], v[32:35], v[60:63], a[76:79]
    s_waitcnt lgkmcnt(4)
    s_waitcnt vmcnt(6)
    v_add_u32 v2, s25, v2
    v_mfma_f32_16x16x32_bf16 a[80:83], v[36:39], v[48:51], a[80:83]
    ds_read_b128 v[32:35], v2
    v_add_f32 v4, v4, v98
    v_mfma_f32_16x16x32_bf16 a[84:87], v[36:39], v[52:55], a[84:87]
    buffer_load_dwordx4 v1, s[8:11], s16 offen offset:2048 lds
    v_mfma_f32_16x16x32_bf16 a[88:91], v[36:39], v[56:59], a[88:91]
    v_add_f32 v5, v5, v102
    v_mfma_f32_16x16x32_bf16 a[92:95], v[36:39], v[60:63], a[92:95]
    s_waitcnt lgkmcnt(3)
    v_add_f32 v6, v6, v106
    v_mfma_f32_16x16x32_bf16 a[96:99], v[40:43], v[48:51], a[96:99]
    ds_read_b128 v[36:39], v2 offset:2048
    v_add_f32 v7, v7, v110
    v_mfma_f32_16x16x32_bf16 a[100:103], v[40:43], v[52:55], a[100:103]
    buffer_load_dwordx4 v1, s[8:11], s16 offen offset:3072 lds
    v_mfma_f32_16x16x32_bf16 a[104:107], v[40:43], v[56:59], a[104:107]
    s_add_u32 m0, m0, 4096
    v_mfma_f32_16x16x32_bf16 a[108:111], v[40:43], v[60:63], a[108:111]
    s_waitcnt lgkmcnt(2)
    s_cmp_eq_u32 m0, s29
    v_add_f32 v4, v4, v99
    v_mfma_f32_16x16x32_bf16 a[112:115], v[44:47], v[48:51], a[112:115]
    s_cselect_b32 m0, s26, m0
    ds_read_b128 v[40:43], v2 offset:256
    v_add_f32 v5, v5, v103
    v_mfma_f32_16x16x32_bf16 a[116:119], v[44:47], v[52:55], a[116:119]
    s_add_u32 s16, s16, 4096
    v_add_f32 v6, v6, v107
    v_mfma_f32_16x16x32_bf16 a[120:123], v[44:47], v[56:59], a[120:123]
    v_add_f32 v7, v7, v111
    v_mfma_f32_16x16x32_bf16 a[124:127], v[44:47], v[60:63], a[124:127]
    s_waitcnt lgkmcnt(1)
    v_mfma_f32_16x16x32_bf16 v[64:67], v[32:35], a[192:195], v[64:67]
    s_add_u32 s20, s20, s22
    ds_read_b128 v[44:47], v2 offset:2304
    v_add_f32 v4, v4, v112
    v_mfma_f32_16x16x32_bf16 v[64:67], v[36:39], a[208:211], v[64:67]
    s_cmp_eq_u32 s20, s24
    buffer_load_dwordx4 v1, s[8:11], s16 offen lds
    v_mfma_f32_16x16x32_bf16 v[68:71], v[32:35], a[196:199], v[68:71]
    s_cselect_b32 s28, s23, s22
    v_add_f32 v5, v5, v116
    v_mfma_f32_16x16x32_bf16 v[68:71], v[36:39], a[212:215], v[68:71]
    s_cselect_b32 s20, 0, s20
    v_add_f32 v6, v6, v120
    v_mfma_f32_16x16x32_bf16 v[72:75], v[32:35], a[200:203], v[72:75]
    v_add_f32 v7, v7, v124
    v_mfma_f32_16x16x32_bf16 v[72:75], v[36:39], a[216:219], v[72:75]
    buffer_load_dwordx4 v1, s[8:11], s16 offen offset:1024 lds
    v_mfma_f32_16x16x32_bf16 v[76:79], v[32:35], a[204:207], v[76:79]
    ds_read_b128 v[32:35], v2 offset:4096
    v_mfma_f32_16x16x32_bf16 v[76:79], v[36:39], a[220:223], v[76:79]
    s_waitcnt lgkmcnt(1)
    v_add_f32 v4, v4, v113
    v_mfma_f32_16x16x32_bf16 v[80:83], v[40:43], a[192:195], v[80:83]
    ds_read_b128 v[36:39], v2 offset:6144
    v_add_f32 v5, v5, v117
    v_mfma_f32_16x16x32_bf16 v[80:83], v[44:47], a[208:211], v[80:83]
    buffer_load_dwordx4 v1, s[8:11], s16 offen offset:2048 lds
    v_mfma_f32_16x16x32_bf16 v[84:87], v[40:43], a[196:199], v[84:87]
    v_add_f32 v6, v6, v121
    v_mfma_f32_16x16x32_bf16 v[84:87], v[44:47], a[212:215], v[84:87]
    v_add_f32 v7, v7, v125
    v_mfma_f32_16x16x32_bf16 v[88:91], v[40:43], a[200:203], v[88:91]
    v_mfma_f32_16x16x32_bf16 v[88:91], v[44:47], a[216:219], v[88:91]
    buffer_load_dwordx4 v1, s[8:11], s16 offen offset:3072 lds
    v_mfma_f32_16x16x32_bf16 v[92:95], v[40:43], a[204:207], v[92:95]
    s_add_u32 m0, m0, 4096
    ds_read_b128 v[40:43], v2 offset:4352
    v_add_f32 v4, v4, v114
    v_mfma_f32_16x16x32_bf16 v[92:95], v[44:47], a[220:223], v[92:95]
    s_waitcnt lgkmcnt(1)
    s_add_u32 s16, s16, 4096
    v_add_f32 v5, v5, v118
    v_mfma_f32_16x16x32_bf16 v[64:67], v[32:35], a[224:227], v[64:67]
    s_add_u32 s19, s19, s22
    ds_read_b128 v[44:47], v2 offset:6400
    v_add_f32 v6, v6, v122
    v_mfma_f32_16x16x32_bf16 v[64:67], v[36:39], a[240:243], v[64:67]
    s_cmp_eq_u32 s19, s24
    buffer_load_dwordx4 v1, s[8:11], s16 offen lds
    v_mfma_f32_16x16x32_bf16 v[68:71], v[32:35], a[228:231], v[68:71]
    s_cselect_b32 s25, s23, s22
    v_add_f32 v7, v7, v126
    v_mfma_f32_16x16x32_bf16 v[68:71], v[36:39], a[244:247], v[68:71]
    s_cselect_b32 s19, 0, s19
    v_mfma_f32_16x16x32_bf16 v[72:75], v[32:35], a[232:235], v[72:75]
    v_add_f32 v4, v4, v115
    v_add_u32 v3, s28, v3
    v_mfma_f32_16x16x32_bf16 v[72:75], v[36:39], a[248:251], v[72:75]
    buffer_load_dwordx4 v1, s[8:11], s16 offen offset:1024 lds
    v_mfma_f32_16x16x32_bf16 v[76:79], v[32:35], a[236:239], v[76:79]
    ds_read_b64_tr_b16 v[32:33], v3
    ds_read_b64_tr_b16 v[34:35], v3 offset:256
    v_mfma_f32_16x16x32_bf16 v[76:79], v[36:39], a[252:255], v[76:79]
    s_waitcnt lgkmcnt(2)
    v_add_f32 v5, v5, v119
    v_mfma_f32_16x16x32_bf16 v[80:83], v[40:43], a[224:227], v[80:83]
    ds_read_b64_tr_b16 v[36:37], v3 offset:1024
    ds_read_b64_tr_b16 v[38:39], v3 offset:1280
    v_mfma_f32_16x16x32_bf16 v[80:83], v[44:47], a[240:243], v[80:83]
    buffer_load_dwordx4 v1, s[8:11], s16 offen offset:2048 lds
    v_mfma_f32_16x16x32_bf16 v[84:87], v[40:43], a[228:231], v[84:87]
    v_add_f32 v6, v6, v123
    v_mfma_f32_16x16x32_bf16 v[84:87], v[44:47], a[244:247], v[84:87]
    v_add_f32 v7, v7, v127
    v_mfma_f32_16x16x32_bf16 v[88:91], v[40:43], a[232:235], v[88:91]
    v_mfma_f32_16x16x32_bf16 v[88:91], v[44:47], a[248:251], v[88:91]
    buffer_load_dwordx4 v1, s[8:11], s16 offen offset:3072 lds
    v_mfma_f32_16x16x32_bf16 v[92:95], v[40:43], a[236:239], v[92:95]
    s_add_u32 m0, m0, 4096
    ds_read_b64_tr_b16 v[40:41], v3 offset:2048
    ds_read_b64_tr_b16 v[42:43], v3 offset:2304
    v_mfma_f32_16x16x32_bf16 v[92:95], v[44:47], a[252:255], v[92:95]
    s_waitcnt lgkmcnt(4)
    s_cmp_eq_u32 m0, s29
    v_mfma_f32_16x16x32_bf16 v[128:131], v[32:35], v[48:51], v[128:131]
    s_cselect_b32 m0, s26, m0
    ds_read_b64_tr_b16 v[44:45], v3 offset:3072
    ds_read_b64_tr_b16 v[46:47], v3 offset:3328
    v_mfma_f32_16x16x32_bf16 v[132:135], v[32:35], v[52:55], v[132:135]
    s_add_u32 s16, s16, 4096
    v_add_u32 v2, s25, v2
    v_mfma_f32_16x16x32_bf16 v[136:139], v[32:35], v[56:59], v[136:139]
    s_cmp_eq_u32 s16, s18
    v_exp_f32 v64, v64
    v_mfma_f32_16x16x32_bf16 v[140:143], v[32:35], v[60:63], v[140:143]
    s_waitcnt lgkmcnt(4)
    v_exp_f32 v65, v65
    v_mfma_f32_16x16x32_bf16 v[144:147], v[36:39], v[48:51], v[144:147]
    s_cselect_b32 s16, s17, s16
    ds_read_b64_tr_b16 v[32:33], v3 offset:4096
    ds_read_b64_tr_b16 v[34:35], v3 offset:4352
    v_mfma_f32_16x16x32_bf16 v[148:151], v[36:39], v[52:55], v[148:151]
    v_exp_f32 v66, v66
    v_mfma_f32_16x16x32_bf16 v[152:155], v[36:39], v[56:59], v[152:155]
    v_exp_f32 v67, v67
    v_mfma_f32_16x16x32_bf16 v[156:159], v[36:39], v[60:63], v[156:159]
    s_waitcnt lgkmcnt(4)
    v_exp_f32 v68, v68
    v_mfma_f32_16x16x32_bf16 v[160:163], v[40:43], v[48:51], v[160:163]
    ds_read_b64_tr_b16 v[36:37], v3 offset:5120
    ds_read_b64_tr_b16 v[38:39], v3 offset:5376
    v_mfma_f32_16x16x32_bf16 v[164:167], v[40:43], v[52:55], v[164:167]
    v_exp_f32 v69, v69
    v_mfma_f32_16x16x32_bf16 v[168:171], v[40:43], v[56:59], v[168:171]
    v_exp_f32 v70, v70
    v_mfma_f32_16x16x32_bf16 v[172:175], v[40:43], v[60:63], v[172:175]
    s_waitcnt lgkmcnt(4)
    v_exp_f32 v71, v71
    v_mfma_f32_16x16x32_bf16 v[176:179], v[44:47], v[48:51], v[176:179]
    s_add_u32 s20, s20, s22
    ds_read_b64_tr_b16 v[40:41], v3 offset:6144
    ds_read_b64_tr_b16 v[42:43], v3 offset:6400
    v_mfma_f32_16x16x32_bf16 v[180:183], v[44:47], v[52:55], v[180:183]
    s_cmp_eq_u32 s20, s24
    v_exp_f32 v72, v72
    v_mfma_f32_16x16x32_bf16 v[184:187], v[44:47], v[56:59], v[184:187]
    s_cselect_b32 s28, s23, s22
    v_exp_f32 v73, v73
    v_mfma_f32_16x16x32_bf16 v[188:191], v[44:47], v[60:63], v[188:191]
    s_waitcnt lgkmcnt(4)
    v_exp_f32 v74, v74
    v_mfma_f32_16x16x32_bf16 v[192:195], v[32:35], v[48:51], v[192:195]
    s_cselect_b32 s20, 0, s20
    ds_read_b64_tr_b16 v[44:45], v3 offset:7168
    ds_read_b64_tr_b16 v[46:47], v3 offset:7424
    v_mfma_f32_16x16x32_bf16 v[196:199], v[32:35], v[52:55], v[196:199]
    v_exp_f32 v75, v75
    v_mfma_f32_16x16x32_bf16 v[200:203], v[32:35], v[56:59], v[200:203]
    v_exp_f32 v76, v76
    v_mfma_f32_16x16x32_bf16 v[204:207], v[32:35], v[60:63], v[204:207]
    s_waitcnt lgkmcnt(4)
    s_waitcnt vmcnt(8)
    v_exp_f32 v77, v77
    v_mfma_f32_16x16x32_bf16 v[208:211], v[36:39], v[48:51], v[208:211]
    ds_read_b128 v[32:35], v2
    v_mfma_f32_16x16x32_bf16 v[212:215], v[36:39], v[52:55], v[212:215]
    s_cmp_le_u32 s27, 2
    s_cbranch_scc0 K2_NOFL1
    buffer_load_dword v15, v1, s[8:11], s21 offen sc0 sc1
K2_NOFL1:
    v_exp_f32 v78, v78
    v_mfma_f32_16x16x32_bf16 v[216:219], v[36:39], v[56:59], v[216:219]
    s_addk_i32 s27, -1
    v_exp_f32 v79, v79
    v_mfma_f32_16x16x32_bf16 v[220:223], v[36:39], v[60:63], v[220:223]
    s_waitcnt lgkmcnt(3)
    v_exp_f32 v80, v80
    v_mfma_f32_16x16x32_bf16 v[224:227], v[40:43], v[48:51], v[224:227]
    s_cmp_eq_u32 s27, 0
    ds_read_b128 v[36:39], v2 offset:2048
    v_mfma_f32_16x16x32_bf16 v[228:231], v[40:43], v[52:55], v[228:231]
    v_exp_f32 v81, v81
    v_mfma_f32_16x16x32_bf16 v[232:235], v[40:43], v[56:59], v[232:235]
    v_exp_f32 v82, v82
    v_mfma_f32_16x16x32_bf16 v[236:239], v[40:43], v[60:63], v[236:239]
    s_waitcnt lgkmcnt(2)
    v_exp_f32 v83, v83
    v_mfma_f32_16x16x32_bf16 v[240:243], v[44:47], v[48:51], v[240:243]
    ds_read_b128 v[40:43], v2 offset:256
    v_mfma_f32_16x16x32_bf16 v[244:247], v[44:47], v[52:55], v[244:247]
    v_exp_f32 v84, v84
    v_mfma_f32_16x16x32_bf16 v[248:251], v[44:47], v[56:59], v[248:251]
    v_exp_f32 v85, v85
    v_mfma_f32_16x16x32_bf16 v[252:255], v[44:47], v[60:63], v[252:255]
    s_waitcnt lgkmcnt(1)
    v_add_u32 v3, s28, v3
    s_cbranch_scc0 K2_LOOP
K2_TAIL0:
    s_waitcnt lgkmcnt(0)
    ds_read_b64_tr_b16 v[32:33], v3
    ds_read_b64_tr_b16 v[34:35], v3 offset:256
    ds_read_b64_tr_b16 v[36:37], v3 offset:1024
    ds_read_b64_tr_b16 v[38:39], v3 offset:1280
    ds_read_b64_tr_b16 v[40:41], v3 offset:2048
    ds_read_b64_tr_b16 v[42:43], v3 offset:2304
    v_exp_f32 v86, v86
    v_exp_f32 v87, v87
    v_exp_f32 v88, v88
    v_exp_f32 v89, v89
    v_exp_f32 v90, v90
    v_exp_f32 v91, v91
    v_exp_f32 v92, v92
    v_exp_f32 v93, v93
    v_exp_f32 v94, v94
    v_exp_f32 v95, v95
    v_cvt_pk_bf16_f32 v48, v64, v65
    v_cvt_pk_bf16_f32 v49, v66, v67
    v_or_b32 v8, v48, v49
    v_cvt_pk_bf16_f32 v52, v68, v69
    v_cvt_pk_bf16_f32 v53, v70, v71
    v_or3_b32 v8, v52, v53, v8
    v_cvt_pk_bf16_f32 v56, v72, v73
    v_cvt_pk_bf16_f32 v57, v74, v75
    v_or3_b32 v8, v56, v57, v8
    v_cvt_pk_bf16_f32 v60, v76, v77
    v_cvt_pk_bf16_f32 v61, v78, v79
    v_or3_b32 v8, v60, v61, v8
    v_cvt_pk_bf16_f32 v50, v80, v81
    v_cvt_pk_bf16_f32 v51, v82, v83
    v_or3_b32 v8, v50, v51, v8
    v_cvt_pk_bf16_f32 v54, v84, v85
    v_cvt_pk_bf16_f32 v55, v86, v87
    v_or3_b32 v8, v54, v55, v8
    v_cvt_pk_bf16_f32 v58, v88, v89
    v_cvt_pk_bf16_f32 v59, v90, v91
    v_or3_b32 v8, v58, v59, v8
    v_cvt_pk_bf16_f32 v62, v92, v93
    v_cvt_pk_bf16_f32 v63, v94, v95
    v_or3_b32 v8, v62, v63, v8
    v_and_b32 v8, 0x40004000, v8
    v_cmp_ne_u32 vcc, 0, v8
    s_nop 1
    s_cbranch_vccnz K2_STUB_T0
K2_BACK_T0:
    s_waitcnt vmcnt(0)
    v_cmp_eq_u32 vcc, 0, v15
    s_nop 1
    s_and_b32 s14, vcc_lo, 0xff
    s_cbranch_scc1 K2_FSTUB0
K2_FBACK0:
    buffer_load_dwordx4 a[248:251], v1, s[8:11], s82 offen
    buffer_load_dwordx4 a[252:255], v1, s[8:11], s83 offen
    s_mov_b32 s12, s81
    s_waitcnt lgkmcnt(4)
    v_mfma_f32_16x16x32_bf16 a[0:3], v[32:35], v[48:51], a[0:3]
    ds_read_b64_tr_b16 v[44:45], v3 offset:3072
    ds_read_b64_tr_b16 v[46:47], v3 offset:3328
    v_mfma_f32_16x16x32_bf16 a[4:7], v[32:35], v[52:55], a[4:7]
    buffer_load_dwordx4 a[128:131], v1, s[8:11], s12 offen
    v_mfma_f32_16x16x32_bf16 a[8:11], v[32:35], v[56:59], a[8:11]
    v_add_f32 v4, v4, v64
    v_mfma_f32_16x16x32_bf16 a[12:15], v[32:35], v[60:63], a[12:15]
    v_add_f32 v5, v5, v68
    s_waitcnt lgkmcnt(4)
    v_mfma_f32_16x16x32_bf16 a[16:19], v[36:39], v[48:51], a[16:19]
    ds_read_b64_tr_b16 v[32:33], v3 offset:4096
    ds_read_b64_tr_b16 v[34:35], v3 offset:4352
    v_mfma_f32_16x16x32_bf16 a[20:23], v[36:39], v[52:55], a[20:23]
    buffer_load_dwordx4 a[132:135], v1, s[8:11], s12 offen offset:1024
    v_mfma_f32_16x16x32_bf16 a[24:27], v[36:39], v[56:59], a[24:27]
    v_add_f32 v6, v6, v72
    v_mfma_f32_16x16x32_bf16 a[28:31], v[36:39], v[60:63], a[28:31]
    v_add_f32 v7, v7, v76
    s_waitcnt lgkmcnt(4)
    v_mfma_f32_16x16x32_bf16 a[32:35], v[40:43], v[48:51], a[32:35]
    ds_read_b64_tr_b16 v[36:37], v3 offset:5120
    ds_read_b64_tr_b16 v[38:39], v3 offset:5376
    v_mfma_f32_16x16x32_bf16 a[36:39], v[40:43], v[52:55], a[36:39]
    buffer_load_dwordx4 a[136:139], v1, s[8:11], s12 offen offset:2048
    v_mfma_f32_16x16x32_bf16 a[40:43], v[40:43], v[56:59], a[40:43]
    v_add_f32 v4, v4, v65
    v_mfma_f32_16x16x32_bf16 a[44:47], v[40:43], v[60:63], a[44:47]
    v_add_f32 v5, v5, v69
    s_waitcnt lgkmcnt(4)
    v_mfma_f32_16x16x32_bf16 a[48:51], v[44:47], v[48:51], a[48:51]
    ds_read_b64_tr_b16 v[40:41], v3 offset:6144
    ds_read_b64_tr_b16 v[42:43], v3 offset:6400
    v_mfma_f32_16x16x32_bf16 a[52:55], v[44:47], v[52:55], a[52:55]
    buffer_load_dwordx4 a[140:143], v1, s[8:11], s12 offen offset:3072
    v_mfma_f32_16x16x32_bf16 a[56:59], v[44:47], v[56:59], a[56:59]
    v_add_f32 v6, v6, v73
    v_mfma_f32_16x16x32_bf16 a[60:63], v[44:47], v[60:63], a[60:63]
    v_add_f32 v7, v7, v77
    s_waitcnt lgkmcnt(4)
    v_mfma_f32_16x16x32_bf16 a[64:67], v[32:35], v[48:51], a[64:67]
    ds_read_b64_tr_b16 v[44:45], v3 offset:7168
    ds_read_b64_tr_b16 v[46:47], v3 offset:7424
    v_mfma_f32_16x16x32_bf16 a[68:71], v[32:35], v[52:55], a[68:71]
    s_add_u32 s12, s12, 4096
    buffer_load_dwordx4 a[144:147], v1, s[8:11], s12 offen
    v_mfma_f32_16x16x32_bf16 a[72:75], v[32:35], v[56:59], a[72:75]
    v_add_f32 v4, v4, v66
    v_mfma_f32_16x16x32_bf16 a[76:79], v[32:35], v[60:63], a[76:79]
    v_add_f32 v5, v5, v70
    s_add_u32 s20, s20, s22
    s_cmp_eq_u32 s20, s24
    s_cselect_b32 s28, s23, s22
    s_cselect_b32 s20, 0, s20
    v_add_u32 v3, s28, v3
    s_waitcnt lgkmcnt(4)
    v_mfma_f32_16x16x32_bf16 a[80:83], v[36:39], v[48:51], a[80:83]
    ds_read_b64_tr_b16 v[32:33], v3
    ds_read_b64_tr_b16 v[34:35], v3 offset:256
    v_mfma_f32_16x16x32_bf16 a[84:87], v[36:39], v[52:55], a[84:87]
    buffer_load_dwordx4 a[148:151], v1, s[8:11], s12 offen offset:1024
    v_mfma_f32_16x16x32_bf16 a[88:91], v[36:39], v[56:59], a[88:91]
    v_add_f32 v6, v6, v74
    v_mfma_f32_16x16x32_bf16 a[92:95], v[36:39], v[60:63], a[92:95]
    v_add_f32 v7, v7, v78
    s_waitcnt lgkmcnt(4)
    v_mfma_f32_16x16x32_bf16 a[96:99], v[40:43], v[48:51], a[96:99]
    ds_read_b64_tr_b16 v[36:37], v3 offset:1024
    ds_read_b64_tr_b16 v[38:39], v3 offset:1280
    v_mfma_f32_16x16x32_bf16 a[100:103], v[40:43], v[52:55], a[100:103]
    buffer_load_dwordx4 a[152:155], v1, s[8:11], s12 offen offset:2048
    v_mfma_f32_16x16x32_bf16 a[104:107], v[40:43], v[56:59], a[104:107]
    v_add_f32 v4, v4, v67
    v_mfma_f32_16x16x32_bf16 a[108:111], v[40:43], v[60:63], a[108:111]
    v_add_f32 v5, v5, v71
    s_waitcnt lgkmcnt(4)
    v_mfma_f32_16x16x32_bf16 a[112:115], v[44:47], v[48:51], a[112:115]
    ds_read_b64_tr_b16 v[40:41], v3 offset:2048
    ds_read_b64_tr_b16 v[42:43], v3 offset:2304
    v_mfma_f32_16x16x32_bf16 a[116:119], v[44:47], v[52:55], a[116:119]
    buffer_load_dwordx4 a[156:159], v1, s[8:11], s12 offen offset:3072
    v_mfma_f32_16x16x32_bf16 a[120:123], v[44:47], v[56:59], a[120:123]
    v_add_f32 v6, v6, v75
    v_mfma_f32_16x16x32_bf16 a[124:127], v[44:47], v[60:63], a[124:127]
    v_add_f32 v7, v7, v79
    s_waitcnt lgkmcnt(4)
    v_mfma_f32_16x16x32_bf16 v[128:131], v[32:35], v[48:51], v[128:131]
    ds_read_b64_tr_b16 v[44:45], v3 offset:3072
    ds_read_b64_tr_b16 v[46:47], v3 offset:3328
    v_mfma_f32_16x16x32_bf16 v[132:135], v[32:35], v[52:55], v[132:135]
    s_add_u32 s12, s12, 4096
    buffer_load_dwordx4 a[160:163], v1, s[8:11], s12 offen
    v_mfma_f32_16x16x32_bf16 v[136:139], v[32:35], v[56:59], v[136:139]
    v_add_f32 v4, v4, v80
    v_mfma_f32_16x16x32_bf16 v[140:143], v[32:35], v[60:63], v[140:143]
    v_add_f32 v5, v5, v84
    s_waitcnt lgkmcnt(4)
    v_mfma_f32_16x16x32_bf16 v[144:147], v[36:39], v[48:51], v[144:147]
    ds_read_b64_tr_b16 v[32:33], v3 offset:4096
    ds_read_b64_tr_b16 v[34:35], v3 offset:4352
    v_mfma_f32_16x16x32_bf16 v[148:151], v[36:39], v[52:55], v[148:151]
    buffer_load_dwordx4 a[164:167], v1, s[8:11], s12 offen offset:1024
    v_mfma_f32_16x16x32_bf16 v[152:155], v[36:39], v[56:59], v[152:155]
    v_add_f32 v6, v6, v88
    v_mfma_f32_16x16x32_bf16 v[156:159], v[36:39], v[60:63], v[156:159]
    v_add_f32 v7, v7, v92
    s_waitcnt lgkmcnt(4)
    v_mfma_f32_16x16x32_bf16 v[160:163], v[40:43], v[48:51], v[160:163]
    ds_read_b64_tr_b16 v[36:37], v3 offset:5120
    ds_read_b64_tr_b16 v[38:39], v3 offset:5376
    v_mfma_f32_16x16x32_bf16 v[164:167], v[40:43], v[52:55], v[164:167]
    buffer_load_dwordx4 a[168:171], v1, s[8:11], s12 offen offset:2048
    v_mfma_f32_16x16x32_bf16 v[168:171], v[40:43], v[56:59], v[168:171]
    v_add_f32 v4, v4, v81
    v_mfma_f32_16x16x32_bf16 v[172:175], v[40:43], v[60:63], v[172:175]
    v_add_f32 v5, v5, v85
    s_waitcnt lgkmcnt(4)
    v_mfma_f32_16x16x32_bf16 v[176:179], v[44:47], v[48:51], v[176:179]
    ds_read_b64_tr_b16 v[40:41], v3 offset:6144
    ds_read_b64_tr_b16 v[42:43], v3 offset:6400
    v_mfma_f32_16x16x32_bf16 v[180:183], v[44:47], v[52:55], v[180:183]
    buffer_load_dwordx4 a[172:175], v1, s[8:11], s12 offen offset:3072
    v_mfma_f32_16x16x32_bf16 v[184:187], v[44:47], v[56:59], v[184:187]
    v_add_f32 v6, v6, v89
    v_mfma_f32_16x16x32_bf16 v[188:191], v[44:47], v[60:63], v[188:191]
    v_add_f32 v7, v7, v93
    s_waitcnt lgkmcnt(4)
    v_mfma_f32_16x16x32_bf16 v[192:195], v[32:35], v[48:51], v[192:195]
    ds_read_b64_tr_b16 v[44:45], v3 offset:7168
    ds_read_b64_tr_b16 v[46:47], v3 offset:7424
    v_mfma_f32_16x16x32_bf16 v[196:199], v[32:35], v[52:55], v[196:199]
    s_add_u32 s12, s12, 4096
    buffer_load_dwordx4 a[176:179], v1, s[8:11], s12 offen
    v_mfma_f32_16x16x32_bf16 v[200:203], v[32:35], v[56:59], v[200:203]
    v_add_f32 v4, v4, v82
    v_mfma_f32_16x16x32_bf16 v[204:207], v[32:35], v[60:63], v[204:207]
    v_add_f32 v5, v5, v86
    s_waitcnt lgkmcnt(4)
    v_mfma_f32_16x16x32_bf16 v[208:211], v[36:39], v[48:51], v[208:211]
    v_mfma_f32_16x16x32_bf16 v[212:215], v[36:39], v[52:55], v[212:215]
    buffer_load_dwordx4 a[180:183], v1, s[8:11], s12 offen offset:1024
    v_mfma_f32_16x16x32_bf16 v[216:219], v[36:39], v[56:59], v[216:219]
    v_add_f32 v6, v6, v90
    v_mfma_f32_16x16x32_bf16 v[220:223], v[36:39], v[60:63], v[220:223]
    v_add_f32 v7, v7, v94
    s_waitcnt lgkmcnt(2)
    v_mfma_f32_16x16x32_bf16 v[224:227], v[40:43], v[48:51], v[224:227]
    v_mfma_f32_16x16x32_bf16 v[228:231], v[40:43], v[52:55], v[228:231]
    buffer_load_dwordx4 a[184:187], v1, s[8:11], s12 offen offset:2048
    v_mfma_f32_16x16x32_bf16 v[232:235], v[40:43], v[56:59], v[232:235]
    v_add_f32 v4, v4, v83
    v_mfma_f32_16x16x32_bf16 v[236:239], v[40:43], v[60:63], v[236:239]
    v_add_f32 v5, v5, v87
    s_waitcnt lgkmcnt(0)
    v_mfma_f32_16x16x32_bf16 v[240:243], v[44:47], v[48:51], v[240:243]
    v_mfma_f32_16x16x32_bf16 v[244:247], v[44:47], v[52:55], v[244:247]
    buffer_load_dwordx4 a[188:191], v1, s[8:11], s12 offen offset:3072
    v_mfma_f32_16x16x32_bf16 v[248:251], v[44:47], v[56:59], v[248:251]
    v_add_f32 v6, v6, v91
    v_mfma_f32_16x16x32_bf16 v[252:255], v[44:47], v[60:63], v[252:255]
    v_add_f32 v7, v7, v95
    s_branch K2_EPI
K2_TAIL1:
    s_waitcnt lgkmcnt(0)
    ds_read_b64_tr_b16 v[32:33], v3
    ds_read_b64_tr_b16 v[34:35], v3 offset:256
    ds_read_b64_tr_b16 v[36:37], v3 offset:1024
    ds_read_b64_tr_b16 v[38:39], v3 offset:1280
    ds_read_b64_tr_b16 v[40:41], v3 offset:2048
    ds_read_b64_tr_b16 v[42:43], v3 offset:2304
    v_exp_f32 v118, v118
    v_exp_f32 v119, v119
    v_exp_f32 v120, v120
    v_exp_f32 v121, v121
    v_exp_f32 v122, v122
    v_exp_f32 v123, v123
    v_exp_f32 v124, v124
    v_exp_f32 v125, v125
    v_exp_f32 v126, v126
    v_exp_f32 v127, v127
    v_cvt_pk_bf16_f32 v48, v96, v97
    v_cvt_pk_bf16_f32 v49, v98, v99
    v_or_b32 v8, v48, v49
    v_cvt_pk_bf16_f32 v52, v100, v101
    v_cvt_pk_bf16_f32 v53, v102, v103
    v_or3_b32 v8, v52, v53, v8
    v_cvt_pk_bf16_f32 v56, v104, v105
    v_cvt_pk_bf16_f32 v57, v106, v107
    v_or3_b32 v8, v56, v57, v8
    v_cvt_pk_bf16_f32 v60, v108, v109
    v_cvt_pk_bf16_f32 v61, v110, v111
    v_or3_b32 v8, v60, v61, v8
    v_cvt_pk_bf16_f32 v50, v112, v113
    v_cvt_pk_bf16_f32 v51, v114, v115
    v_or3_b32 v8, v50, v51, v8
    v_cvt_pk_bf16_f32 v54, v116, v117
    v_cvt_pk_bf16_f32 v55, v118, v119
    v_or3_b32 v8, v54, v55, v8
    v_cvt_pk_bf16_f32 v58, v120, v121
    v_cvt_pk_bf16_f32 v59, v122, v123
    v_or3_b32 v8, v58, v59, v8
    v_cvt_pk_bf16_f32 v62, v124, v125
    v_cvt_pk_bf16_f32 v63, v126, v127
    v_or3_b32 v8, v62, v63, v8
    v_and_b32 v8, 0x40004000, v8
    v_cmp_ne_u32 vcc, 0, v8
    s_nop 1
    s_cbranch_vccnz K2_STUB_T1
K2_BACK_T1:
    s_waitcnt vmcnt(8)
    v_cmp_eq_u32 vcc, 0, v15
    s_nop 1
    s_and_b32 s14, vcc_lo, 0xff
    s_cbranch_scc1 K2_FSTUB1
K2_FBACK1:
    buffer_load_dwordx4 a[248:251], v1, s[8:11], s82 offen
    buffer_load_dwordx4 a[252:255], v1, s[8:11], s83 offen
    s_mov_b32 s12, s81
    s_waitcnt lgkmcnt(4)
    v_mfma_f32_16x16x32_bf16 a[0:3], v[32:35], v[48:51], a[0:3]
    ds_read_b64_tr_b16 v[44:45], v3 offset:3072
    ds_read_b64_tr_b16 v[46:47], v3 offset:3328
    v_mfma_f32_16x16x32_bf16 a[4:7], v[32:35], v[52:55], a[4:7]
    buffer_load_dwordx4 a[128:131], v1, s[8:11], s12 offen
    v_mfma_f32_16x16x32_bf16 a[8:11], v[32:35], v[56:59], a[8:11]
    v_add_f32 v4, v4, v96
    v_mfma_f32_16x16x32_bf16 a[12:15], v[32:35], v[60:63], a[12:15]
    v_add_f32 v5, v5, v100
    s_waitcnt lgkmcnt(4)
    v_mfma_f32_16x16x32_bf16 a[16:19], v[36:39], v[48:51], a[16:19]
    ds_read_b64_tr_b16 v[32:33], v3 offset:4096
    ds_read_b64_tr_b16 v[34:35], v3 offset:4352
    v_mfma_f32_16x16x32_bf16 a[20:23], v[36:39], v[52:55], a[20:23]
    buffer_load_dwordx4 a[132:135], v1, s[8:11], s12 offen offset:1024
    v_mfma_f32_16x16x32_bf16 a[24:27], v[36:39], v[56:59], a[24:27]
    v_add_f32 v6, v6, v104
    v_mfma_f32_16x16x32_bf16 a[28:31], v[36:39], v[60:63], a[28:31]
    v_add_f32 v7, v7, v108
    s_waitcnt lgkmcnt(4)
    v_mfma_f32_16x16x32_bf16 a[32:35], v[40:43], v[48:51], a[32:35]
    ds_read_b64_tr_b16 v[36:37], v3 offset:5120
    ds_read_b64_tr_b16 v[38:39], v3 offset:5376
    v_mfma_f32_16x16x32_bf16 a[36:39], v[40:43], v[52:55], a[36:39]
    buffer_load_dwordx4 a[136:139], v1, s[8:11], s12 offen offset:2048
    v_mfma_f32_16x16x32_bf16 a[40:43], v[40:43], v[56:59], a[40:43]
    v_add_f32 v4, v4, v97
    v_mfma_f32_16x16x32_bf16 a[44:47], v[40:43], v[60:63], a[44:47]
    v_add_f32 v5, v5, v101
    s_waitcnt lgkmcnt(4)
    v_mfma_f32_16x16x32_bf16 a[48:51], v[44:47], v[48:51], a[48:51]
    ds_read_b64_tr_b16 v[40:41], v3 offset:6144
    ds_read_b64_tr_b16 v[42:43], v3 offset:6400
    v_mfma_f32_16x16x32_bf16 a[52:55], v[44:47], v[52:55], a[52:55]
    buffer_load_dwordx4 a[140:143], v1, s[8:11], s12 offen offset:3072
    v_mfma_f32_16x16x32_bf16 a[56:59], v[44:47], v[56:59], a[56:59]
    v_add_f32 v6, v6, v105
    v_mfma_f32_16x16x32_bf16 a[60:63], v[44:47], v[60:63], a[60:63]
    v_add_f32 v7, v7, v109
    s_waitcnt lgkmcnt(4)
    v_mfma_f32_16x16x32_bf16 a[64:67], v[32:35], v[48:51], a[64:67]
    ds_read_b64_tr_b16 v[44:45], v3 offset:7168
    ds_read_b64_tr_b16 v[46:47], v3 offset:7424
    v_mfma_f32_16x16x32_bf16 a[68:71], v[32:35], v[52:55], a[68:71]
    s_add_u32 s12, s12, 4096
    buffer_load_dwordx4 a[144:147], v1, s[8:11], s12 offen
    v_mfma_f32_16x16x32_bf16 a[72:75], v[32:35], v[56:59], a[72:75]
    v_add_f32 v4, v4, v98
    v_mfma_f32_16x16x32_bf16 a[76:79], v[32:35], v[60:63], a[76:79]
    v_add_f32 v5, v5, v102
    s_add_u32 s20, s20, s22
    s_cmp_eq_u32 s20, s24
    s_cselect_b32 s28, s23, s22
    s_cselect_b32 s20, 0, s20
    v_add_u32 v3, s28, v3
    s_waitcnt lgkmcnt(4)
    v_mfma_f32_16x16x32_bf16 a[80:83], v[36:39], v[48:51], a[80:83]
    ds_read_b64_tr_b16 v[32:33], v3
    ds_read_b64_tr_b16 v[34:35], v3 offset:256
    v_mfma_f32_16x16x32_bf16 a[84:87], v[36:39], v[52:55], a[84:87]
    buffer_load_dwordx4 a[148:151], v1, s[8:11], s12 offen offset:1024
    v_mfma_f32_16x16x32_bf16 a[88:91], v[36:39], v[56:59], a[88:91]
    v_add_f32 v6, v6, v106
    v_mfma_f32_16x16x32_bf16 a[92:95], v[36:39], v[60:63], a[92:95]
    v_add_f32 v7, v7, v110
    s_waitcnt lgkmcnt(4)
    v_mfma_f32_16x16x32_bf16 a[96:99], v[40:43], v[48:51], a[96:99]
    ds_read_b64_tr_b16 v[36:37], v3 offset:1024
    ds_read_b64_tr_b16 v[38:39], v3 offset:1280
    v_mfma_f32_16x16x32_bf16 a[100:103], v[40:43], v[52:55], a[100:103]
    buffer_load_dwordx4 a[152:155], v1, s[8:11], s12 offen offset:2048
    v_mfma_f32_16x16x32_bf16 a[104:107], v[40:43], v[56:59], a[104:107]
    v_add_f32 v4, v4, v99
    v_mfma_f32_16x16x32_bf16 a[108:111], v[40:43], v[60:63], a[108:111]
    v_add_f32 v5, v5, v103
    s_waitcnt lgkmcnt(4)
    v_mfma_f32_16x16x32_bf16 a[112:115], v[44:47], v[48:51], a[112:115]
    ds_read_b64_tr_b16 v[40:41], v3 offset:2048
    ds_read_b64_tr_b16 v[42:43], v3 offset:2304
    v_mfma_f32_16x16x32_bf16 a[116:119], v[44:47], v[52:55], a[116:119]
    buffer_load_dwordx4 a[156:159], v1, s[8:11], s12 offen offset:3072
    v_mfma_f32_16x16x32_bf16 a[120:123], v[44:47], v[56:59], a[120:123]
    v_add_f32 v6, v6, v107
    v_mfma_f32_16x16x32_bf16 a[124:127], v[44:47], v[60:63], a[124:127]
    v_add_f32 v7, v7, v111
    s_waitcnt lgkmcnt(4)
    v_mfma_f32_16x16x32_bf16 v[128:131], v[32:35], v[48:51], v[128:131]
    ds_read_b64_tr_b16 v[44:45], v3 offset:3072
    ds_read_b64_tr_b16 v[46:47], v3 offset:3328
    v_mfma_f32_16x16x32_bf16 v[132:135], v[32:35], v[52:55], v[132:135]
    s_add_u32 s12, s12, 4096
    buffer_load_dwordx4 a[160:163], v1, s[8:11], s12 offen
    v_mfma_f32_16x16x32_bf16 v[136:139], v[32:35], v[56:59], v[136:139]
    v_add_f32 v4, v4, v112
    v_mfma_f32_16x16x32_bf16 v[140:143], v[32:35], v[60:63], v[140:143]
    v_add_f32 v5, v5, v116
    s_waitcnt lgkmcnt(4)
    v_mfma_f32_16x16x32_bf16 v[144:147], v[36:39], v[48:51], v[144:147]
    ds_read_b64_tr_b16 v[32:33], v3 offset:4096
    ds_read_b64_tr_b16 v[34:35], v3 offset:4352
    v_mfma_f32_16x16x32_bf16 v[148:151], v[36:39], v[52:55], v[148:151]
    buffer_load_dwordx4 a[164:167], v1, s[8:11], s12 offen offset:1024
    v_mfma_f32_16x16x32_bf16 v[152:155], v[36:39], v[56:59], v[152:155]
    v_add_f32 v6, v6, v120
    v_mfma_f32_16x16x32_bf16 v[156:159], v[36:39], v[60:63], v[156:159]
    v_add_f32 v7, v7, v124
    s_waitcnt lgkmcnt(4)
    v_mfma_f32_16x16x32_bf16 v[160:163], v[40:43], v[48:51], v[160:163]
    ds_read_b64_tr_b16 v[36:37], v3 offset:5120
    ds_read_b64_tr_b16 v[38:39], v3 offset:5376
    v_mfma_f32_16x16x32_bf16 v[164:167], v[40:43], v[52:55], v[164:167]
    buffer_load_dwordx4 a[168:171], v1, s[8:11], s12 offen offset:2048
    v_mfma_f32_16x16x32_bf16 v[168:171], v[40:43], v[56:59], v[168:171]
    v_add_f32 v4, v4, v113
    v_mfma_f32_16x16x32_bf16 v[172:175], v[40:43], v[60:63], v[172:175]
    v_add_f32 v5, v5, v117
    s_waitcnt lgkmcnt(4)
    v_mfma_f32_16x16x32_bf16 v[176:179], v[44:47], v[48:51], v[176:179]
    ds_read_b64_tr_b16 v[40:41], v3 offset:6144
    ds_read_b64_tr_b16 v[42:43], v3 offset:6400
    v_mfma_f32_16x16x32_bf16 v[180:183], v[44:47], v[52:55], v[180:183]
    buffer_load_dwordx4 a[172:175], v1, s[8:11], s12 offen offset:3072
    v_mfma_f32_16x16x32_bf16 v[184:187], v[44:47], v[56:59], v[184:187]
    v_add_f32 v6, v6, v121
    v_mfma_f32_16x16x32_bf16 v[188:191], v[44:47], v[60:63], v[188:191]
    v_add_f32 v7, v7, v125
    s_waitcnt lgkmcnt(4)
    v_mfma_f32_16x16x32_bf16 v[192:195], v[32:35], v[48:51], v[192:195]
    ds_read_b64_tr_b16 v[44:45], v3 offset:7168
    ds_read_b64_tr_b16 v[46:47], v3 offset:7424
    v_mfma_f32_16x16x32_bf16 v[196:199], v[32:35], v[52:55], v[196:199]
    s_add_u32 s12, s12, 4096
    buffer_load_dwordx4 a[176:179], v1, s[8:11], s12 offen
    v_mfma_f32_16x16x32_bf16 v[200:203], v[32:35], v[56:59], v[200:203]
    v_add_f32 v4, v4, v114
    v_mfma_f32_16x16x32_bf16 v[204:207], v[32:35], v[60:63], v[204:207]
    v_add_f32 v5, v5, v118
    s_waitcnt lgkmcnt(4)
    v_mfma_f32_16x16x32_bf16 v[208:211], v[36:39], v[48:51], v[208:211]
    v_mfma_f32_16x16x32_bf16 v[212:215], v[36:39], v[52:55], v[212:215]
    buffer_load_dwordx4 a[180:183], v1, s[8:11], s12 offen offset:1024
    v_mfma_f32_16x16x32_bf16 v[216:219], v[36:39], v[56:59], v[216:219]
    v_add_f32 v6, v6, v122
    v_mfma_f32_16x16x32_bf16 v[220:223], v[36:39], v[60:63], v[220:223]
    v_add_f32 v7, v7, v126
    s_waitcnt lgkmcnt(2)
    v_mfma_f32_16x16x32_bf16 v[224:227], v[40:43], v[48:51], v[224:227]
    v_mfma_f32_16x16x32_bf16 v[228:231], v[40:43], v[52:55], v[228:231]
    buffer_load_dwordx4 a[184:187], v1, s[8:11], s12 offen offset:2048
    v_mfma_f32_16x16x32_bf16 v[232:235], v[40:43], v[56:59], v[232:235]
    v_add_f32 v4, v4, v115
    v_mfma_f32_16x16x32_bf16 v[236:239], v[40:43], v[60:63], v[236:239]
    v_add_f32 v5, v5, v119
    s_waitcnt lgkmcnt(0)
    v_mfma_f32_16x16x32_bf16 v[240:243], v[44:47], v[48:51], v[240:243]
    v_mfma_f32_16x16x32_bf16 v[244:247], v[44:47], v[52:55], v[244:247]
    buffer_load_dwordx4 a[188:191], v1, s[8:11], s12 offen offset:3072
    v_mfma_f32_16x16x32_bf16 v[248:251], v[44:47], v[56:59], v[248:251]
    v_add_f32 v6, v6, v123
    v_mfma_f32_16x16x32_bf16 v[252:255], v[44:47], v[60:63], v[252:255]
    v_add_f32 v7, v7, v127
K2_EPI:
    s_waitcnt vmcnt(18)
    s_waitcnt lgkmcnt(0)
    v_permlane16_swap_b32 v4, v5
    v_permlane16_swap_b32 v6, v7
    v_add_f32 v4, v4, v5
    v_add_f32 v6, v6, v7
    s_nop 1
    v_permlane32_swap_b32 v4, v6
    v_add_f32 v65, v4, v6
    v_permlane16_swap_b32 v16, v20
    v_permlane16_swap_b32 v24, v28
    s_nop 1
    v_permlane32_swap_b32 v16, v24
    v_mov_b32 v64, v16
    v_and_b32 v10, 15, v0
    v_lshlrev_b32 v10, 3, v10
    v_lshrrev_b32 v9, 4, v0
    v_lshl_add_u32 v8, v9, 8, v10
    v_add_u32 v9, s26, v8
    ds_write_b64 v9, v[64:65] offset:32768
    buffer_load_dwordx4 v[32:35], v1, s[8:11], s76 offen
    buffer_load_dwordx4 v[40:43], v1, s[8:11], s76 offen offset:1024
    s_add_u32 s76, s76, 8192
    buffer_load_dwordx4 v[36:39], v1, s[8:11], s76 offen
    buffer_load_dwordx4 v[44:47], v1, s[8:11], s76 offen offset:1024
    s_add_u32 m0, s26, 32768
    s_mov_b32 exec_lo, 0xc000c000
    s_mov_b32 exec_hi, 0xc000c000
    buffer_load_dwordx4 v1, s[8:11], s72 offen lds
    buffer_load_dwordx4 v1, s[8:11], s72 offen offset:1024 lds
    s_mov_b64 exec, -1
    s_add_u32 m0, s26, 34816
    s_nop 0
    buffer_load_dwordx4 v1, s[8:11], s73 offen lds
    buffer_load_dwordx4 v1, s[8:11], s73 offen offset:1024 lds
    s_add_u32 m0, s26, 36864
    s_nop 0
    buffer_load_dwordx4 v1, s[8:11], s74 offen lds
    buffer_load_dwordx4 v1, s[8:11], s74 offen offset:1024 lds
    s_add_u32 m0, s26, 38912
    s_nop 0
    buffer_load_dwordx4 v1, s[8:11], s75 offen lds
    buffer_load_dwordx4 v1, s[8:11], s75 offen offset:1024 lds
    v_and_b32 v13, 15, v0
    v_lshlrev_b32 v13, 9, v13
    v_lshrrev_b32 v9, 4, v0
    v_lshl_add_u32 v13, v9, 5, v13
    v_and_b32 v10, 15, v0
    v_lshlrev_b32 v10, 4, v10
    v_add_u32 v9, s26, v1
    s_mov_b32 s66, 0xbdd2d3e8
    s_mov_b32 s67, 0xbdd2d3e8
    v_accvgpr_read_b32 v16, a0
    v_accvgpr_read_b32 v17, a1
    v_accvgpr_read_b32 v18, a2
    v_accvgpr_read_b32 v19, a3
    v_accvgpr_read_b32 v20, a16
    v_accvgpr_read_b32 v21, a17
    v_accvgpr_read_b32 v22, a18
    v_accvgpr_read_b32 v23, a19
    v_cvt_pk_bf16_f32 v24, v16, v17
    v_cvt_pk_bf16_f32 v25, v18, v19
    v_cvt_pk_bf16_f32 v26, v20, v21
    v_cvt_pk_bf16_f32 v27, v22, v23
    ds_write_b128 v9, v[24:27]
    v_accvgpr_read_b32 v48, a4
    v_accvgpr_read_b32 v49, a5
    v_accvgpr_read_b32 v50, a6
    s_add_u32 s12, s12, 4096
    buffer_load_dwordx4 a[192:195], v1, s[8:11], s12 offen
    v_accvgpr_read_b32 v51, a7
    v_accvgpr_read_b32 v52, a20
    v_accvgpr_read_b32 v53, a21
    v_accvgpr_read_b32 v54, a22
    v_accvgpr_read_b32 v55, a23
    v_cvt_pk_bf16_f32 v56, v48, v49
    v_cvt_pk_bf16_f32 v57, v50, v51
    v_cvt_pk_bf16_f32 v58, v52, v53
    v_cvt_pk_bf16_f32 v59, v54, v55
    ds_write_b128 v9, v[56:59] offset:1024
    v_accvgpr_read_b32 v16, a8
    v_accvgpr_read_b32 v17, a9
    v_accvgpr_read_b32 v18, a10
    v_accvgpr_read_b32 v19, a11
    v_accvgpr_read_b32 v20, a24
    v_accvgpr_read_b32 v21, a25
    buffer_load_dwordx4 a[196:199], v1, s[8:11], s12 offen offset:1024
    v_accvgpr_read_b32 v22, a26
    v_accvgpr_read_b32 v23, a27
    v_cvt_pk_bf16_f32 v24, v16, v17
    v_cvt_pk_bf16_f32 v25, v18, v19
    v_cvt_pk_bf16_f32 v26, v20, v21
    v_cvt_pk_bf16_f32 v27, v22, v23
    ds_write_b128 v9, v[24:27] offset:2048
    v_accvgpr_read_b32 v48, a12
    v_accvgpr_read_b32 v49, a13
    v_accvgpr_read_b32 v50, a14
    v_accvgpr_read_b32 v51, a15
    v_accvgpr_read_b32 v52, a28
    v_accvgpr_read_b32 v53, a29
    v_accvgpr_read_b32 v54, a30
    v_accvgpr_read_b32 v55, a31
    v_cvt_pk_bf16_f32 v56, v48, v49
    buffer_load_dwordx4 a[200:203], v1, s[8:11], s12 offen offset:2048
    v_cvt_pk_bf16_f32 v57, v50, v51
    v_cvt_pk_bf16_f32 v58, v52, v53
    v_cvt_pk_bf16_f32 v59, v54, v55
    ds_write_b128 v9, v[56:59] offset:3072
    v_accvgpr_read_b32 v16, a32
    v_accvgpr_read_b32 v17, a33
    v_accvgpr_read_b32 v18, a34
    v_accvgpr_read_b32 v19, a35
    v_accvgpr_read_b32 v20, a48
    v_accvgpr_read_b32 v21, a49
    v_accvgpr_read_b32 v22, a50
    v_accvgpr_read_b32 v23, a51
    v_cvt_pk_bf16_f32 v24, v16, v17
    v_cvt_pk_bf16_f32 v25, v18, v19
    v_cvt_pk_bf16_f32 v26, v20, v21
    v_cvt_pk_bf16_f32 v27, v22, v23
    buffer_load_dwordx4 a[204:207], v1, s[8:11], s12 offen offset:3072
    ds_write_b128 v9, v[24:27] offset:4096
    v_accvgpr_read_b32 v48, a36
    v_accvgpr_read_b32 v49, a37
    v_accvgpr_read_b32 v50, a38
    v_accvgpr_read_b32 v51, a39
    v_accvgpr_read_b32 v52, a52
    v_accvgpr_read_b32 v53, a53
    v_accvgpr_read_b32 v54, a54
    v_accvgpr_read_b32 v55, a55
    v_cvt_pk_bf16_f32 v56, v48, v49
    v_cvt_pk_bf16_f32 v57, v50, v51
    v_cvt_pk_bf16_f32 v58, v52, v53
    v_cvt_pk_bf16_f32 v59, v54, v55
    ds_write_b128 v9, v[56:59] offset:5120
    v_accvgpr_read_b32 v16, a40
    v_accvgpr_read_b32 v17, a41
    s_add_u32 s12, s12, 4096
    buffer_load_dwordx4 a[208:211], v1, s[8:11], s12 offen
    v_accvgpr_read_b32 v18, a42
    v_accvgpr_read_b32 v19, a43
    v_accvgpr_read_b32 v20, a56
    v_accvgpr_read_b32 v21, a57
    v_accvgpr_read_b32 v22, a58
    v_accvgpr_read_b32 v23, a59
    v_cvt_pk_bf16_f32 v24, v16, v17
    v_cvt_pk_bf16_f32 v25, v18, v19
    v_cvt_pk_bf16_f32 v26, v20, v21
    v_cvt_pk_bf16_f32 v27, v22, v23
    ds_write_b128 v9, v[24:27] offset:6144
    v_accvgpr_read_b32 v48, a44
    v_accvgpr_read_b32 v49, a45
    v_accvgpr_read_b32 v50, a46
    v_accvgpr_read_b32 v51, a47
    v_accvgpr_read_b32 v52, a60
    buffer_load_dwordx4 a[212:215], v1, s[8:11], s12 offen offset:1024
    v_accvgpr_read_b32 v53, a61
    v_accvgpr_read_b32 v54, a62
    v_accvgpr_read_b32 v55, a63
    v_cvt_pk_bf16_f32 v56, v48, v49
    v_cvt_pk_bf16_f32 v57, v50, v51
    v_cvt_pk_bf16_f32 v58, v52, v53
    v_cvt_pk_bf16_f32 v59, v54, v55
    ds_write_b128 v9, v[56:59] offset:7168
    v_accvgpr_read_b32 v16, a64
    v_accvgpr_read_b32 v17, a65
    v_mov_b32 v78, 0xc0135761
    v_accvgpr_read_b32 v18, a66
    s_waitcnt vmcnt(17)
    v_lshlrev_b32 v80, 16, v32
    v_accvgpr_read_b32 v19, a67
    v_and_b32 v81, 0xffff0000, v32
    v_accvgpr_read_b32 v20, a80
    v_lshlrev_b32 v82, 16, v33
    v_accvgpr_read_b32 v21, a81
    v_and_b32 v83, 0xffff0000, v33
    v_accvgpr_read_b32 v22, a82
    v_lshlrev_b32 v84, 16, v34
    v_accvgpr_read_b32 v23, a83
    v_and_b32 v85, 0xffff0000, v34
    v_cvt_pk_bf16_f32 v24, v16, v17
    v_lshlrev_b32 v86, 16, v35
    v_cvt_pk_bf16_f32 v25, v18, v19
    v_and_b32 v87, 0xffff0000, v35
    v_cvt_pk_bf16_f32 v26, v20, v21
    v_pk_mul_f32 v[112:113], v[80:81], v[80:81]
    v_cvt_pk_bf16_f32 v27, v22, v23
    v_pk_mul_f32 v[114:115], v[82:83], v[82:83]
    ds_write_b128 v9, v[24:27] offset:8192
    buffer_load_dwordx4 a[216:219], v1, s[8:11], s12 offen offset:2048
    v_pk_fma_f32 v[112:113], v[112:113], s[66:67], v[78:79] op_sel_hi:[1,1,0]
    v_accvgpr_read_b32 v48, a68
    v_pk_fma_f32 v[114:115], v[114:115], s[66:67], v[78:79] op_sel_hi:[1,1,0]
    v_accvgpr_read_b32 v49, a69
    v_pk_mul_f32 v[112:113], v[112:113], v[80:81]
    v_accvgpr_read_b32 v50, a70
    v_pk_mul_f32 v[114:115], v[114:115], v[82:83]
    v_accvgpr_read_b32 v51, a71
    v_exp_f32 v112, v112
    v_accvgpr_read_b32 v52, a84
    v_exp_f32 v113, v113
    v_accvgpr_read_b32 v53, a85
    v_exp_f32 v114, v114
    v_accvgpr_read_b32 v54, a86
    v_exp_f32 v115, v115
    v_accvgpr_read_b32 v55, a87
    v_pk_add_f32 v[112:113], v[112:113], 1.0 op_sel_hi:[1,0]
    v_cvt_pk_bf16_f32 v56, v48, v49
    v_pk_add_f32 v[114:115], v[114:115], 1.0 op_sel_hi:[1,0]
    v_cvt_pk_bf16_f32 v57, v50, v51
    v_rcp_f32 v112, v112
    v_cvt_pk_bf16_f32 v58, v52, v53
    v_rcp_f32 v113, v113
    v_cvt_pk_bf16_f32 v59, v54, v55
    buffer_load_dwordx4 a[220:223], v1, s[8:11], s12 offen offset:3072
    v_rcp_f32 v114, v114
    ds_write_b128 v9, v[56:59] offset:9216
    v_rcp_f32 v115, v115
    v_accvgpr_read_b32 v16, a72
    v_accvgpr_read_b32 v17, a73
    v_pk_mul_f32 v[80:81], v[80:81], v[112:113]
    v_accvgpr_read_b32 v18, a74
    v_pk_mul_f32 v[82:83], v[82:83], v[114:115]
    v_accvgpr_read_b32 v19, a75
    v_pk_mul_f32 v[112:113], v[84:85], v[84:85]
    v_accvgpr_read_b32 v20, a88
    v_pk_mul_f32 v[114:115], v[86:87], v[86:87]
    v_accvgpr_read_b32 v21, a89
    v_pk_fma_f32 v[112:113], v[112:113], s[66:67], v[78:79] op_sel_hi:[1,1,0]
    v_accvgpr_read_b32 v22, a90
    v_pk_fma_f32 v[114:115], v[114:115], s[66:67], v[78:79] op_sel_hi:[1,1,0]
    v_accvgpr_read_b32 v23, a91
    v_pk_mul_f32 v[112:113], v[112:113], v[84:85]
    v_cvt_pk_bf16_f32 v24, v16, v17
    v_pk_mul_f32 v[114:115], v[114:115], v[86:87]
    v_cvt_pk_bf16_f32 v25, v18, v19
    v_exp_f32 v112, v112
    v_cvt_pk_bf16_f32 v26, v20, v21
    v_exp_f32 v113, v113
    s_add_u32 s12, s12, 4096
    buffer_load_dwordx4 a[224:227], v1, s[8:11], s12 offen
    v_cvt_pk_bf16_f32 v27, v22, v23
    v_exp_f32 v114, v114
    ds_write_b128 v9, v[24:27] offset:10240
    v_exp_f32 v115, v115
    v_accvgpr_read_b32 v48, a76
    v_pk_add_f32 v[112:113], v[112:113], 1.0 op_sel_hi:[1,0]
    v_accvgpr_read_b32 v49, a77
    v_pk_add_f32 v[114:115], v[114:115], 1.0 op_sel_hi:[1,0]
    v_accvgpr_read_b32 v50, a78
    v_rcp_f32 v112, v112
    v_accvgpr_read_b32 v51, a79
    v_rcp_f32 v113, v113
    v_accvgpr_read_b32 v52, a92
    v_rcp_f32 v114, v114
    v_accvgpr_read_b32 v53, a93
    v_rcp_f32 v115, v115
    v_accvgpr_read_b32 v54, a94
    v_pk_mul_f32 v[84:85], v[84:85], v[112:113]
    v_accvgpr_read_b32 v55, a95
    v_pk_mul_f32 v[86:87], v[86:87], v[114:115]
    v_cvt_pk_bf16_f32 v56, v48, v49
    s_waitcnt vmcnt(18)
    v_lshlrev_b32 v88, 16, v36
    v_cvt_pk_bf16_f32 v57, v50, v51
    v_and_b32 v89, 0xffff0000, v36
    buffer_load_dwordx4 a[228:231], v1, s[8:11], s12 offen offset:1024
    v_cvt_pk_bf16_f32 v58, v52, v53
    v_lshlrev_b32 v90, 16, v37
    v_cvt_pk_bf16_f32 v59, v54, v55
    v_and_b32 v91, 0xffff0000, v37
    ds_write_b128 v9, v[56:59] offset:11264
    v_lshlrev_b32 v92, 16, v38
    v_accvgpr_read_b32 v16, a96
    v_accvgpr_read_b32 v17, a97
    v_and_b32 v93, 0xffff0000, v38
    v_accvgpr_read_b32 v18, a98
    v_lshlrev_b32 v94, 16, v39
    v_accvgpr_read_b32 v19, a99
    v_and_b32 v95, 0xffff0000, v39
    v_accvgpr_read_b32 v20, a112
    v_pk_mul_f32 v[112:113], v[88:89], v[88:89]
    v_accvgpr_read_b32 v21, a113
    v_pk_mul_f32 v[114:115], v[90:91], v[90:91]
    v_accvgpr_read_b32 v22, a114
    v_pk_fma_f32 v[112:113], v[112:113], s[66:67], v[78:79] op_sel_hi:[1,1,0]
    v_accvgpr_read_b32 v23, a115
    v_pk_fma_f32 v[114:115], v[114:115], s[66:67], v[78:79] op_sel_hi:[1,1,0]
    v_cvt_pk_bf16_f32 v24, v16, v17
    v_pk_mul_f32 v[112:113], v[112:113], v[88:89]
    v_cvt_pk_bf16_f32 v25, v18, v19
    buffer_load_dwordx4 a[232:235], v1, s[8:11], s12 offen offset:2048
    v_pk_mul_f32 v[114:115], v[114:115], v[90:91]
    v_cvt_pk_bf16_f32 v26, v20, v21
    v_exp_f32 v112, v112
    v_cvt_pk_bf16_f32 v27, v22, v23
    v_exp_f32 v113, v113
    ds_write_b128 v9, v[24:27] offset:12288
    v_exp_f32 v114, v114
    v_accvgpr_read_b32 v48, a100
    v_exp_f32 v115, v115
    v_accvgpr_read_b32 v49, a101
    v_pk_add_f32 v[112:113], v[112:113], 1.0 op_sel_hi:[1,0]
    v_accvgpr_read_b32 v50, a102
    v_pk_add_f32 v[114:115], v[114:115], 1.0 op_sel_hi:[1,0]
    v_accvgpr_read_b32 v51, a103
    v_rcp_f32 v112, v112
    v_accvgpr_read_b32 v52, a116
    v_rcp_f32 v113, v113
    v_accvgpr_read_b32 v53, a117
    v_rcp_f32 v114, v114
    v_accvgpr_read_b32 v54, a118
    v_rcp_f32 v115, v115
    v_accvgpr_read_b32 v55, a119
    v_pk_mul_f32 v[88:89], v[88:89], v[112:113]
    v_cvt_pk_bf16_f32 v56, v48, v49
    buffer_load_dwordx4 a[236:239], v1, s[8:11], s12 offen offset:3072
    v_pk_mul_f32 v[90:91], v[90:91], v[114:115]
    v_cvt_pk_bf16_f32 v57, v50, v51
    v_pk_mul_f32 v[112:113], v[92:93], v[92:93]
    v_cvt_pk_bf16_f32 v58, v52, v53
    v_pk_mul_f32 v[114:115], v[94:95], v[94:95]
    v_cvt_pk_bf16_f32 v59, v54, v55
    v_pk_fma_f32 v[112:113], v[112:113], s[66:67], v[78:79] op_sel_hi:[1,1,0]
    ds_write_b128 v9, v[56:59] offset:13312
    v_pk_fma_f32 v[114:115], v[114:115], s[66:67], v[78:79] op_sel_hi:[1,1,0]
    v_accvgpr_read_b32 v16, a104
    v_accvgpr_read_b32 v17, a105
    v_pk_mul_f32 v[112:113], v[112:113], v[92:93]
    v_accvgpr_read_b32 v18, a106
    v_pk_mul_f32 v[114:115], v[114:115], v[94:95]
    v_accvgpr_read_b32 v19, a107
    v_exp_f32 v112, v112
    v_accvgpr_read_b32 v20, a120
    v_exp_f32 v113, v113
    v_accvgpr_read_b32 v21, a121
    v_exp_f32 v114, v114
    v_accvgpr_read_b32 v22, a122
    v_exp_f32 v115, v115
    v_accvgpr_read_b32 v23, a123
    v_pk_add_f32 v[112:113], v[112:113], 1.0 op_sel_hi:[1,0]
    s_add_u32 s12, s12, 4096
    buffer_load_dwordx4 a[240:243], v1, s[8:11], s12 offen
    v_cvt_pk_bf16_f32 v24, v16, v17
    v_pk_add_f32 v[114:115], v[114:115], 1.0 op_sel_hi:[1,0]
    v_cvt_pk_bf16_f32 v25, v18, v19
    v_rcp_f32 v112, v112
    v_cvt_pk_bf16_f32 v26, v20, v21
    v_rcp_f32 v113, v113
    v_cvt_pk_bf16_f32 v27, v22, v23
    v_rcp_f32 v114, v114
    s_waitcnt lgkmcnt(12)
    ds_write_b128 v9, v[24:27] offset:14336
    v_rcp_f32 v115, v115
    v_accvgpr_read_b32 v48, a108
    v_pk_mul_f32 v[92:93], v[92:93], v[112:113]
    v_accvgpr_read_b32 v49, a109
    v_pk_mul_f32 v[94:95], v[94:95], v[114:115]
    v_accvgpr_read_b32 v50, a110
    v_lshlrev_b32 v96, 16, v40
    v_accvgpr_read_b32 v51, a111
    v_and_b32 v97, 0xffff0000, v40
    v_accvgpr_read_b32 v52, a124
    v_lshlrev_b32 v98, 16, v41
    v_accvgpr_read_b32 v53, a125
    v_and_b32 v99, 0xffff0000, v41
    v_accvgpr_read_b32 v54, a126
    v_lshlrev_b32 v100, 16, v42
    buffer_load_dwordx4 a[244:247], v1, s[8:11], s12 offen offset:1024
    v_accvgpr_read_b32 v55, a127
    v_and_b32 v101, 0xffff0000, v42
    v_cvt_pk_bf16_f32 v56, v48, v49
    v_lshlrev_b32 v102, 16, v43
    v_cvt_pk_bf16_f32 v57, v50, v51
    v_and_b32 v103, 0xffff0000, v43
    v_cvt_pk_bf16_f32 v58, v52, v53
    v_pk_mul_f32 v[112:113], v[96:97], v[96:97]
    v_cvt_pk_bf16_f32 v59, v54, v55
    v_pk_mul_f32 v[114:115], v[98:99], v[98:99]
    ds_write_b128 v9, v[56:59] offset:15360
    v_pk_fma_f32 v[112:113], v[112:113], s[66:67], v[78:79] op_sel_hi:[1,1,0]
    buffer_load_dwordx4 a[248:251], v1, s[8:11], s12 offen offset:2048
    buffer_load_dwordx4 a[252:255], v1, s[8:11], s12 offen offset:3072
    v_cvt_pk_bf16_f32 v24, v128, v129
    v_pk_fma_f32 v[114:115], v[114:115], s[66:67], v[78:79] op_sel_hi:[1,1,0]
    v_cvt_pk_bf16_f32 v25, v130, v131
    v_cvt_pk_bf16_f32 v26, v144, v145
    v_pk_mul_f32 v[112:113], v[112:113], v[96:97]
    v_cvt_pk_bf16_f32 v27, v146, v147
    v_pk_mul_f32 v[114:115], v[114:115], v[98:99]
    ds_write_b128 v9, v[24:27] offset:16384
    v_exp_f32 v112, v112
    v_cvt_pk_bf16_f32 v56, v132, v133
    v_exp_f32 v113, v113
    v_cvt_pk_bf16_f32 v57, v134, v135
    v_exp_f32 v114, v114
    v_cvt_pk_bf16_f32 v58, v148, v149
    v_exp_f32 v115, v115
    v_cvt_pk_bf16_f32 v59, v150, v151
    v_pk_add_f32 v[112:113], v[112:113], 1.0 op_sel_hi:[1,0]
    s_waitcnt lgkmcnt(12)
    ds_write_b128 v9, v[56:59] offset:17408
    v_pk_add_f32 v[114:115], v[114:115], 1.0 op_sel_hi:[1,0]
    v_cvt_pk_bf16_f32 v24, v136, v137
    v_rcp_f32 v112, v112
    v_cvt_pk_bf16_f32 v25, v138, v139
    buffer_load_dwordx4 a[0:3], v1, s[8:11], s79 offen
    v_rcp_f32 v113, v113
    v_cvt_pk_bf16_f32 v26, v152, v153
    v_rcp_f32 v114, v114
    v_cvt_pk_bf16_f32 v27, v154, v155
    v_rcp_f32 v115, v115
    ds_write_b128 v9, v[24:27] offset:18432
    v_pk_mul_f32 v[96:97], v[96:97], v[112:113]
    v_cvt_pk_bf16_f32 v56, v140, v141
    v_pk_mul_f32 v[98:99], v[98:99], v[114:115]
    v_cvt_pk_bf16_f32 v57, v142, v143
    v_pk_mul_f32 v[112:113], v[100:101], v[100:101]
    v_cvt_pk_bf16_f32 v58, v156, v157
    v_pk_mul_f32 v[114:115], v[102:103], v[102:103]
    v_cvt_pk_bf16_f32 v59, v158, v159
    v_pk_fma_f32 v[112:113], v[112:113], s[66:67], v[78:79] op_sel_hi:[1,1,0]
    ds_write_b128 v9, v[56:59] offset:19456
    v_pk_fma_f32 v[114:115], v[114:115], s[66:67], v[78:79] op_sel_hi:[1,1,0]
    v_cvt_pk_bf16_f32 v24, v160, v161
    v_pk_mul_f32 v[112:113], v[112:113], v[100:101]
    v_cvt_pk_bf16_f32 v25, v162, v163
    v_pk_mul_f32 v[114:115], v[114:115], v[102:103]
    v_cvt_pk_bf16_f32 v26, v176, v177
    buffer_load_dwordx4 a[4:7], v1, s[8:11], s79 offen offset:1024
    v_exp_f32 v112, v112
    v_cvt_pk_bf16_f32 v27, v178, v179
    v_exp_f32 v113, v113
    s_waitcnt lgkmcnt(12)
    ds_write_b128 v9, v[24:27] offset:20480
    v_exp_f32 v114, v114
    v_cvt_pk_bf16_f32 v56, v164, v165
    v_exp_f32 v115, v115
    v_cvt_pk_bf16_f32 v57, v166, v167
    v_pk_add_f32 v[112:113], v[112:113], 1.0 op_sel_hi:[1,0]
    v_cvt_pk_bf16_f32 v58, v180, v181
    v_cvt_pk_bf16_f32 v59, v182, v183
    v_pk_add_f32 v[114:115], v[114:115], 1.0 op_sel_hi:[1,0]
    ds_write_b128 v9, v[56:59] offset:21504
    v_rcp_f32 v112, v112
    v_cvt_pk_bf16_f32 v24, v168, v169
    v_rcp_f32 v113, v113
    v_cvt_pk_bf16_f32 v25, v170, v171
    v_rcp_f32 v114, v114
    v_cvt_pk_bf16_f32 v26, v184, v185
    v_rcp_f32 v115, v115
    v_cvt_pk_bf16_f32 v27, v186, v187
    v_pk_mul_f32 v[100:101], v[100:101], v[112:113]
    buffer_load_dwordx4 a[8:11], v1, s[8:11], s79 offen offset:2048
    ds_write_b128 v9, v[24:27] offset:22528
    v_pk_mul_f32 v[102:103], v[102:103], v[114:115]
    v_cvt_pk_bf16_f32 v56, v172, v173
    s_waitcnt vmcnt(27)
    v_lshlrev_b32 v104, 16, v44
    v_cvt_pk_bf16_f32 v57, v174, v175
    v_and_b32 v105, 0xffff0000, v44
    v_cvt_pk_bf16_f32 v58, v188, v189
    v_lshlrev_b32 v106, 16, v45
    v_cvt_pk_bf16_f32 v59, v190, v191
    v_and_b32 v107, 0xffff0000, v45
    s_waitcnt lgkmcnt(12)
    ds_write_b128 v9, v[56:59] offset:23552
    v_lshlrev_b32 v108, 16, v46
    v_cvt_pk_bf16_f32 v24, v192, v193
    v_and_b32 v109, 0xffff0000, v46
    v_cvt_pk_bf16_f32 v25, v194, v195
    v_lshlrev_b32 v110, 16, v47
    v_cvt_pk_bf16_f32 v26, v208, v209
    v_and_b32 v111, 0xffff0000, v47
    v_cvt_pk_bf16_f32 v27, v210, v211
    v_pk_mul_f32 v[112:113], v[104:105], v[104:105]
    ds_write_b128 v9, v[24:27] offset:24576
    v_pk_mul_f32 v[114:115], v[106:107], v[106:107]
    buffer_load_dwordx4 a[12:15], v1, s[8:11], s79 offen offset:3072
    v_cvt_pk_bf16_f32 v56, v196, v197
    v_pk_fma_f32 v[112:113], v[112:113], s[66:67], v[78:79] op_sel_hi:[1,1,0]
    v_cvt_pk_bf16_f32 v57, v198, v199
    v_pk_fma_f32 v[114:115], v[114:115], s[66:67], v[78:79] op_sel_hi:[1,1,0]
    v_cvt_pk_bf16_f32 v58, v212, v213
    v_pk_mul_f32 v[112:113], v[112:113], v[104:105]
    v_cvt_pk_bf16_f32 v59, v214, v215
    v_pk_mul_f32 v[114:115], v[114:115], v[106:107]
    ds_write_b128 v9, v[56:59] offset:25600
    v_exp_f32 v112, v112
    v_cvt_pk_bf16_f32 v24, v200, v201
    v_exp_f32 v113, v113
    v_cvt_pk_bf16_f32 v25, v202, v203
    v_exp_f32 v114, v114
    v_cvt_pk_bf16_f32 v26, v216, v217
    v_exp_f32 v115, v115
    v_cvt_pk_bf16_f32 v27, v218, v219
    s_waitcnt lgkmcnt(12)
    ds_write_b128 v9, v[24:27] offset:26624
    v_pk_add_f32 v[112:113], v[112:113], 1.0 op_sel_hi:[1,0]
    v_cvt_pk_bf16_f32 v56, v204, v205
    v_pk_add_f32 v[114:115], v[114:115], 1.0 op_sel_hi:[1,0]
    v_cvt_pk_bf16_f32 v57, v206, v207
    s_add_u32 s79, s79, 4096
    buffer_load_dwordx4 a[16:19], v1, s[8:11], s79 offen
    v_rcp_f32 v112, v112
    v_cvt_pk_bf16_f32 v58, v220, v221
    v_rcp_f32 v113, v113
    v_cvt_pk_bf16_f32 v59, v222, v223
    v_rcp_f32 v114, v114
    ds_write_b128 v9, v[56:59] offset:27648
    v_rcp_f32 v115, v115
    v_cvt_pk_bf16_f32 v24, v224, v225
    v_pk_mul_f32 v[104:105], v[104:105], v[112:113]
    v_cvt_pk_bf16_f32 v25, v226, v227
    v_pk_mul_f32 v[106:107], v[106:107], v[114:115]
    v_cvt_pk_bf16_f32 v26, v240, v241
    v_pk_mul_f32 v[112:113], v[108:109], v[108:109]
    v_cvt_pk_bf16_f32 v27, v242, v243
    v_pk_mul_f32 v[114:115], v[110:111], v[110:111]
    ds_write_b128 v9, v[24:27] offset:28672
    v_pk_fma_f32 v[112:113], v[112:113], s[66:67], v[78:79] op_sel_hi:[1,1,0]
    v_cvt_pk_bf16_f32 v56, v228, v229
    v_pk_fma_f32 v[114:115], v[114:115], s[66:67], v[78:79] op_sel_hi:[1,1,0]
    v_cvt_pk_bf16_f32 v57, v230, v231
    v_pk_mul_f32 v[112:113], v[112:113], v[108:109]
    v_cvt_pk_bf16_f32 v58, v244, v245
    buffer_load_dwordx4 a[20:23], v1, s[8:11], s79 offen offset:1024
    v_pk_mul_f32 v[114:115], v[114:115], v[110:111]
    v_cvt_pk_bf16_f32 v59, v246, v247
    v_exp_f32 v112, v112
    s_waitcnt lgkmcnt(12)
    ds_write_b128 v9, v[56:59] offset:29696
    v_exp_f32 v113, v113
    v_cvt_pk_bf16_f32 v24, v232, v233
    v_exp_f32 v114, v114
    v_cvt_pk_bf16_f32 v25, v234, v235
    v_exp_f32 v115, v115
    v_cvt_pk_bf16_f32 v26, v248, v249
    v_pk_add_f32 v[112:113], v[112:113], 1.0 op_sel_hi:[1,0]
    v_cvt_pk_bf16_f32 v27, v250, v251
    v_pk_add_f32 v[114:115], v[114:115], 1.0 op_sel_hi:[1,0]
    ds_write_b128 v9, v[24:27] offset:30720
    v_rcp_f32 v112, v112
    v_cvt_pk_bf16_f32 v56, v236, v237
    v_rcp_f32 v113, v113
    v_cvt_pk_bf16_f32 v57, v238, v239
    v_rcp_f32 v114, v114
    v_cvt_pk_bf16_f32 v58, v252, v253
    v_rcp_f32 v115, v115
    v_cvt_pk_bf16_f32 v59, v254, v255
    buffer_load_dwordx4 a[24:27], v1, s[8:11], s79 offen offset:2048
    v_pk_mul_f32 v[108:109], v[108:109], v[112:113]
    ds_write_b128 v9, v[56:59] offset:31744
    v_pk_mul_f32 v[110:111], v[110:111], v[114:115]
    buffer_load_dwordx4 a[28:31], v1, s[8:11], s79 offen offset:3072
    s_add_u32 s79, s79, 4096
    buffer_load_dwordx4 a[32:35], v1, s[8:11], s79 offen
    buffer_load_dwordx4 a[36:39], v1, s[8:11], s79 offen offset:1024
    v_lshrrev_b32 v12, 4, v0
    v_and_b32 v11, 15, v0
    v_lshlrev_b32 v12, 2, v12
    v_sub_u32 v11, v11, v12
    v_mov_b32 v26, 0xffff
    v_mov_b32 v27, 0xffff0000
    v_cmp_eq_u32 vcc, 0, v11
    s_nop 1
    v_cndmask_b32 v24, 0, v26, vcc
    v_cmp_eq_u32 vcc, 1, v11
    s_nop 1
    v_cndmask_b32 v28, 0, v27, vcc
    v_or_b32 v24, v24, v28
    v_cmp_eq_u32 vcc, 2, v11
    s_nop 1
    v_cndmask_b32 v25, 0, v26, vcc
    v_cmp_eq_u32 vcc, 3, v11
    s_nop 1
    v_cndmask_b32 v28, 0, v27, vcc
    v_or_b32 v25, v25, v28
    v_and_b32 v16, 0x3f803f80, v24
    v_and_b32 v17, 0x3f803f80, v25
    v_mov_b32 v18, 0
    v_mov_b32 v19, 0
    v_mov_b32 v20, 0
    v_mov_b32 v21, 0
    v_mov_b32 v22, v16
    v_mov_b32 v23, v17
    v_add_u32 v11, s88, v1
    v_add_u32 v12, s89, v1
    v_add_u32 v28, 40960, v11
    v_add_u32 v29, 40960, v12
    v_add_u32 v30, 81920, v11
    v_add_u32 v31, 81920, v12
    v_add_u32 v26, 122880, v11
    v_add_u32 v27, 122880, v12
    v_add_u32 v9, 32768, v8
    s_waitcnt lgkmcnt(0)
    s_barrier
    ds_read_b64 v[66:67], v9
    v_add_u32 v9, 40960, v9
    ds_read_b64 v[68:69], v9
    v_add_u32 v9, 40960, v9
    ds_read_b64 v[70:71], v9
    v_add_u32 v9, 40960, v9
    ds_read_b64 v[72:73], v9
    ds_read_b128 v[48:51], v12 offset:2048
    ds_read_b128 v[52:55], v12 offset:3072
    ds_read_b128 v[56:59], v11
    s_waitcnt lgkmcnt(5)
    v_min_f32 v74, v66, v68
    s_waitcnt lgkmcnt(3)
    v_min3_f32 v74, v74, v70, v72
    v_sub_f32 v66, v74, v66
    v_sub_f32 v68, v74, v68
    v_sub_f32 v70, v74, v70
    v_sub_f32 v72, v74, v72
    v_min_f32 v76, v66, v68
    v_min3_f32 v76, v76, v70, v72
    v_exp_f32 v66, v66
    v_exp_f32 v68, v68
    v_exp_f32 v70, v70
    v_exp_f32 v72, v72
    v_mul_f32 v75, v66, v67
    v_fmac_f32 v75, v68, v69
    v_fmac_f32 v75, v70, v71
    v_fmac_f32 v75, v72, v73
    v_mov_b32 v2, v74
    v_mov_b32 v3, v75
    v_cmp_neq_f32 vcc, 0, v76
    s_nop 1
    s_cbranch_vccnz K2_RSCALED
    s_waitcnt lgkmcnt(2)
    v_mfma_f32_16x16x32_bf16 v[136:139], v[16:19], v[48:51], 0
    ds_read_b128 v[60:63], v11 offset:1024
    v_mfma_f32_16x16x32_bf16 v[152:155], v[20:23], v[48:51], 0
    s_waitcnt lgkmcnt(2)
    v_mfma_f32_16x16x32_bf16 v[140:143], v[16:19], v[52:55], 0
    ds_read_b128 v[48:51], v12 offset:6144
    v_mfma_f32_16x16x32_bf16 v[156:159], v[20:23], v[52:55], 0
    buffer_load_dwordx4 v[192:195], v10, s[8:11], s80 offen
    s_waitcnt lgkmcnt(2)
    v_mfma_f32_16x16x32_bf16 v[128:131], v[16:19], v[56:59], 0
    ds_read_b128 v[52:55], v12 offset:7168
    v_mfma_f32_16x16x32_bf16 v[144:147], v[20:23], v[56:59], 0
    s_waitcnt lgkmcnt(2)
    v_mfma_f32_16x16x32_bf16 v[132:135], v[16:19], v[60:63], 0
    ds_read_b128 v[56:59], v11 offset:4096
    v_mfma_f32_16x16x32_bf16 v[148:151], v[20:23], v[60:63], 0
    buffer_load_dwordx4 v[196:199], v10, s[8:11], s80 offen offset:1024
    s_waitcnt lgkmcnt(2)
    v_mfma_f32_16x16x32_bf16 v[168:171], v[16:19], v[48:51], 0
    ds_read_b128 v[60:63], v11 offset:5120
    v_mfma_f32_16x16x32_bf16 v[184:187], v[20:23], v[48:51], 0
    s_waitcnt lgkmcnt(2)
    v_mfma_f32_16x16x32_bf16 v[172:175], v[16:19], v[52:55], 0
    ds_read_b128 v[48:51], v29 offset:2048
    v_mfma_f32_16x16x32_bf16 v[188:191], v[20:23], v[52:55], 0
    buffer_load_dwordx4 v[200:203], v10, s[8:11], s80 offen offset:2048
    s_waitcnt lgkmcnt(2)
    v_mfma_f32_16x16x32_bf16 v[160:163], v[16:19], v[56:59], 0
    ds_read_b128 v[52:55], v29 offset:3072
    v_mfma_f32_16x16x32_bf16 v[176:179], v[20:23], v[56:59], 0
    s_waitcnt lgkmcnt(2)
    v_mfma_f32_16x16x32_bf16 v[164:167], v[16:19], v[60:63], 0
    ds_read_b128 v[56:59], v28
    v_mfma_f32_16x16x32_bf16 v[180:183], v[20:23], v[60:63], 0
    buffer_load_dwordx4 v[204:207], v10, s[8:11], s80 offen offset:3072
    s_waitcnt lgkmcnt(2)
    v_mfma_f32_16x16x32_bf16 v[136:139], v[16:19], v[48:51], v[136:139]
    ds_read_b128 v[60:63], v28 offset:1024
    v_mfma_f32_16x16x32_bf16 v[152:155], v[20:23], v[48:51], v[152:155]
    s_waitcnt lgkmcnt(2)
    v_mfma_f32_16x16x32_bf16 v[140:143], v[16:19], v[52:55], v[140:143]
    ds_read_b128 v[48:51], v29 offset:6144
    v_mfma_f32_16x16x32_bf16 v[156:159], v[20:23], v[52:55], v[156:159]
    s_add_u32 s80, s80, 4096
    buffer_load_dwordx4 v[208:211], v10, s[8:11], s80 offen
    s_waitcnt lgkmcnt(2)
    v_mfma_f32_16x16x32_bf16 v[128:131], v[16:19], v[56:59], v[128:131]
    ds_read_b128 v[52:55], v29 offset:7168
    v_mfma_f32_16x16x32_bf16 v[144:147], v[20:23], v[56:59], v[144:147]
    s_waitcnt lgkmcnt(2)
    v_mfma_f32_16x16x32_bf16 v[132:135], v[16:19], v[60:63], v[132:135]
    ds_read_b128 v[56:59], v28 offset:4096
    v_mfma_f32_16x16x32_bf16 v[148:151], v[20:23], v[60:63], v[148:151]
    buffer_load_dwordx4 a[40:43], v1, s[8:11], s79 offen offset:2048
    s_waitcnt lgkmcnt(2)
    v_mfma_f32_16x16x32_bf16 v[168:171], v[16:19], v[48:51], v[168:171]
    ds_read_b128 v[60:63], v28 offset:5120
    v_mfma_f32_16x16x32_bf16 v[184:187], v[20:23], v[48:51], v[184:187]
    s_waitcnt lgkmcnt(2)
    v_mfma_f32_16x16x32_bf16 v[172:175], v[16:19], v[52:55], v[172:175]
    ds_read_b128 v[48:51], v31 offset:2048
    v_mfma_f32_16x16x32_bf16 v[188:191], v[20:23], v[52:55], v[188:191]
    buffer_load_dwordx4 a[44:47], v1, s[8:11], s79 offen offset:3072
    s_waitcnt lgkmcnt(2)
    v_mfma_f32_16x16x32_bf16 v[160:163], v[16:19], v[56:59], v[160:163]
    ds_read_b128 v[52:55], v31 offset:3072
    v_mfma_f32_16x16x32_bf16 v[176:179], v[20:23], v[56:59], v[176:179]
    s_waitcnt lgkmcnt(2)
    v_mfma_f32_16x16x32_bf16 v[164:167], v[16:19], v[60:63], v[164:167]
    ds_read_b128 v[56:59], v30
    v_mfma_f32_16x16x32_bf16 v[180:183], v[20:23], v[60:63], v[180:183]
    s_add_u32 s79, s79, 4096
    buffer_load_dwordx4 a[48:51], v1, s[8:11], s79 offen
    s_waitcnt lgkmcnt(2)
    v_mfma_f32_16x16x32_bf16 v[136:139], v[16:19], v[48:51], v[136:139]
    ds_read_b128 v[60:63], v30 offset:1024
    v_mfma_f32_16x16x32_bf16 v[152:155], v[20:23], v[48:51], v[152:155]
    s_waitcnt lgkmcnt(2)
    v_mfma_f32_16x16x32_bf16 v[140:143], v[16:19], v[52:55], v[140:143]
    ds_read_b128 v[48:51], v31 offset:6144
    v_mfma_f32_16x16x32_bf16 v[156:159], v[20:23], v[52:55], v[156:159]
    buffer_load_dwordx4 a[52:55], v1, s[8:11], s79 offen offset:1024
    s_waitcnt lgkmcnt(2)
    v_mfma_f32_16x16x32_bf16 v[128:131], v[16:19], v[56:59], v[128:131]
    ds_read_b128 v[52:55], v31 offset:7168
    v_mfma_f32_16x16x32_bf16 v[144:147], v[20:23], v[56:59], v[144:147]
    s_waitcnt lgkmcnt(2)
    v_mfma_f32_16x16x32_bf16 v[132:135], v[16:19], v[60:63], v[132:135]
    ds_read_b128 v[56:59], v30 offset:4096
    v_mfma_f32_16x16x32_bf16 v[148:151], v[20:23], v[60:63], v[148:151]
    buffer_load_dwordx4 a[56:59], v1, s[8:11], s79 offen offset:2048
    s_waitcnt lgkmcnt(2)
    v_mfma_f32_16x16x32_bf16 v[168:171], v[16:19], v[48:51], v[168:171]
    ds_read_b128 v[60:63], v30 offset:5120
    v_mfma_f32_16x16x32_bf16 v[184:187], v[20:23], v[48:51], v[184:187]
    s_waitcnt lgkmcnt(2)
    v_mfma_f32_16x16x32_bf16 v[172:175], v[16:19], v[52:55], v[172:175]
    ds_read_b128 v[48:51], v27 offset:2048
    v_mfma_f32_16x16x32_bf16 v[188:191], v[20:23], v[52:55], v[188:191]
    buffer_load_dwordx4 a[60:63], v1, s[8:11], s79 offen offset:3072
    s_waitcnt lgkmcnt(2)
    v_mfma_f32_16x16x32_bf16 v[160:163], v[16:19], v[56:59], v[160:163]
    ds_read_b128 v[52:55], v27 offset:3072
    v_mfma_f32_16x16x32_bf16 v[176:179], v[20:23], v[56:59], v[176:179]
    s_waitcnt lgkmcnt(2)
    v_mfma_f32_16x16x32_bf16 v[164:167], v[16:19], v[60:63], v[164:167]
    ds_read_b128 v[56:59], v26
    v_mfma_f32_16x16x32_bf16 v[180:183], v[20:23], v[60:63], v[180:183]
    s_add_u32 s79, s79, 4096
    buffer_load_dwordx4 a[64:67], v1, s[8:11], s79 offen
    s_waitcnt lgkmcnt(2)
    v_mfma_f32_16x16x32_bf16 v[136:139], v[16:19], v[48:51], v[136:139]
    ds_read_b128 v[60:63], v26 offset:1024
    v_mfma_f32_16x16x32_bf16 v[152:155], v[20:23], v[48:51], v[152:155]
    s_waitcnt lgkmcnt(2)
    v_mfma_f32_16x16x32_bf16 v[140:143], v[16:19], v[52:55], v[140:143]
    ds_read_b128 v[48:51], v27 offset:6144
    v_mfma_f32_16x16x32_bf16 v[156:159], v[20:23], v[52:55], v[156:159]
    buffer_load_dwordx4 a[68:71], v1, s[8:11], s79 offen offset:1024
    s_waitcnt lgkmcnt(2)
    v_mfma_f32_16x16x32_bf16 v[128:131], v[16:19], v[56:59], v[128:131]
    ds_read_b128 v[52:55], v27 offset:7168
    v_mfma_f32_16x16x32_bf16 v[144:147], v[20:23], v[56:59], v[144:147]
    s_waitcnt lgkmcnt(2)
    v_mfma_f32_16x16x32_bf16 v[132:135], v[16:19], v[60:63], v[132:135]
    ds_read_b128 v[56:59], v26 offset:4096
    v_mfma_f32_16x16x32_bf16 v[148:151], v[20:23], v[60:63], v[148:151]
    buffer_load_dwordx4 a[72:75], v1, s[8:11], s79 offen offset:2048
    s_waitcnt lgkmcnt(2)
    v_mfma_f32_16x16x32_bf16 v[168:171], v[16:19], v[48:51], v[168:171]
    ds_read_b128 v[60:63], v26 offset:5120
    v_mfma_f32_16x16x32_bf16 v[184:187], v[20:23], v[48:51], v[184:187]
    s_waitcnt lgkmcnt(2)
    v_mfma_f32_16x16x32_bf16 v[172:175], v[16:19], v[52:55], v[172:175]
    v_mfma_f32_16x16x32_bf16 v[188:191], v[20:23], v[52:55], v[188:191]
    buffer_load_dwordx4 a[76:79], v1, s[8:11], s79 offen offset:3072
    s_waitcnt lgkmcnt(1)
    v_mfma_f32_16x16x32_bf16 v[160:163], v[16:19], v[56:59], v[160:163]
    v_mfma_f32_16x16x32_bf16 v[176:179], v[20:23], v[56:59], v[176:179]
    s_waitcnt lgkmcnt(0)
    v_mfma_f32_16x16x32_bf16 v[164:167], v[16:19], v[60:63], v[164:167]
    v_mfma_f32_16x16x32_bf16 v[180:183], v[20:23], v[60:63], v[180:183]
    s_add_u32 s79, s79, 4096
    buffer_load_dwordx4 a[80:83], v1, s[8:11], s79 offen
K2_RJOIN:
    v_and_b32 v114, 15, v0
    v_lshrrev_b32 v115, 4, v0
    v_lshlrev_b32 v115, 8, v115
    v_add_u32 v115, s26, v115
    v_add_u32 v115, 32768, v115
    v_add_u32 v112, 14, v114
    v_lshrrev_b32 v116, 4, v112
    v_lshlrev_b32 v116, 11, v116
    v_and_b32 v112, 15, v112
    v_lshl_add_u32 v116, v112, 4, v116
    v_add_u32 v116, v116, v115
    v_add_u32 v112, 15, v114
    v_lshrrev_b32 v117, 4, v112
    v_lshlrev_b32 v117, 11, v117
    v_and_b32 v112, 15, v112
    v_lshl_add_u32 v117, v112, 4, v117
    v_add_u32 v117, v117, v115
    v_add_u32 v112, 16, v114
    v_lshrrev_b32 v118, 4, v112
    v_lshlrev_b32 v118, 11, v118
    v_and_b32 v112, 15, v112
    v_lshl_add_u32 v118, v112, 4, v118
    v_add_u32 v118, v118, v115
    v_add_u32 v112, 17, v114
    v_lshrrev_b32 v119, 4, v112
    v_lshlrev_b32 v119, 11, v119
    v_and_b32 v112, 15, v112
    v_lshl_add_u32 v119, v112, 4, v119
    v_add_u32 v119, v119, v115
    v_add_u32 v112, 18, v114
    v_lshrrev_b32 v113, 4, v112
    v_lshlrev_b32 v113, 11, v113
    v_and_b32 v112, 15, v112
    v_lshl_add_u32 v113, v112, 4, v113
    v_add_u32 v113, v113, v115
    s_waitcnt vmcnt(42)
    ds_read_b128 v[228:231], v116
    ds_read_b128 v[232:235], v116 offset:2048
    ds_read_b128 v[236:239], v117
    ds_read_b128 v[240:243], v117 offset:2048
    ds_read_b128 v[244:247], v118
    ds_read_b128 v[248:251], v118 offset:2048
    ds_read_b128 v[252:255], v119
    ds_read_b128 v[120:123], v119 offset:2048
    ds_read_b128 v[124:127], v113
    ds_read_b128 v[64:67], v113 offset:2048
    v_cvt_pk_bf16_f32 v48, v136, v137
    v_cvt_pk_bf16_f32 v49, v138, v139
    v_cvt_pk_bf16_f32 v50, v152, v153
    v_cvt_pk_bf16_f32 v51, v154, v155
    buffer_store_dwordx4 v[48:51], v1, s[8:11], s84 offen sc0 sc1
    v_cvt_pk_bf16_f32 v52, v140, v141
    v_cvt_pk_bf16_f32 v53, v142, v143
    v_cvt_pk_bf16_f32 v54, v156, v157
    v_cvt_pk_bf16_f32 v55, v158, v159
    buffer_store_dwordx4 v[52:55], v1, s[8:11], s84 offen offset:1024 sc0 sc1
    v_cvt_pk_bf16_f32 v56, v168, v169
    v_cvt_pk_bf16_f32 v57, v170, v171
    v_cvt_pk_bf16_f32 v58, v184, v185
    v_cvt_pk_bf16_f32 v59, v186, v187
    buffer_store_dwordx4 v[56:59], v1, s[8:11], s84 offen offset:2048 sc0 sc1
    v_cvt_pk_bf16_f32 v60, v172, v173
    v_cvt_pk_bf16_f32 v61, v174, v175
    v_cvt_pk_bf16_f32 v62, v188, v189
    v_cvt_pk_bf16_f32 v63, v190, v191
    buffer_store_dwordx4 v[60:63], v1, s[8:11], s84 offen offset:3072 sc0 sc1
    v_and_b32 v11, 31, v0
    v_lshlrev_b32 v11, 3, v11
    v_lshrrev_b32 v12, 5, v0
    v_cmp_ne_u32 vcc, s36, v12
    v_mov_b32 v28, 0x7ff00000
    s_nop 0
    v_cndmask_b32 v11, v28, v11, vcc
    buffer_store_dwordx2 v[2:3], v11, s[8:11], s85 offen sc0 sc1
    s_waitcnt lgkmcnt(0)
    s_barrier
    v_mov_b32 v16, v2
    v_mov_b32 v17, v2
    s_nop 1
    v_permlane16_swap_b32 v16, v17
    v_mov_b32 v18, v16
    v_mov_b32 v19, v17
    s_nop 0
    v_permlane32_swap_b32 v16, v18
    v_permlane32_swap_b32 v17, v19
    v_mov_b32 v20, v3
    v_mov_b32 v21, v3
    s_nop 1
    v_permlane16_swap_b32 v20, v21
    v_mov_b32 v22, v20
    v_mov_b32 v23, v21
    s_nop 0
    v_permlane32_swap_b32 v20, v22
    v_permlane32_swap_b32 v21, v23
    v_cndmask_b32 v4, v16, v18, s[90:91]
    v_cndmask_b32 v6, v20, v22, s[90:91]
    v_cndmask_b32 v5, v17, v19, s[90:91]
    v_cndmask_b32 v7, v21, v23, s[90:91]
    s_lshl_b32 s31, s30, 12
    v_add_u32 v3, s31, v1
    v_mov_b32 v50, 0
    v_mov_b32 v51, 0
    v_mov_b32 v52, 0
    v_mov_b32 v53, 0
    v_mov_b32 v58, 0
    v_mov_b32 v59, 0
    v_mov_b32 v60, 0
    v_mov_b32 v61, 0
    v_and_b32 v12, 15, v0
    v_lshlrev_b32 v12, 3, v12
    s_waitcnt vmcnt(16)
    v_and_b32 v48, v192, v24
    v_and_b32 v49, v192, v25
    v_and_b32 v54, v193, v24
    v_and_b32 v55, v193, v25
    v_mfma_f32_16x16x32_bf16 v[136:139], v[48:51], v[228:231], 0
    v_mfma_f32_16x16x32_bf16 v[152:155], v[48:51], v[232:235], 0
    v_mfma_f32_16x16x32_bf16 v[140:143], v[52:55], v[228:231], 0
    v_mfma_f32_16x16x32_bf16 v[156:159], v[52:55], v[232:235], 0
    ds_read_b128 v[228:231], v116 offset:1024
    ds_read_b128 v[232:235], v116 offset:3072
    buffer_load_dwordx4 a[84:87], v1, s[8:11], s79 offen offset:1024
    v_and_b32 v56, v196, v24
    v_and_b32 v57, v196, v25
    v_and_b32 v62, v197, v24
    v_and_b32 v63, v197, v25
    v_mfma_f32_16x16x32_bf16 v[136:139], v[56:59], v[236:239], v[136:139]
    v_mfma_f32_16x16x32_bf16 v[152:155], v[56:59], v[240:243], v[152:155]
    v_mfma_f32_16x16x32_bf16 v[140:143], v[60:63], v[236:239], v[140:143]
    v_mfma_f32_16x16x32_bf16 v[156:159], v[60:63], v[240:243], v[156:159]
    ds_read_b128 v[236:239], v117 offset:1024
    ds_read_b128 v[240:243], v117 offset:3072
    buffer_load_dwordx4 a[88:91], v1, s[8:11], s79 offen offset:2048
    v_and_b32 v48, v200, v24
    v_and_b32 v49, v200, v25
    v_and_b32 v54, v201, v24
    v_and_b32 v55, v201, v25
    v_mfma_f32_16x16x32_bf16 v[136:139], v[48:51], v[244:247], v[136:139]
    v_mfma_f32_16x16x32_bf16 v[152:155], v[48:51], v[248:251], v[152:155]
    v_mfma_f32_16x16x32_bf16 v[140:143], v[52:55], v[244:247], v[140:143]
    v_mfma_f32_16x16x32_bf16 v[156:159], v[52:55], v[248:251], v[156:159]
    ds_read_b128 v[244:247], v118 offset:1024
    ds_read_b128 v[248:251], v118 offset:3072
    buffer_load_dwordx4 a[92:95], v1, s[8:11], s79 offen offset:3072
    v_and_b32 v56, v204, v24
    v_and_b32 v57, v204, v25
    v_and_b32 v62, v205, v24
    v_and_b32 v63, v205, v25
    v_mfma_f32_16x16x32_bf16 v[136:139], v[56:59], v[252:255], v[136:139]
    v_mfma_f32_16x16x32_bf16 v[152:155], v[56:59], v[120:123], v[152:155]
    v_mfma_f32_16x16x32_bf16 v[140:143], v[60:63], v[252:255], v[140:143]
    v_mfma_f32_16x16x32_bf16 v[156:159], v[60:63], v[120:123], v[156:159]
    ds_read_b128 v[252:255], v119 offset:1024
    ds_read_b128 v[120:123], v119 offset:3072
    s_add_u32 s79, s79, 4096
    buffer_load_dwordx4 a[96:99], v1, s[8:11], s79 offen
    v_and_b32 v48, v208, v24
    v_and_b32 v49, v208, v25
    v_and_b32 v54, v209, v24
    v_and_b32 v55, v209, v25
    v_mfma_f32_16x16x32_bf16 v[136:139], v[48:51], v[124:127], v[136:139]
    v_mfma_f32_16x16x32_bf16 v[152:155], v[48:51], v[64:67], v[152:155]
    v_mfma_f32_16x16x32_bf16 v[140:143], v[52:55], v[124:127], v[140:143]
    v_mfma_f32_16x16x32_bf16 v[156:159], v[52:55], v[64:67], v[156:159]
    ds_read_b128 v[124:127], v113 offset:1024
    ds_read_b128 v[64:67], v113 offset:3072
    buffer_load_dwordx4 a[100:103], v1, s[8:11], s79 offen offset:1024
    buffer_load_dwordx4 v[32:35], v1, s[8:11], s86 offen sc0 sc1
    buffer_load_dwordx4 v[36:39], v1, s[8:11], s86 offen offset:1024 sc0 sc1
    buffer_load_dwordx4 v[40:43], v1, s[8:11], s86 offen offset:2048 sc0 sc1
    buffer_load_dwordx4 v[44:47], v1, s[8:11], s86 offen offset:3072 sc0 sc1
    buffer_load_dwordx2 v[8:9], v12, s[8:11], s87 offen sc0 sc1
    buffer_load_dwordx2 v[10:11], v12, s[8:11], s87 offen offset:128 sc0 sc1
    v_and_b32 v48, v194, v24
    v_and_b32 v49, v194, v25
    v_and_b32 v54, v195, v24
    v_and_b32 v55, v195, v25
    s_waitcnt lgkmcnt(9)
    v_mfma_f32_16x16x32_bf16 v[168:171], v[48:51], v[228:231], 0
    s_waitcnt lgkmcnt(8)
    v_mfma_f32_16x16x32_bf16 v[184:187], v[48:51], v[232:235], 0
    v_mfma_f32_16x16x32_bf16 v[172:175], v[52:55], v[228:231], 0
    v_mfma_f32_16x16x32_bf16 v[188:191], v[52:55], v[232:235], 0
    buffer_load_dwordx4 a[104:107], v1, s[8:11], s79 offen offset:2048
    v_and_b32 v56, v198, v24
    v_and_b32 v57, v198, v25
    v_and_b32 v62, v199, v24
    v_and_b32 v63, v199, v25
    s_waitcnt lgkmcnt(7)
    v_mfma_f32_16x16x32_bf16 v[168:171], v[56:59], v[236:239], v[168:171]
    v_mul_f32 v80, v80, v136
    v_mul_f32 v81, v81, v137
    s_waitcnt lgkmcnt(6)
    v_mfma_f32_16x16x32_bf16 v[184:187], v[56:59], v[240:243], v[184:187]
    v_mul_f32 v82, v82, v138
    v_mul_f32 v83, v83, v139
    v_mfma_f32_16x16x32_bf16 v[172:175], v[60:63], v[236:239], v[172:175]
    v_mul_f32 v84, v84, v140
    v_mul_f32 v85, v85, v141
    v_mfma_f32_16x16x32_bf16 v[188:191], v[60:63], v[240:243], v[188:191]
    v_mul_f32 v86, v86, v142
    v_mul_f32 v87, v87, v143
    buffer_load_dwordx4 a[108:111], v1, s[8:11], s79 offen offset:3072
    v_and_b32 v48, v202, v24
    v_and_b32 v49, v202, v25
    v_and_b32 v54, v203, v24
    v_and_b32 v55, v203, v25
    s_waitcnt lgkmcnt(5)
    v_mfma_f32_16x16x32_bf16 v[168:171], v[48:51], v[244:247], v[168:171]
    v_cvt_pk_bf16_f32 v80, v80, v81
    v_cvt_pk_bf16_f32 v81, v82, v83
    s_waitcnt lgkmcnt(4)
    v_mfma_f32_16x16x32_bf16 v[184:187], v[48:51], v[248:251], v[184:187]
    v_cvt_pk_bf16_f32 v82, v84, v85
    v_cvt_pk_bf16_f32 v83, v86, v87
    v_mfma_f32_16x16x32_bf16 v[172:175], v[52:55], v[244:247], v[172:175]
    ds_write_b128 v3, v[80:83] offset:16384
    v_mul_f32 v88, v88, v152
    v_mfma_f32_16x16x32_bf16 v[188:191], v[52:55], v[248:251], v[188:191]
    v_mul_f32 v89, v89, v153
    v_mul_f32 v90, v90, v154
    s_add_u32 s79, s79, 4096
    buffer_load_dwordx4 a[112:115], v1, s[8:11], s79 offen
    v_and_b32 v56, v206, v24
    v_and_b32 v57, v206, v25
    v_and_b32 v62, v207, v24
    v_and_b32 v63, v207, v25
    s_waitcnt lgkmcnt(4)
    v_mfma_f32_16x16x32_bf16 v[168:171], v[56:59], v[252:255], v[168:171]
    v_mul_f32 v91, v91, v155
    v_mul_f32 v92, v92, v156
    s_waitcnt lgkmcnt(3)
    v_mfma_f32_16x16x32_bf16 v[184:187], v[56:59], v[120:123], v[184:187]
    v_mul_f32 v93, v93, v157
    v_mul_f32 v94, v94, v158
    v_mfma_f32_16x16x32_bf16 v[172:175], v[60:63], v[252:255], v[172:175]
    v_mul_f32 v95, v95, v159
    v_cvt_pk_bf16_f32 v88, v88, v89
    v_mfma_f32_16x16x32_bf16 v[188:191], v[60:63], v[120:123], v[188:191]
    v_cvt_pk_bf16_f32 v89, v90, v91
    v_cvt_pk_bf16_f32 v90, v92, v93
    buffer_load_dwordx4 a[116:119], v1, s[8:11], s79 offen offset:1024
    v_and_b32 v48, v210, v24
    v_and_b32 v49, v210, v25
    v_and_b32 v54, v211, v24
    v_and_b32 v55, v211, v25
    s_waitcnt lgkmcnt(2)
    v_mfma_f32_16x16x32_bf16 v[168:171], v[48:51], v[124:127], v[168:171]
    v_cvt_pk_bf16_f32 v91, v94, v95
    ds_write_b128 v3, v[88:91] offset:17408
    s_waitcnt lgkmcnt(2)
    v_mfma_f32_16x16x32_bf16 v[184:187], v[48:51], v[64:67], v[184:187]
    v_mfma_f32_16x16x32_bf16 v[172:175], v[52:55], v[124:127], v[172:175]
    v_mfma_f32_16x16x32_bf16 v[188:191], v[52:55], v[64:67], v[188:191]
    buffer_load_dwordx4 a[120:123], v1, s[8:11], s79 offen offset:2048
    buffer_load_dwordx4 a[124:127], v1, s[8:11], s79 offen offset:3072
    v_mul_f32 v96, v96, v168
    v_mul_f32 v97, v97, v169
    v_mul_f32 v98, v98, v170
    v_mul_f32 v99, v99, v171
    s_nop 0
    v_mul_f32 v100, v100, v172
    v_mul_f32 v101, v101, v173
    v_mul_f32 v102, v102, v174
    v_mul_f32 v103, v103, v175
    v_cvt_pk_bf16_f32 v96, v96, v97
    v_cvt_pk_bf16_f32 v97, v98, v99
    v_cvt_pk_bf16_f32 v98, v100, v101
    v_cvt_pk_bf16_f32 v99, v102, v103
    ds_write_b128 v3, v[96:99] offset:18432
    v_mul_f32 v104, v104, v184
    v_mul_f32 v105, v105, v185
    v_mul_f32 v106, v106, v186
    v_mul_f32 v107, v107, v187
    v_mul_f32 v108, v108, v188
    v_mul_f32 v109, v109, v189
    v_mul_f32 v110, v110, v190
    v_mul_f32 v111, v111, v191
    v_cvt_pk_bf16_f32 v104, v104, v105
    v_cvt_pk_bf16_f32 v105, v106, v107
    v_cvt_pk_bf16_f32 v106, v108, v109
    v_cvt_pk_bf16_f32 v107, v110, v111
    ds_write_b128 v3, v[104:107] offset:19456
    buffer_load_dwordx4 v[212:215], v13, s[44:47], s77 offen
    buffer_load_dwordx4 v[216:219], v13, s[44:47], s77 offen offset:16
    buffer_load_dwordx4 v[220:223], v13, s[44:47], s78 offen
    buffer_load_dwordx4 v[224:227], v13, s[44:47], s78 offen offset:16
    s_waitcnt lgkmcnt(0)
    s_barrier
    ds_read_b128 v[112:115], v1 offset:16384
    ds_read_b128 v[116:119], v1 offset:17408
    ds_read_b128 v[120:123], v1 offset:18432
    ds_read_b128 v[124:127], v1 offset:19456
    s_waitcnt lgkmcnt(3)
    v_mfma_f32_16x16x32_bf16 v[64:67], a[128:131], v[112:115], 0
    ds_read_b128 v[228:231], v1 offset:20480
    s_waitcnt lgkmcnt(3)
    v_mfma_f32_16x16x32_bf16 v[68:71], a[128:131], v[116:119], 0
    ds_read_b128 v[232:235], v1 offset:21504
    v_mfma_f32_16x16x32_bf16 v[72:75], a[160:163], v[112:115], 0
    v_mfma_f32_16x16x32_bf16 v[76:79], a[160:163], v[116:119], 0
    v_mfma_f32_16x16x32_bf16 v[96:99], a[192:195], v[112:115], 0
    v_mfma_f32_16x16x32_bf16 v[100:103], a[192:195], v[116:119], 0
    v_mfma_f32_16x16x32_bf16 v[104:107], a[224:227], v[112:115], 0
    v_mfma_f32_16x16x32_bf16 v[108:111], a[224:227], v[116:119], 0
    s_waitcnt lgkmcnt(3)
    v_mfma_f32_16x16x32_bf16 v[64:67], a[132:135], v[120:123], v[64:67]
    ds_read_b128 v[112:115], v1 offset:22528
    s_waitcnt lgkmcnt(3)
    v_mfma_f32_16x16x32_bf16 v[68:71], a[132:135], v[124:127], v[68:71]
    ds_read_b128 v[116:119], v1 offset:23552
    v_mfma_f32_16x16x32_bf16 v[72:75], a[164:167], v[120:123], v[72:75]
    v_mfma_f32_16x16x32_bf16 v[76:79], a[164:167], v[124:127], v[76:79]
    v_mfma_f32_16x16x32_bf16 v[96:99], a[196:199], v[120:123], v[96:99]
    v_mfma_f32_16x16x32_bf16 v[100:103], a[196:199], v[124:127], v[100:103]
    v_mfma_f32_16x16x32_bf16 v[104:107], a[228:231], v[120:123], v[104:107]
    v_mfma_f32_16x16x32_bf16 v[108:111], a[228:231], v[124:127], v[108:111]
    s_waitcnt lgkmcnt(3)
    v_mfma_f32_16x16x32_bf16 v[64:67], a[136:139], v[228:231], v[64:67]
    ds_read_b128 v[120:123], v1 offset:24576
    s_waitcnt lgkmcnt(3)
    v_mfma_f32_16x16x32_bf16 v[68:71], a[136:139], v[232:235], v[68:71]
    ds_read_b128 v[124:127], v1 offset:25600
    v_mfma_f32_16x16x32_bf16 v[72:75], a[168:171], v[228:231], v[72:75]
    v_mfma_f32_16x16x32_bf16 v[76:79], a[168:171], v[232:235], v[76:79]
    v_mfma_f32_16x16x32_bf16 v[96:99], a[200:203], v[228:231], v[96:99]
    v_mfma_f32_16x16x32_bf16 v[100:103], a[200:203], v[232:235], v[100:103]
    v_mfma_f32_16x16x32_bf16 v[104:107], a[232:235], v[228:231], v[104:107]
    v_mfma_f32_16x16x32_bf16 v[108:111], a[232:235], v[232:235], v[108:111]
    s_waitcnt lgkmcnt(3)
    v_mfma_f32_16x16x32_bf16 v[64:67], a[140:143], v[112:115], v[64:67]
    ds_read_b128 v[228:231], v1 offset:26624
    s_waitcnt lgkmcnt(3)
    v_mfma_f32_16x16x32_bf16 v[68:71], a[140:143], v[116:119], v[68:71]
    ds_read_b128 v[232:235], v1 offset:27648
    v_mfma_f32_16x16x32_bf16 v[72:75], a[172:175], v[112:115], v[72:75]
    v_mfma_f32_16x16x32_bf16 v[76:79], a[172:175], v[116:119], v[76:79]
    v_mfma_f32_16x16x32_bf16 v[96:99], a[204:207], v[112:115], v[96:99]
    v_mfma_f32_16x16x32_bf16 v[100:103], a[204:207], v[116:119], v[100:103]
    v_mfma_f32_16x16x32_bf16 v[104:107], a[236:239], v[112:115], v[104:107]
    v_mfma_f32_16x16x32_bf16 v[108:111], a[236:239], v[116:119], v[108:111]
    s_waitcnt lgkmcnt(3)
    v_mfma_f32_16x16x32_bf16 v[64:67], a[144:147], v[120:123], v[64:67]
    ds_read_b128 v[112:115], v1 offset:28672
    s_waitcnt lgkmcnt(3)
    v_mfma_f32_16x16x32_bf16 v[68:71], a[144:147], v[124:127], v[68:71]
    ds_read_b128 v[116:119], v1 offset:29696
    v_mfma_f32_16x16x32_bf16 v[72:75], a[176:179], v[120:123], v[72:75]
    v_mfma_f32_16x16x32_bf16 v[76:79], a[176:179], v[124:127], v[76:79]
    v_mfma_f32_16x16x32_bf16 v[96:99], a[208:211], v[120:123], v[96:99]
    v_mfma_f32_16x16x32_bf16 v[100:103], a[208:211], v[124:127], v[100:103]
    v_mfma_f32_16x16x32_bf16 v[104:107], a[240:243], v[120:123], v[104:107]
    v_mfma_f32_16x16x32_bf16 v[108:111], a[240:243], v[124:127], v[108:111]
    s_waitcnt lgkmcnt(3)
    v_mfma_f32_16x16x32_bf16 v[64:67], a[148:151], v[228:231], v[64:67]
    ds_read_b128 v[120:123], v1 offset:30720
    s_waitcnt lgkmcnt(3)
    v_mfma_f32_16x16x32_bf16 v[68:71], a[148:151], v[232:235], v[68:71]
    ds_read_b128 v[124:127], v1 offset:31744
    v_mfma_f32_16x16x32_bf16 v[72:75], a[180:183], v[228:231], v[72:75]
    v_mfma_f32_16x16x32_bf16 v[76:79], a[180:183], v[232:235], v[76:79]
    v_mfma_f32_16x16x32_bf16 v[96:99], a[212:215], v[228:231], v[96:99]
    v_mfma_f32_16x16x32_bf16 v[100:103], a[212:215], v[232:235], v[100:103]
    v_mfma_f32_16x16x32_bf16 v[104:107], a[244:247], v[228:231], v[104:107]
    v_mfma_f32_16x16x32_bf16 v[108:111], a[244:247], v[232:235], v[108:111]
    s_waitcnt lgkmcnt(3)
    v_mfma_f32_16x16x32_bf16 v[64:67], a[152:155], v[112:115], v[64:67]
    s_waitcnt lgkmcnt(2)
    v_mfma_f32_16x16x32_bf16 v[68:71], a[152:155], v[116:119], v[68:71]
    v_mfma_f32_16x16x32_bf16 v[72:75], a[184:187], v[112:115], v[72:75]
    v_mfma_f32_16x16x32_bf16 v[76:79], a[184:187], v[116:119], v[76:79]
    v_mfma_f32_16x16x32_bf16 v[96:99], a[216:219], v[112:115], v[96:99]
    v_mfma_f32_16x16x32_bf16 v[100:103], a[216:219], v[116:119], v[100:103]
    v_mfma_f32_16x16x32_bf16 v[104:107], a[248:251], v[112:115], v[104:107]
    v_mfma_f32_16x16x32_bf16 v[108:111], a[248:251], v[116:119], v[108:111]
    s_waitcnt lgkmcnt(1)
    v_mfma_f32_16x16x32_bf16 v[64:67], a[156:159], v[120:123], v[64:67]
    s_waitcnt lgkmcnt(0)
    v_mfma_f32_16x16x32_bf16 v[68:71], a[156:159], v[124:127], v[68:71]
    v_mfma_f32_16x16x32_bf16 v[72:75], a[188:191], v[120:123], v[72:75]
    v_mfma_f32_16x16x32_bf16 v[76:79], a[188:191], v[124:127], v[76:79]
    v_mfma_f32_16x16x32_bf16 v[96:99], a[220:223], v[120:123], v[96:99]
    v_mfma_f32_16x16x32_bf16 v[100:103], a[220:223], v[124:127], v[100:103]
    v_mfma_f32_16x16x32_bf16 v[104:107], a[252:255], v[120:123], v[104:107]
    v_mfma_f32_16x16x32_bf16 v[108:111], a[252:255], v[124:127], v[108:111]
    s_mov_b32 s34, 0
K2_POLL:
    s_waitcnt vmcnt(0)
    v_max3_u32 v236, v32, v33, v34
    v_max3_u32 v236, v236, v35, v36
    v_max3_u32 v236, v236, v37, v38
    v_max3_u32 v236, v236, v39, v40
    v_max3_u32 v236, v236, v41, v42
    v_max3_u32 v236, v236, v43, v44
    v_max3_u32 v236, v236, v45, v46
    v_max3_u32 v236, v236, v47, v8
    v_max3_u32 v236, v236, v9, v10
    v_max_u32 v236, v236, v11
    v_cmp_eq_u32 vcc, -1, v236
    s_nop 1
    s_cbranch_vccz K2_GOT
    s_add_u32 s34, s34, 1
    s_cmp_gt_u32 s34, 0x40000
    s_cbranch_scc1 K2_GOT
    s_sleep 1
    buffer_load_dwordx4 v[32:35], v1, s[8:11], s86 offen sc0 sc1
    buffer_load_dwordx4 v[36:39], v1, s[8:11], s86 offen offset:1024 sc0 sc1
    buffer_load_dwordx4 v[40:43], v1, s[8:11], s86 offen offset:2048 sc0 sc1
    buffer_load_dwordx4 v[44:47], v1, s[8:11], s86 offen offset:3072 sc0 sc1
    buffer_load_dwordx2 v[8:9], v12, s[8:11], s87 offen sc0 sc1
    buffer_load_dwordx2 v[10:11], v12, s[8:11], s87 offen offset:128 sc0 sc1
    s_branch K2_POLL
K2_GOT:
    v_min_f32 v236, v4, v8
    v_sub_f32 v237, v236, v4
    v_sub_f32 v238, v236, v8
    v_exp_f32 v237, v237
    v_exp_f32 v238, v238
    v_mul_f32 v236, v237, v6
    v_fmac_f32 v236, v238, v9
    v_rcp_f32 v236, v236
    s_nop 0
    v_mul_f32 v237, v237, v236
    v_mul_f32 v238, v238, v236
    v_lshlrev_b32 v240, 16, v32
    v_and_b32 v241, 0xffff0000, v32
    v_mul_f32 v128, v128, v237
    v_mul_f32 v129, v129, v237
    v_fmac_f32 v128, v240, v238
    v_fmac_f32 v129, v241, v238
    v_cvt_pk_bf16_f32 v80, v128, v129
    v_lshlrev_b32 v242, 16, v33
    v_and_b32 v243, 0xffff0000, v33
    v_mul_f32 v130, v130, v237
    v_mul_f32 v131, v131, v237
    v_fmac_f32 v130, v242, v238
    v_fmac_f32 v131, v243, v238
    v_cvt_pk_bf16_f32 v81, v130, v131
    v_lshlrev_b32 v240, 16, v34
    v_and_b32 v241, 0xffff0000, v34
    v_mul_f32 v144, v144, v237
    v_mul_f32 v145, v145, v237
    v_fmac_f32 v144, v240, v238
    v_fmac_f32 v145, v241, v238
    v_cvt_pk_bf16_f32 v82, v144, v145
    v_lshlrev_b32 v242, 16, v35
    v_and_b32 v243, 0xffff0000, v35
    v_mul_f32 v146, v146, v237
    v_mul_f32 v147, v147, v237
    v_fmac_f32 v146, v242, v238
    v_fmac_f32 v147, v243, v238
    v_cvt_pk_bf16_f32 v83, v146, v147
    ds_write_b128 v3, v[80:83]
    v_lshlrev_b32 v240, 16, v40
    v_and_b32 v241, 0xffff0000, v40
    v_mul_f32 v160, v160, v237
    v_mul_f32 v161, v161, v237
    v_fmac_f32 v160, v240, v238
    v_fmac_f32 v161, v241, v238
    v_cvt_pk_bf16_f32 v88, v160, v161
    v_lshlrev_b32 v242, 16, v41
    v_and_b32 v243, 0xffff0000, v41
    v_mul_f32 v162, v162, v237
    v_mul_f32 v163, v163, v237
    v_fmac_f32 v162, v242, v238
    v_fmac_f32 v163, v243, v238
    v_cvt_pk_bf16_f32 v89, v162, v163
    v_lshlrev_b32 v240, 16, v42
    v_and_b32 v241, 0xffff0000, v42
    v_mul_f32 v176, v176, v237
    v_mul_f32 v177, v177, v237
    v_fmac_f32 v176, v240, v238
    v_fmac_f32 v177, v241, v238
    v_cvt_pk_bf16_f32 v90, v176, v177
    v_lshlrev_b32 v242, 16, v43
    v_and_b32 v243, 0xffff0000, v43
    v_mul_f32 v178, v178, v237
    v_mul_f32 v179, v179, v237
    v_fmac_f32 v178, v242, v238
    v_fmac_f32 v179, v243, v238
    v_cvt_pk_bf16_f32 v91, v178, v179
    ds_write_b128 v3, v[88:91] offset:2048
    v_min_f32 v236, v5, v10
    v_sub_f32 v237, v236, v5
    v_sub_f32 v238, v236, v10
    v_exp_f32 v237, v237
    v_exp_f32 v238, v238
    v_mul_f32 v236, v237, v7
    v_fmac_f32 v236, v238, v11
    v_rcp_f32 v236, v236
    s_nop 0
    v_mul_f32 v237, v237, v236
    v_mul_f32 v238, v238, v236
    v_lshlrev_b32 v240, 16, v36
    v_and_b32 v241, 0xffff0000, v36
    v_mul_f32 v132, v132, v237
    v_mul_f32 v133, v133, v237
    v_fmac_f32 v132, v240, v238
    v_fmac_f32 v133, v241, v238
    v_cvt_pk_bf16_f32 v84, v132, v133
    v_lshlrev_b32 v242, 16, v37
    v_and_b32 v243, 0xffff0000, v37
    v_mul_f32 v134, v134, v237
    v_mul_f32 v135, v135, v237
    v_fmac_f32 v134, v242, v238
    v_fmac_f32 v135, v243, v238
    v_cvt_pk_bf16_f32 v85, v134, v135
    v_lshlrev_b32 v240, 16, v38
    v_and_b32 v241, 0xffff0000, v38
    v_mul_f32 v148, v148, v237
    v_mul_f32 v149, v149, v237
    v_fmac_f32 v148, v240, v238
    v_fmac_f32 v149, v241, v238
    v_cvt_pk_bf16_f32 v86, v148, v149
    v_lshlrev_b32 v242, 16, v39
    v_and_b32 v243, 0xffff0000, v39
    v_mul_f32 v150, v150, v237
    v_mul_f32 v151, v151, v237
    v_fmac_f32 v150, v242, v238
    v_fmac_f32 v151, v243, v238
    v_cvt_pk_bf16_f32 v87, v150, v151
    ds_write_b128 v3, v[84:87] offset:1024
    v_lshlrev_b32 v240, 16, v44
    v_and_b32 v241, 0xffff0000, v44
    v_mul_f32 v164, v164, v237
    v_mul_f32 v165, v165, v237
    v_fmac_f32 v164, v240, v238
    v_fmac_f32 v165, v241, v238
    v_cvt_pk_bf16_f32 v92, v164, v165
    v_lshlrev_b32 v242, 16, v45
    v_and_b32 v243, 0xffff0000, v45
    v_mul_f32 v166, v166, v237
    v_mul_f32 v167, v167, v237
    v_fmac_f32 v166, v242, v238
    v_fmac_f32 v167, v243, v238
    v_cvt_pk_bf16_f32 v93, v166, v167
    v_lshlrev_b32 v240, 16, v46
    v_and_b32 v241, 0xffff0000, v46
    v_mul_f32 v180, v180, v237
    v_mul_f32 v181, v181, v237
    v_fmac_f32 v180, v240, v238
    v_fmac_f32 v181, v241, v238
    v_cvt_pk_bf16_f32 v94, v180, v181
    v_lshlrev_b32 v242, 16, v47
    v_and_b32 v243, 0xffff0000, v47
    v_mul_f32 v182, v182, v237
    v_mul_f32 v183, v183, v237
    v_fmac_f32 v182, v242, v238
    v_fmac_f32 v183, v243, v238
    v_cvt_pk_bf16_f32 v95, v182, v183
    ds_write_b128 v3, v[92:95] offset:3072
    s_waitcnt lgkmcnt(0)
    s_barrier
    ds_read_b128 v[112:115], v1
    ds_read_b128 v[116:119], v1 offset:1024
    ds_read_b128 v[120:123], v1 offset:2048
    ds_read_b128 v[124:127], v1 offset:3072
    s_waitcnt lgkmcnt(3)
    v_mfma_f32_16x16x32_bf16 v[64:67], a[0:3], v[112:115], v[64:67]
    ds_read_b128 v[228:231], v1 offset:4096
    s_waitcnt vmcnt(3)
    v_lshlrev_b32 v236, 16, v212
    s_waitcnt lgkmcnt(3)
    v_mfma_f32_16x16x32_bf16 v[68:71], a[0:3], v[116:119], v[68:71]
    ds_read_b128 v[232:235], v1 offset:5120
    v_and_b32 v237, 0xffff0000, v212
    v_mfma_f32_16x16x32_bf16 v[72:75], a[32:35], v[112:115], v[72:75]
    v_lshlrev_b32 v238, 16, v213
    v_and_b32 v239, 0xffff0000, v213
    v_mfma_f32_16x16x32_bf16 v[76:79], a[32:35], v[116:119], v[76:79]
    v_lshlrev_b32 v240, 16, v214
    v_and_b32 v241, 0xffff0000, v214
    v_mfma_f32_16x16x32_bf16 v[96:99], a[64:67], v[112:115], v[96:99]
    v_lshlrev_b32 v242, 16, v215
    v_and_b32 v243, 0xffff0000, v215
    v_mfma_f32_16x16x32_bf16 v[100:103], a[64:67], v[116:119], v[100:103]
    s_waitcnt vmcnt(2)
    v_lshlrev_b32 v244, 16, v216
    v_and_b32 v245, 0xffff0000, v216
    v_mfma_f32_16x16x32_bf16 v[104:107], a[96:99], v[112:115], v[104:107]
    v_lshlrev_b32 v246, 16, v217
    v_and_b32 v247, 0xffff0000, v217
    v_mfma_f32_16x16x32_bf16 v[108:111], a[96:99], v[116:119], v[108:111]
    v_lshlrev_b32 v248, 16, v218
    v_and_b32 v249, 0xffff0000, v218
    s_waitcnt lgkmcnt(3)
    v_mfma_f32_16x16x32_bf16 v[64:67], a[4:7], v[120:123], v[64:67]
    ds_read_b128 v[112:115], v1 offset:6144
    v_lshlrev_b32 v250, 16, v219
    s_waitcnt lgkmcnt(3)
    v_mfma_f32_16x16x32_bf16 v[68:71], a[4:7], v[124:127], v[68:71]
    ds_read_b128 v[116:119], v1 offset:7168
    v_and_b32 v251, 0xffff0000, v219
    v_mfma_f32_16x16x32_bf16 v[72:75], a[36:39], v[120:123], v[72:75]
    s_waitcnt vmcnt(1)
    v_lshlrev_b32 v80, 16, v220
    v_and_b32 v81, 0xffff0000, v220
    v_mfma_f32_16x16x32_bf16 v[76:79], a[36:39], v[124:127], v[76:79]
    v_lshlrev_b32 v82, 16, v221
    v_and_b32 v83, 0xffff0000, v221
    v_mfma_f32_16x16x32_bf16 v[96:99], a[68:71], v[120:123], v[96:99]
    v_lshlrev_b32 v84, 16, v222
    v_and_b32 v85, 0xffff0000, v222
    v_mfma_f32_16x16x32_bf16 v[100:103], a[68:71], v[124:127], v[100:103]
    v_lshlrev_b32 v86, 16, v223
    v_and_b32 v87, 0xffff0000, v223
    v_mfma_f32_16x16x32_bf16 v[104:107], a[100:103], v[120:123], v[104:107]
    s_waitcnt vmcnt(0)
    v_lshlrev_b32 v88, 16, v224
    v_and_b32 v89, 0xffff0000, v224
    v_mfma_f32_16x16x32_bf16 v[108:111], a[100:103], v[124:127], v[108:111]
    v_lshlrev_b32 v90, 16, v225
    v_and_b32 v91, 0xffff0000, v225
    s_waitcnt lgkmcnt(3)
    v_mfma_f32_16x16x32_bf16 v[64:67], a[8:11], v[228:231], v[64:67]
    ds_read_b128 v[120:123], v1 offset:8192
    v_lshlrev_b32 v92, 16, v226
    s_waitcnt lgkmcnt(3)
    v_mfma_f32_16x16x32_bf16 v[68:71], a[8:11], v[232:235], v[68:71]
    ds_read_b128 v[124:127], v1 offset:9216
    v_and_b32 v93, 0xffff0000, v226
    v_mfma_f32_16x16x32_bf16 v[72:75], a[40:43], v[228:231], v[72:75]
    v_lshlrev_b32 v94, 16, v227
    v_and_b32 v95, 0xffff0000, v227
    v_mfma_f32_16x16x32_bf16 v[76:79], a[40:43], v[232:235], v[76:79]
    v_mfma_f32_16x16x32_bf16 v[96:99], a[72:75], v[228:231], v[96:99]
    v_mfma_f32_16x16x32_bf16 v[100:103], a[72:75], v[232:235], v[100:103]
    v_mfma_f32_16x16x32_bf16 v[104:107], a[104:107], v[228:231], v[104:107]
    v_mfma_f32_16x16x32_bf16 v[108:111], a[104:107], v[232:235], v[108:111]
    s_waitcnt lgkmcnt(3)
    v_mfma_f32_16x16x32_bf16 v[64:67], a[12:15], v[112:115], v[64:67]
    ds_read_b128 v[228:231], v1 offset:10240
    s_waitcnt lgkmcnt(3)
    v_mfma_f32_16x16x32_bf16 v[68:71], a[12:15], v[116:119], v[68:71]
    ds_read_b128 v[232:235], v1 offset:11264
    v_mfma_f32_16x16x32_bf16 v[72:75], a[44:47], v[112:115], v[72:75]
    v_mfma_f32_16x16x32_bf16 v[76:79], a[44:47], v[116:119], v[76:79]
    v_mfma_f32_16x16x32_bf16 v[96:99], a[76:79], v[112:115], v[96:99]
    v_mfma_f32_16x16x32_bf16 v[100:103], a[76:79], v[116:119], v[100:103]
    v_mfma_f32_16x16x32_bf16 v[104:107], a[108:111], v[112:115], v[104:107]
    v_mfma_f32_16x16x32_bf16 v[108:111], a[108:111], v[116:119], v[108:111]
    s_waitcnt lgkmcnt(3)
    v_mfma_f32_16x16x32_bf16 v[64:67], a[16:19], v[120:123], v[64:67]
    ds_read_b128 v[112:115], v1 offset:12288
    s_waitcnt lgkmcnt(3)
    v_mfma_f32_16x16x32_bf16 v[68:71], a[16:19], v[124:127], v[68:71]
    ds_read_b128 v[116:119], v1 offset:13312
    v_mfma_f32_16x16x32_bf16 v[72:75], a[48:51], v[120:123], v[72:75]
    v_mfma_f32_16x16x32_bf16 v[76:79], a[48:51], v[124:127], v[76:79]
    v_mfma_f32_16x16x32_bf16 v[96:99], a[80:83], v[120:123], v[96:99]
    v_mfma_f32_16x16x32_bf16 v[100:103], a[80:83], v[124:127], v[100:103]
    v_mfma_f32_16x16x32_bf16 v[104:107], a[112:115], v[120:123], v[104:107]
    v_mfma_f32_16x16x32_bf16 v[108:111], a[112:115], v[124:127], v[108:111]
    s_waitcnt lgkmcnt(3)
    v_mfma_f32_16x16x32_bf16 v[64:67], a[20:23], v[228:231], v[64:67]
    ds_read_b128 v[120:123], v1 offset:14336
    s_waitcnt lgkmcnt(3)
    v_mfma_f32_16x16x32_bf16 v[68:71], a[20:23], v[232:235], v[68:71]
    ds_read_b128 v[124:127], v1 offset:15360
    v_mfma_f32_16x16x32_bf16 v[72:75], a[52:55], v[228:231], v[72:75]
    v_mfma_f32_16x16x32_bf16 v[76:79], a[52:55], v[232:235], v[76:79]
    v_mfma_f32_16x16x32_bf16 v[96:99], a[84:87], v[228:231], v[96:99]
    v_mfma_f32_16x16x32_bf16 v[100:103], a[84:87], v[232:235], v[100:103]
    v_mfma_f32_16x16x32_bf16 v[104:107], a[116:119], v[228:231], v[104:107]
    v_mfma_f32_16x16x32_bf16 v[108:111], a[116:119], v[232:235], v[108:111]
    s_waitcnt lgkmcnt(3)
    v_mfma_f32_16x16x32_bf16 v[64:67], a[24:27], v[112:115], v[64:67]
    s_waitcnt lgkmcnt(2)
    v_mfma_f32_16x16x32_bf16 v[68:71], a[24:27], v[116:119], v[68:71]
    v_mfma_f32_16x16x32_bf16 v[72:75], a[56:59], v[112:115], v[72:75]
    v_mfma_f32_16x16x32_bf16 v[76:79], a[56:59], v[116:119], v[76:79]
    v_mfma_f32_16x16x32_bf16 v[96:99], a[88:91], v[112:115], v[96:99]
    v_mfma_f32_16x16x32_bf16 v[100:103], a[88:91], v[116:119], v[100:103]
    v_mfma_f32_16x16x32_bf16 v[104:107], a[120:123], v[112:115], v[104:107]
    v_mfma_f32_16x16x32_bf16 v[108:111], a[120:123], v[116:119], v[108:111]
    s_waitcnt lgkmcnt(1)
    v_mfma_f32_16x16x32_bf16 v[64:67], a[28:31], v[120:123], v[64:67]
    s_waitcnt lgkmcnt(0)
    v_mfma_f32_16x16x32_bf16 v[68:71], a[28:31], v[124:127], v[68:71]
    v_mfma_f32_16x16x32_bf16 v[72:75], a[60:63], v[120:123], v[72:75]
    v_mfma_f32_16x16x32_bf16 v[76:79], a[60:63], v[124:127], v[76:79]
    v_mfma_f32_16x16x32_bf16 v[96:99], a[92:95], v[120:123], v[96:99]
    v_mfma_f32_16x16x32_bf16 v[100:103], a[92:95], v[124:127], v[100:103]
    v_mfma_f32_16x16x32_bf16 v[104:107], a[124:127], v[120:123], v[104:107]
    v_mfma_f32_16x16x32_bf16 v[108:111], a[124:127], v[124:127], v[108:111]
    v_add_f32 v64, v64, v236
    v_add_f32 v65, v65, v237
    v_add_f32 v66, v66, v238
    v_add_f32 v67, v67, v239
    v_add_f32 v72, v72, v240
    v_add_f32 v73, v73, v241
    v_add_f32 v74, v74, v242
    v_add_f32 v75, v75, v243
    v_add_f32 v96, v96, v244
    v_add_f32 v97, v97, v245
    v_add_f32 v98, v98, v246
    v_add_f32 v99, v99, v247
    v_add_f32 v104, v104, v248
    v_add_f32 v105, v105, v249
    v_add_f32 v106, v106, v250
    v_add_f32 v107, v107, v251
    v_cvt_pk_bf16_f32 v212, v64, v65
    v_cvt_pk_bf16_f32 v213, v66, v67
    v_cvt_pk_bf16_f32 v214, v72, v73
    v_cvt_pk_bf16_f32 v215, v74, v75
    buffer_store_dwordx4 v[212:215], v13, s[48:51], s77 offen
    v_cvt_pk_bf16_f32 v216, v96, v97
    v_cvt_pk_bf16_f32 v217, v98, v99
    v_cvt_pk_bf16_f32 v218, v104, v105
    v_cvt_pk_bf16_f32 v219, v106, v107
    buffer_store_dwordx4 v[216:219], v13, s[48:51], s77 offen offset:16
    v_add_f32 v68, v68, v80
    v_add_f32 v69, v69, v81
    v_add_f32 v70, v70, v82
    v_add_f32 v71, v71, v83
    v_add_f32 v76, v76, v84
    v_add_f32 v77, v77, v85
    v_add_f32 v78, v78, v86
    v_add_f32 v79, v79, v87
    v_add_f32 v100, v100, v88
    v_add_f32 v101, v101, v89
    v_add_f32 v102, v102, v90
    v_add_f32 v103, v103, v91
    v_add_f32 v108, v108, v92
    v_add_f32 v109, v109, v93
    v_add_f32 v110, v110, v94
    v_add_f32 v111, v111, v95
    v_cvt_pk_bf16_f32 v220, v68, v69
    v_cvt_pk_bf16_f32 v221, v70, v71
    v_cvt_pk_bf16_f32 v222, v76, v77
    v_cvt_pk_bf16_f32 v223, v78, v79
    buffer_store_dwordx4 v[220:223], v13, s[48:51], s78 offen
    v_cvt_pk_bf16_f32 v224, v100, v101
    v_cvt_pk_bf16_f32 v225, v102, v103
    v_cvt_pk_bf16_f32 v226, v108, v109
    v_cvt_pk_bf16_f32 v227, v110, v111
    buffer_store_dwordx4 v[224:227], v13, s[48:51], s78 offen offset:16
    s_endpgm
K2_RSCALED:
    s_waitcnt vmcnt(0) lgkmcnt(0)
    v_mov_b32 v228, v66
    v_mov_b32 v229, v66
    s_nop 1
    v_permlane16_swap_b32 v228, v229
    v_mov_b32 v230, v228
    v_mov_b32 v231, v229
    s_nop 0
    v_permlane32_swap_b32 v228, v230
    v_permlane32_swap_b32 v229, v231
    v_mov_b32 v232, v68
    v_mov_b32 v233, v68
    s_nop 1
    v_permlane16_swap_b32 v232, v233
    v_mov_b32 v234, v232
    v_mov_b32 v235, v233
    s_nop 0
    v_permlane32_swap_b32 v232, v234
    v_permlane32_swap_b32 v233, v235
    v_mov_b32 v236, v70
    v_mov_b32 v237, v70
    s_nop 1
    v_permlane16_swap_b32 v236, v237
    v_mov_b32 v238, v236
    v_mov_b32 v239, v237
    s_nop 0
    v_permlane32_swap_b32 v236, v238
    v_permlane32_swap_b32 v237, v239
    v_mov_b32 v240, v72
    v_mov_b32 v241, v72
    s_nop 1
    v_permlane16_swap_b32 v240, v241
    v_mov_b32 v242, v240
    v_mov_b32 v243, v241
    s_nop 0
    v_permlane32_swap_b32 v240, v242
    v_permlane32_swap_b32 v241, v243
    v_cndmask_b32 v116, v228, v230, s[90:91]
    v_cndmask_b32 v230, v230, v228, s[90:91]
    v_mov_b32 v228, v116
    v_cndmask_b32 v116, v229, v231, s[90:91]
    v_cndmask_b32 v231, v231, v229, s[90:91]
    v_mov_b32 v229, v116
    v_cndmask_b32 v116, v232, v234, s[90:91]
    v_cndmask_b32 v234, v234, v232, s[90:91]
    v_mov_b32 v232, v116
    v_cndmask_b32 v116, v233, v235, s[90:91]
    v_cndmask_b32 v235, v235, v233, s[90:91]
    v_mov_b32 v233, v116
    v_cndmask_b32 v116, v236, v238, s[90:91]
    v_cndmask_b32 v238, v238, v236, s[90:91]
    v_mov_b32 v236, v116
    v_cndmask_b32 v116, v237, v239, s[90:91]
    v_cndmask_b32 v239, v239, v237, s[90:91]
    v_mov_b32 v237, v116
    v_cndmask_b32 v116, v240, v242, s[90:91]
    v_cndmask_b32 v242, v242, v240, s[90:91]
    v_mov_b32 v240, v116
    v_cndmask_b32 v116, v241, v243, s[90:91]
    v_cndmask_b32 v243, v243, v241, s[90:91]
    v_mov_b32 v241, v116
    ds_read_b128 v[48:51], v12 offset:2048
    s_waitcnt lgkmcnt(0)
    v_lshlrev_b32 v116, 16, v48
    v_and_b32 v117, 0xffff0000, v48
    v_mul_f32 v116, v116, v230
    v_mul_f32 v117, v117, v230
    v_cvt_pk_bf16_f32 v48, v116, v117
    v_lshlrev_b32 v116, 16, v49
    v_and_b32 v117, 0xffff0000, v49
    v_mul_f32 v116, v116, v230
    v_mul_f32 v117, v117, v230
    v_cvt_pk_bf16_f32 v49, v116, v117
    v_lshlrev_b32 v116, 16, v50
    v_and_b32 v117, 0xffff0000, v50
    v_mul_f32 v116, v116, v230
    v_mul_f32 v117, v117, v230
    v_cvt_pk_bf16_f32 v50, v116, v117
    v_lshlrev_b32 v116, 16, v51
    v_and_b32 v117, 0xffff0000, v51
    v_mul_f32 v116, v116, v230
    v_mul_f32 v117, v117, v230
    v_cvt_pk_bf16_f32 v51, v116, v117
    s_nop 1
    v_mfma_f32_16x16x32_bf16 v[136:139], v[16:19], v[48:51], 0
    v_mfma_f32_16x16x32_bf16 v[152:155], v[20:23], v[48:51], 0
    s_nop 7
    ds_read_b128 v[48:51], v12 offset:3072
    s_waitcnt lgkmcnt(0)
    v_lshlrev_b32 v116, 16, v48
    v_and_b32 v117, 0xffff0000, v48
    v_mul_f32 v116, v116, v231
    v_mul_f32 v117, v117, v231
    v_cvt_pk_bf16_f32 v48, v116, v117
    v_lshlrev_b32 v116, 16, v49
    v_and_b32 v117, 0xffff0000, v49
    v_mul_f32 v116, v116, v231
    v_mul_f32 v117, v117, v231
    v_cvt_pk_bf16_f32 v49, v116, v117
    v_lshlrev_b32 v116, 16, v50
    v_and_b32 v117, 0xffff0000, v50
    v_mul_f32 v116, v116, v231
    v_mul_f32 v117, v117, v231
    v_cvt_pk_bf16_f32 v50, v116, v117
    v_lshlrev_b32 v116, 16, v51
    v_and_b32 v117, 0xffff0000, v51
    v_mul_f32 v116, v116, v231
    v_mul_f32 v117, v117, v231
    v_cvt_pk_bf16_f32 v51, v116, v117
    s_nop 1
    v_mfma_f32_16x16x32_bf16 v[140:143], v[16:19], v[48:51], 0
    v_mfma_f32_16x16x32_bf16 v[156:159], v[20:23], v[48:51], 0
    s_nop 7
    ds_read_b128 v[48:51], v11
    s_waitcnt lgkmcnt(0)
    v_lshlrev_b32 v116, 16, v48
    v_and_b32 v117, 0xffff0000, v48
    v_mul_f32 v116, v116, v228
    v_mul_f32 v117, v117, v228
    v_cvt_pk_bf16_f32 v48, v116, v117
    v_lshlrev_b32 v116, 16, v49
    v_and_b32 v117, 0xffff0000, v49
    v_mul_f32 v116, v116, v228
    v_mul_f32 v117, v117, v228
    v_cvt_pk_bf16_f32 v49, v116, v117
    v_lshlrev_b32 v116, 16, v50
    v_and_b32 v117, 0xffff0000, v50
    v_mul_f32 v116, v116, v228
    v_mul_f32 v117, v117, v228
    v_cvt_pk_bf16_f32 v50, v116, v117
    v_lshlrev_b32 v116, 16, v51
    v_and_b32 v117, 0xffff0000, v51
    v_mul_f32 v116, v116, v228
    v_mul_f32 v117, v117, v228
    v_cvt_pk_bf16_f32 v51, v116, v117
    s_nop 1
    v_mfma_f32_16x16x32_bf16 v[128:131], v[16:19], v[48:51], 0
    v_mfma_f32_16x16x32_bf16 v[144:147], v[20:23], v[48:51], 0
    s_nop 7
    ds_read_b128 v[48:51], v11 offset:1024
    s_waitcnt lgkmcnt(0)
    v_lshlrev_b32 v116, 16, v48
    v_and_b32 v117, 0xffff0000, v48
    v_mul_f32 v116, v116, v229
    v_mul_f32 v117, v117, v229
    v_cvt_pk_bf16_f32 v48, v116, v117
    v_lshlrev_b32 v116, 16, v49
    v_and_b32 v117, 0xffff0000, v49
    v_mul_f32 v116, v116, v229
    v_mul_f32 v117, v117, v229
    v_cvt_pk_bf16_f32 v49, v116, v117
    v_lshlrev_b32 v116, 16, v50
    v_and_b32 v117, 0xffff0000, v50
    v_mul_f32 v116, v116, v229
    v_mul_f32 v117, v117, v229
    v_cvt_pk_bf16_f32 v50, v116, v117
    v_lshlrev_b32 v116, 16, v51
    v_and_b32 v117, 0xffff0000, v51
    v_mul_f32 v116, v116, v229
    v_mul_f32 v117, v117, v229
    v_cvt_pk_bf16_f32 v51, v116, v117
    s_nop 1
    v_mfma_f32_16x16x32_bf16 v[132:135], v[16:19], v[48:51], 0
    v_mfma_f32_16x16x32_bf16 v[148:151], v[20:23], v[48:51], 0
    s_nop 7
    ds_read_b128 v[48:51], v12 offset:6144
    s_waitcnt lgkmcnt(0)
    v_lshlrev_b32 v116, 16, v48
    v_and_b32 v117, 0xffff0000, v48
    v_mul_f32 v116, v116, v230
    v_mul_f32 v117, v117, v230
    v_cvt_pk_bf16_f32 v48, v116, v117
    v_lshlrev_b32 v116, 16, v49
    v_and_b32 v117, 0xffff0000, v49
    v_mul_f32 v116, v116, v230
    v_mul_f32 v117, v117, v230
    v_cvt_pk_bf16_f32 v49, v116, v117
    v_lshlrev_b32 v116, 16, v50
    v_and_b32 v117, 0xffff0000, v50
    v_mul_f32 v116, v116, v230
    v_mul_f32 v117, v117, v230
    v_cvt_pk_bf16_f32 v50, v116, v117
    v_lshlrev_b32 v116, 16, v51
    v_and_b32 v117, 0xffff0000, v51
    v_mul_f32 v116, v116, v230
    v_mul_f32 v117, v117, v230
    v_cvt_pk_bf16_f32 v51, v116, v117
    s_nop 1
    v_mfma_f32_16x16x32_bf16 v[168:171], v[16:19], v[48:51], 0
    v_mfma_f32_16x16x32_bf16 v[184:187], v[20:23], v[48:51], 0
    s_nop 7
    ds_read_b128 v[48:51], v12 offset:7168
    s_waitcnt lgkmcnt(0)
    v_lshlrev_b32 v116, 16, v48
    v_and_b32 v117, 0xffff0000, v48
    v_mul_f32 v116, v116, v231
    v_mul_f32 v117, v117, v231
    v_cvt_pk_bf16_f32 v48, v116, v117
    v_lshlrev_b32 v116, 16, v49
    v_and_b32 v117, 0xffff0000, v49
    v_mul_f32 v116, v116, v231
    v_mul_f32 v117, v117, v231
    v_cvt_pk_bf16_f32 v49, v116, v117
    v_lshlrev_b32 v116, 16, v50
    v_and_b32 v117, 0xffff0000, v50
    v_mul_f32 v116, v116, v231
    v_mul_f32 v117, v117, v231
    v_cvt_pk_bf16_f32 v50, v116, v117
    v_lshlrev_b32 v116, 16, v51
    v_and_b32 v117, 0xffff0000, v51
    v_mul_f32 v116, v116, v231
    v_mul_f32 v117, v117, v231
    v_cvt_pk_bf16_f32 v51, v116, v117
    s_nop 1
    v_mfma_f32_16x16x32_bf16 v[172:175], v[16:19], v[48:51], 0
    v_mfma_f32_16x16x32_bf16 v[188:191], v[20:23], v[48:51], 0
    s_nop 7
    ds_read_b128 v[48:51], v11 offset:4096
    s_waitcnt lgkmcnt(0)
    v_lshlrev_b32 v116, 16, v48
    v_and_b32 v117, 0xffff0000, v48
    v_mul_f32 v116, v116, v228
    v_mul_f32 v117, v117, v228
    v_cvt_pk_bf16_f32 v48, v116, v117
    v_lshlrev_b32 v116, 16, v49
    v_and_b32 v117, 0xffff0000, v49
    v_mul_f32 v116, v116, v228
    v_mul_f32 v117, v117, v228
    v_cvt_pk_bf16_f32 v49, v116, v117
    v_lshlrev_b32 v116, 16, v50
    v_and_b32 v117, 0xffff0000, v50
    v_mul_f32 v116, v116, v228
    v_mul_f32 v117, v117, v228
    v_cvt_pk_bf16_f32 v50, v116, v117
    v_lshlrev_b32 v116, 16, v51
    v_and_b32 v117, 0xffff0000, v51
    v_mul_f32 v116, v116, v228
    v_mul_f32 v117, v117, v228
    v_cvt_pk_bf16_f32 v51, v116, v117
    s_nop 1
    v_mfma_f32_16x16x32_bf16 v[160:163], v[16:19], v[48:51], 0
    v_mfma_f32_16x16x32_bf16 v[176:179], v[20:23], v[48:51], 0
    s_nop 7
    ds_read_b128 v[48:51], v11 offset:5120
    s_waitcnt lgkmcnt(0)
    v_lshlrev_b32 v116, 16, v48
    v_and_b32 v117, 0xffff0000, v48
    v_mul_f32 v116, v116, v229
    v_mul_f32 v117, v117, v229
    v_cvt_pk_bf16_f32 v48, v116, v117
    v_lshlrev_b32 v116, 16, v49
    v_and_b32 v117, 0xffff0000, v49
    v_mul_f32 v116, v116, v229
    v_mul_f32 v117, v117, v229
    v_cvt_pk_bf16_f32 v49, v116, v117
    v_lshlrev_b32 v116, 16, v50
    v_and_b32 v117, 0xffff0000, v50
    v_mul_f32 v116, v116, v229
    v_mul_f32 v117, v117, v229
    v_cvt_pk_bf16_f32 v50, v116, v117
    v_lshlrev_b32 v116, 16, v51
    v_and_b32 v117, 0xffff0000, v51
    v_mul_f32 v116, v116, v229
    v_mul_f32 v117, v117, v229
    v_cvt_pk_bf16_f32 v51, v116, v117
    s_nop 1
    v_mfma_f32_16x16x32_bf16 v[164:167], v[16:19], v[48:51], 0
    v_mfma_f32_16x16x32_bf16 v[180:183], v[20:23], v[48:51], 0
    s_nop 7
    ds_read_b128 v[48:51], v29 offset:2048
    s_waitcnt lgkmcnt(0)
    v_lshlrev_b32 v116, 16, v48
    v_and_b32 v117, 0xffff0000, v48
    v_mul_f32 v116, v116, v234
    v_mul_f32 v117, v117, v234
    v_cvt_pk_bf16_f32 v48, v116, v117
    v_lshlrev_b32 v116, 16, v49
    v_and_b32 v117, 0xffff0000, v49
    v_mul_f32 v116, v116, v234
    v_mul_f32 v117, v117, v234
    v_cvt_pk_bf16_f32 v49, v116, v117
    v_lshlrev_b32 v116, 16, v50
    v_and_b32 v117, 0xffff0000, v50
    v_mul_f32 v116, v116, v234
    v_mul_f32 v117, v117, v234
    v_cvt_pk_bf16_f32 v50, v116, v117
    v_lshlrev_b32 v116, 16, v51
    v_and_b32 v117, 0xffff0000, v51
    v_mul_f32 v116, v116, v234
    v_mul_f32 v117, v117, v234
    v_cvt_pk_bf16_f32 v51, v116, v117
    s_nop 1
    v_mfma_f32_16x16x32_bf16 v[136:139], v[16:19], v[48:51], v[136:139]
    v_mfma_f32_16x16x32_bf16 v[152:155], v[20:23], v[48:51], v[152:155]
    s_nop 7
    ds_read_b128 v[48:51], v29 offset:3072
    s_waitcnt lgkmcnt(0)
    v_lshlrev_b32 v116, 16, v48
    v_and_b32 v117, 0xffff0000, v48
    v_mul_f32 v116, v116, v235
    v_mul_f32 v117, v117, v235
    v_cvt_pk_bf16_f32 v48, v116, v117
    v_lshlrev_b32 v116, 16, v49
    v_and_b32 v117, 0xffff0000, v49
    v_mul_f32 v116, v116, v235
    v_mul_f32 v117, v117, v235
    v_cvt_pk_bf16_f32 v49, v116, v117
    v_lshlrev_b32 v116, 16, v50
    v_and_b32 v117, 0xffff0000, v50
    v_mul_f32 v116, v116, v235
    v_mul_f32 v117, v117, v235
    v_cvt_pk_bf16_f32 v50, v116, v117
    v_lshlrev_b32 v116, 16, v51
    v_and_b32 v117, 0xffff0000, v51
    v_mul_f32 v116, v116, v235
    v_mul_f32 v117, v117, v235
    v_cvt_pk_bf16_f32 v51, v116, v117
    s_nop 1
    v_mfma_f32_16x16x32_bf16 v[140:143], v[16:19], v[48:51], v[140:143]
    v_mfma_f32_16x16x32_bf16 v[156:159], v[20:23], v[48:51], v[156:159]
    s_nop 7
    ds_read_b128 v[48:51], v28
    s_waitcnt lgkmcnt(0)
    v_lshlrev_b32 v116, 16, v48
    v_and_b32 v117, 0xffff0000, v48
    v_mul_f32 v116, v116, v232
    v_mul_f32 v117, v117, v232
    v_cvt_pk_bf16_f32 v48, v116, v117
    v_lshlrev_b32 v116, 16, v49
    v_and_b32 v117, 0xffff0000, v49
    v_mul_f32 v116, v116, v232
    v_mul_f32 v117, v117, v232
    v_cvt_pk_bf16_f32 v49, v116, v117
    v_lshlrev_b32 v116, 16, v50
    v_and_b32 v117, 0xffff0000, v50
    v_mul_f32 v116, v116, v232
    v_mul_f32 v117, v117, v232
    v_cvt_pk_bf16_f32 v50, v116, v117
    v_lshlrev_b32 v116, 16, v51
    v_and_b32 v117, 0xffff0000, v51
    v_mul_f32 v116, v116, v232
    v_mul_f32 v117, v117, v232
    v_cvt_pk_bf16_f32 v51, v116, v117
    s_nop 1
    v_mfma_f32_16x16x32_bf16 v[128:131], v[16:19], v[48:51], v[128:131]
    v_mfma_f32_16x16x32_bf16 v[144:147], v[20:23], v[48:51], v[144:147]
    s_nop 7
    ds_read_b128 v[48:51], v28 offset:1024
    s_waitcnt lgkmcnt(0)
    v_lshlrev_b32 v116, 16, v48
    v_and_b32 v117, 0xffff0000, v48
    v_mul_f32 v116, v116, v233
    v_mul_f32 v117, v117, v233
    v_cvt_pk_bf16_f32 v48, v116, v117
    v_lshlrev_b32 v116, 16, v49
    v_and_b32 v117, 0xffff0000, v49
    v_mul_f32 v116, v116, v233
    v_mul_f32 v117, v117, v233
    v_cvt_pk_bf16_f32 v49, v116, v117
    v_lshlrev_b32 v116, 16, v50
    v_and_b32 v117, 0xffff0000, v50
    v_mul_f32 v116, v116, v233
    v_mul_f32 v117, v117, v233
    v_cvt_pk_bf16_f32 v50, v116, v117
    v_lshlrev_b32 v116, 16, v51
    v_and_b32 v117, 0xffff0000, v51
    v_mul_f32 v116, v116, v233
    v_mul_f32 v117, v117, v233
    v_cvt_pk_bf16_f32 v51, v116, v117
    s_nop 1
    v_mfma_f32_16x16x32_bf16 v[132:135], v[16:19], v[48:51], v[132:135]
    v_mfma_f32_16x16x32_bf16 v[148:151], v[20:23], v[48:51], v[148:151]
    s_nop 7
    ds_read_b128 v[48:51], v29 offset:6144
    s_waitcnt lgkmcnt(0)
    v_lshlrev_b32 v116, 16, v48
    v_and_b32 v117, 0xffff0000, v48
    v_mul_f32 v116, v116, v234
    v_mul_f32 v117, v117, v234
    v_cvt_pk_bf16_f32 v48, v116, v117
    v_lshlrev_b32 v116, 16, v49
    v_and_b32 v117, 0xffff0000, v49
    v_mul_f32 v116, v116, v234
    v_mul_f32 v117, v117, v234
    v_cvt_pk_bf16_f32 v49, v116, v117
    v_lshlrev_b32 v116, 16, v50
    v_and_b32 v117, 0xffff0000, v50
    v_mul_f32 v116, v116, v234
    v_mul_f32 v117, v117, v234
    v_cvt_pk_bf16_f32 v50, v116, v117
    v_lshlrev_b32 v116, 16, v51
    v_and_b32 v117, 0xffff0000, v51
    v_mul_f32 v116, v116, v234
    v_mul_f32 v117, v117, v234
    v_cvt_pk_bf16_f32 v51, v116, v117
    s_nop 1
    v_mfma_f32_16x16x32_bf16 v[168:171], v[16:19], v[48:51], v[168:171]
    v_mfma_f32_16x16x32_bf16 v[184:187], v[20:23], v[48:51], v[184:187]
    s_nop 7
    ds_read_b128 v[48:51], v29 offset:7168
    s_waitcnt lgkmcnt(0)
    v_lshlrev_b32 v116, 16, v48
    v_and_b32 v117, 0xffff0000, v48
    v_mul_f32 v116, v116, v235
    v_mul_f32 v117, v117, v235
    v_cvt_pk_bf16_f32 v48, v116, v117
    v_lshlrev_b32 v116, 16, v49
    v_and_b32 v117, 0xffff0000, v49
    v_mul_f32 v116, v116, v235
    v_mul_f32 v117, v117, v235
    v_cvt_pk_bf16_f32 v49, v116, v117
    v_lshlrev_b32 v116, 16, v50
    v_and_b32 v117, 0xffff0000, v50
    v_mul_f32 v116, v116, v235
    v_mul_f32 v117, v117, v235
    v_cvt_pk_bf16_f32 v50, v116, v117
    v_lshlrev_b32 v116, 16, v51
    v_and_b32 v117, 0xffff0000, v51
    v_mul_f32 v116, v116, v235
    v_mul_f32 v117, v117, v235
    v_cvt_pk_bf16_f32 v51, v116, v117
    s_nop 1
    v_mfma_f32_16x16x32_bf16 v[172:175], v[16:19], v[48:51], v[172:175]
    v_mfma_f32_16x16x32_bf16 v[188:191], v[20:23], v[48:51], v[188:191]
    s_nop 7
    ds_read_b128 v[48:51], v28 offset:4096
    s_waitcnt lgkmcnt(0)
    v_lshlrev_b32 v116, 16, v48
    v_and_b32 v117, 0xffff0000, v48
    v_mul_f32 v116, v116, v232
    v_mul_f32 v117, v117, v232
    v_cvt_pk_bf16_f32 v48, v116, v117
    v_lshlrev_b32 v116, 16, v49
    v_and_b32 v117, 0xffff0000, v49
    v_mul_f32 v116, v116, v232
    v_mul_f32 v117, v117, v232
    v_cvt_pk_bf16_f32 v49, v116, v117
    v_lshlrev_b32 v116, 16, v50
    v_and_b32 v117, 0xffff0000, v50
    v_mul_f32 v116, v116, v232
    v_mul_f32 v117, v117, v232
    v_cvt_pk_bf16_f32 v50, v116, v117
    v_lshlrev_b32 v116, 16, v51
    v_and_b32 v117, 0xffff0000, v51
    v_mul_f32 v116, v116, v232
    v_mul_f32 v117, v117, v232
    v_cvt_pk_bf16_f32 v51, v116, v117
    s_nop 1
    v_mfma_f32_16x16x32_bf16 v[160:163], v[16:19], v[48:51], v[160:163]
    v_mfma_f32_16x16x32_bf16 v[176:179], v[20:23], v[48:51], v[176:179]
    s_nop 7
    ds_read_b128 v[48:51], v28 offset:5120
    s_waitcnt lgkmcnt(0)
    v_lshlrev_b32 v116, 16, v48
    v_and_b32 v117, 0xffff0000, v48
    v_mul_f32 v116, v116, v233
    v_mul_f32 v117, v117, v233
    v_cvt_pk_bf16_f32 v48, v116, v117
    v_lshlrev_b32 v116, 16, v49
    v_and_b32 v117, 0xffff0000, v49
    v_mul_f32 v116, v116, v233
    v_mul_f32 v117, v117, v233
    v_cvt_pk_bf16_f32 v49, v116, v117
    v_lshlrev_b32 v116, 16, v50
    v_and_b32 v117, 0xffff0000, v50
    v_mul_f32 v116, v116, v233
    v_mul_f32 v117, v117, v233
    v_cvt_pk_bf16_f32 v50, v116, v117
    v_lshlrev_b32 v116, 16, v51
    v_and_b32 v117, 0xffff0000, v51
    v_mul_f32 v116, v116, v233
    v_mul_f32 v117, v117, v233
    v_cvt_pk_bf16_f32 v51, v116, v117
    s_nop 1
    v_mfma_f32_16x16x32_bf16 v[164:167], v[16:19], v[48:51], v[164:167]
    v_mfma_f32_16x16x32_bf16 v[180:183], v[20:23], v[48:51], v[180:183]
    s_nop 7
    ds_read_b128 v[48:51], v31 offset:2048
    s_waitcnt lgkmcnt(0)
    v_lshlrev_b32 v116, 16, v48
    v_and_b32 v117, 0xffff0000, v48
    v_mul_f32 v116, v116, v238
    v_mul_f32 v117, v117, v238
    v_cvt_pk_bf16_f32 v48, v116, v117
    v_lshlrev_b32 v116, 16, v49
    v_and_b32 v117, 0xffff0000, v49
    v_mul_f32 v116, v116, v238
    v_mul_f32 v117, v117, v238
    v_cvt_pk_bf16_f32 v49, v116, v117
    v_lshlrev_b32 v116, 16, v50
    v_and_b32 v117, 0xffff0000, v50
    v_mul_f32 v116, v116, v238
    v_mul_f32 v117, v117, v238
    v_cvt_pk_bf16_f32 v50, v116, v117
    v_lshlrev_b32 v116, 16, v51
    v_and_b32 v117, 0xffff0000, v51
    v_mul_f32 v116, v116, v238
    v_mul_f32 v117, v117, v238
    v_cvt_pk_bf16_f32 v51, v116, v117
    s_nop 1
    v_mfma_f32_16x16x32_bf16 v[136:139], v[16:19], v[48:51], v[136:139]
    v_mfma_f32_16x16x32_bf16 v[152:155], v[20:23], v[48:51], v[152:155]
    s_nop 7
    ds_read_b128 v[48:51], v31 offset:3072
    s_waitcnt lgkmcnt(0)
    v_lshlrev_b32 v116, 16, v48
    v_and_b32 v117, 0xffff0000, v48
    v_mul_f32 v116, v116, v239
    v_mul_f32 v117, v117, v239
    v_cvt_pk_bf16_f32 v48, v116, v117
    v_lshlrev_b32 v116, 16, v49
    v_and_b32 v117, 0xffff0000, v49
    v_mul_f32 v116, v116, v239
    v_mul_f32 v117, v117, v239
    v_cvt_pk_bf16_f32 v49, v116, v117
    v_lshlrev_b32 v116, 16, v50
    v_and_b32 v117, 0xffff0000, v50
    v_mul_f32 v116, v116, v239
    v_mul_f32 v117, v117, v239
    v_cvt_pk_bf16_f32 v50, v116, v117
    v_lshlrev_b32 v116, 16, v51
    v_and_b32 v117, 0xffff0000, v51
    v_mul_f32 v116, v116, v239
    v_mul_f32 v117, v117, v239
    v_cvt_pk_bf16_f32 v51, v116, v117
    s_nop 1
    v_mfma_f32_16x16x32_bf16 v[140:143], v[16:19], v[48:51], v[140:143]
    v_mfma_f32_16x16x32_bf16 v[156:159], v[20:23], v[48:51], v[156:159]
    s_nop 7
    ds_read_b128 v[48:51], v30
    s_waitcnt lgkmcnt(0)
    v_lshlrev_b32 v116, 16, v48
    v_and_b32 v117, 0xffff0000, v48
    v_mul_f32 v116, v116, v236
    v_mul_f32 v117, v117, v236
    v_cvt_pk_bf16_f32 v48, v116, v117
    v_lshlrev_b32 v116, 16, v49
    v_and_b32 v117, 0xffff0000, v49
    v_mul_f32 v116, v116, v236
    v_mul_f32 v117, v117, v236
    v_cvt_pk_bf16_f32 v49, v116, v117
    v_lshlrev_b32 v116, 16, v50
    v_and_b32 v117, 0xffff0000, v50
    v_mul_f32 v116, v116, v236
    v_mul_f32 v117, v117, v236
    v_cvt_pk_bf16_f32 v50, v116, v117
    v_lshlrev_b32 v116, 16, v51
    v_and_b32 v117, 0xffff0000, v51
    v_mul_f32 v116, v116, v236
    v_mul_f32 v117, v117, v236
    v_cvt_pk_bf16_f32 v51, v116, v117
    s_nop 1
    v_mfma_f32_16x16x32_bf16 v[128:131], v[16:19], v[48:51], v[128:131]
    v_mfma_f32_16x16x32_bf16 v[144:147], v[20:23], v[48:51], v[144:147]
    s_nop 7
    ds_read_b128 v[48:51], v30 offset:1024
    s_waitcnt lgkmcnt(0)
    v_lshlrev_b32 v116, 16, v48
    v_and_b32 v117, 0xffff0000, v48
    v_mul_f32 v116, v116, v237
    v_mul_f32 v117, v117, v237
    v_cvt_pk_bf16_f32 v48, v116, v117
    v_lshlrev_b32 v116, 16, v49
    v_and_b32 v117, 0xffff0000, v49
    v_mul_f32 v116, v116, v237
    v_mul_f32 v117, v117, v237
    v_cvt_pk_bf16_f32 v49, v116, v117
    v_lshlrev_b32 v116, 16, v50
    v_and_b32 v117, 0xffff0000, v50
    v_mul_f32 v116, v116, v237
    v_mul_f32 v117, v117, v237
    v_cvt_pk_bf16_f32 v50, v116, v117
    v_lshlrev_b32 v116, 16, v51
    v_and_b32 v117, 0xffff0000, v51
    v_mul_f32 v116, v116, v237
    v_mul_f32 v117, v117, v237
    v_cvt_pk_bf16_f32 v51, v116, v117
    s_nop 1
    v_mfma_f32_16x16x32_bf16 v[132:135], v[16:19], v[48:51], v[132:135]
    v_mfma_f32_16x16x32_bf16 v[148:151], v[20:23], v[48:51], v[148:151]
    s_nop 7
    ds_read_b128 v[48:51], v31 offset:6144
    s_waitcnt lgkmcnt(0)
    v_lshlrev_b32 v116, 16, v48
    v_and_b32 v117, 0xffff0000, v48
    v_mul_f32 v116, v116, v238
    v_mul_f32 v117, v117, v238
    v_cvt_pk_bf16_f32 v48, v116, v117
    v_lshlrev_b32 v116, 16, v49
    v_and_b32 v117, 0xffff0000, v49
    v_mul_f32 v116, v116, v238
    v_mul_f32 v117, v117, v238
    v_cvt_pk_bf16_f32 v49, v116, v117
    v_lshlrev_b32 v116, 16, v50
    v_and_b32 v117, 0xffff0000, v50
    v_mul_f32 v116, v116, v238
    v_mul_f32 v117, v117, v238
    v_cvt_pk_bf16_f32 v50, v116, v117
    v_lshlrev_b32 v116, 16, v51
    v_and_b32 v117, 0xffff0000, v51
    v_mul_f32 v116, v116, v238
    v_mul_f32 v117, v117, v238
    v_cvt_pk_bf16_f32 v51, v116, v117
    s_nop 1
    v_mfma_f32_16x16x32_bf16 v[168:171], v[16:19], v[48:51], v[168:171]
    v_mfma_f32_16x16x32_bf16 v[184:187], v[20:23], v[48:51], v[184:187]
    s_nop 7
    ds_read_b128 v[48:51], v31 offset:7168
    s_waitcnt lgkmcnt(0)
    v_lshlrev_b32 v116, 16, v48
    v_and_b32 v117, 0xffff0000, v48
    v_mul_f32 v116, v116, v239
    v_mul_f32 v117, v117, v239
    v_cvt_pk_bf16_f32 v48, v116, v117
    v_lshlrev_b32 v116, 16, v49
    v_and_b32 v117, 0xffff0000, v49
    v_mul_f32 v116, v116, v239
    v_mul_f32 v117, v117, v239
    v_cvt_pk_bf16_f32 v49, v116, v117
    v_lshlrev_b32 v116, 16, v50
    v_and_b32 v117, 0xffff0000, v50
    v_mul_f32 v116, v116, v239
    v_mul_f32 v117, v117, v239
    v_cvt_pk_bf16_f32 v50, v116, v117
    v_lshlrev_b32 v116, 16, v51
    v_and_b32 v117, 0xffff0000, v51
    v_mul_f32 v116, v116, v239
    v_mul_f32 v117, v117, v239
    v_cvt_pk_bf16_f32 v51, v116, v117
    s_nop 1
    v_mfma_f32_16x16x32_bf16 v[172:175], v[16:19], v[48:51], v[172:175]
    v_mfma_f32_16x16x32_bf16 v[188:191], v[20:23], v[48:51], v[188:191]
    s_nop 7
    ds_read_b128 v[48:51], v30 offset:4096
    s_waitcnt lgkmcnt(0)
    v_lshlrev_b32 v116, 16, v48
    v_and_b32 v117, 0xffff0000, v48
    v_mul_f32 v116, v116, v236
    v_mul_f32 v117, v117, v236
    v_cvt_pk_bf16_f32 v48, v116, v117
    v_lshlrev_b32 v116, 16, v49
    v_and_b32 v117, 0xffff0000, v49
    v_mul_f32 v116, v116, v236
    v_mul_f32 v117, v117, v236
    v_cvt_pk_bf16_f32 v49, v116, v117
    v_lshlrev_b32 v116, 16, v50
    v_and_b32 v117, 0xffff0000, v50
    v_mul_f32 v116, v116, v236
    v_mul_f32 v117, v117, v236
    v_cvt_pk_bf16_f32 v50, v116, v117
    v_lshlrev_b32 v116, 16, v51
    v_and_b32 v117, 0xffff0000, v51
    v_mul_f32 v116, v116, v236
    v_mul_f32 v117, v117, v236
    v_cvt_pk_bf16_f32 v51, v116, v117
    s_nop 1
    v_mfma_f32_16x16x32_bf16 v[160:163], v[16:19], v[48:51], v[160:163]
    v_mfma_f32_16x16x32_bf16 v[176:179], v[20:23], v[48:51], v[176:179]
    s_nop 7
    ds_read_b128 v[48:51], v30 offset:5120
    s_waitcnt lgkmcnt(0)
    v_lshlrev_b32 v116, 16, v48
    v_and_b32 v117, 0xffff0000, v48
    v_mul_f32 v116, v116, v237
    v_mul_f32 v117, v117, v237
    v_cvt_pk_bf16_f32 v48, v116, v117
    v_lshlrev_b32 v116, 16, v49
    v_and_b32 v117, 0xffff0000, v49
    v_mul_f32 v116, v116, v237
    v_mul_f32 v117, v117, v237
    v_cvt_pk_bf16_f32 v49, v116, v117
    v_lshlrev_b32 v116, 16, v50
    v_and_b32 v117, 0xffff0000, v50
    v_mul_f32 v116, v116, v237
    v_mul_f32 v117, v117, v237
    v_cvt_pk_bf16_f32 v50, v116, v117
    v_lshlrev_b32 v116, 16, v51
    v_and_b32 v117, 0xffff0000, v51
    v_mul_f32 v116, v116, v237
    v_mul_f32 v117, v117, v237
    v_cvt_pk_bf16_f32 v51, v116, v117
    s_nop 1
    v_mfma_f32_16x16x32_bf16 v[164:167], v[16:19], v[48:51], v[164:167]
    v_mfma_f32_16x16x32_bf16 v[180:183], v[20:23], v[48:51], v[180:183]
    s_nop 7
    ds_read_b128 v[48:51], v27 offset:2048
    s_waitcnt lgkmcnt(0)
    v_lshlrev_b32 v116, 16, v48
    v_and_b32 v117, 0xffff0000, v48
    v_mul_f32 v116, v116, v242
    v_mul_f32 v117, v117, v242
    v_cvt_pk_bf16_f32 v48, v116, v117
    v_lshlrev_b32 v116, 16, v49
    v_and_b32 v117, 0xffff0000, v49
    v_mul_f32 v116, v116, v242
    v_mul_f32 v117, v117, v242
    v_cvt_pk_bf16_f32 v49, v116, v117
    v_lshlrev_b32 v116, 16, v50
    v_and_b32 v117, 0xffff0000, v50
    v_mul_f32 v116, v116, v242
    v_mul_f32 v117, v117, v242
    v_cvt_pk_bf16_f32 v50, v116, v117
    v_lshlrev_b32 v116, 16, v51
    v_and_b32 v117, 0xffff0000, v51
    v_mul_f32 v116, v116, v242
    v_mul_f32 v117, v117, v242
    v_cvt_pk_bf16_f32 v51, v116, v117
    s_nop 1
    v_mfma_f32_16x16x32_bf16 v[136:139], v[16:19], v[48:51], v[136:139]
    v_mfma_f32_16x16x32_bf16 v[152:155], v[20:23], v[48:51], v[152:155]
    s_nop 7
    ds_read_b128 v[48:51], v27 offset:3072
    s_waitcnt lgkmcnt(0)
    v_lshlrev_b32 v116, 16, v48
    v_and_b32 v117, 0xffff0000, v48
    v_mul_f32 v116, v116, v243
    v_mul_f32 v117, v117, v243
    v_cvt_pk_bf16_f32 v48, v116, v117
    v_lshlrev_b32 v116, 16, v49
    v_and_b32 v117, 0xffff0000, v49
    v_mul_f32 v116, v116, v243
    v_mul_f32 v117, v117, v243
    v_cvt_pk_bf16_f32 v49, v116, v117
    v_lshlrev_b32 v116, 16, v50
    v_and_b32 v117, 0xffff0000, v50
    v_mul_f32 v116, v116, v243
    v_mul_f32 v117, v117, v243
    v_cvt_pk_bf16_f32 v50, v116, v117
    v_lshlrev_b32 v116, 16, v51
    v_and_b32 v117, 0xffff0000, v51
    v_mul_f32 v116, v116, v243
    v_mul_f32 v117, v117, v243
    v_cvt_pk_bf16_f32 v51, v116, v117
    s_nop 1
    v_mfma_f32_16x16x32_bf16 v[140:143], v[16:19], v[48:51], v[140:143]
    v_mfma_f32_16x16x32_bf16 v[156:159], v[20:23], v[48:51], v[156:159]
    s_nop 7
    ds_read_b128 v[48:51], v26
    s_waitcnt lgkmcnt(0)
    v_lshlrev_b32 v116, 16, v48
    v_and_b32 v117, 0xffff0000, v48
    v_mul_f32 v116, v116, v240
    v_mul_f32 v117, v117, v240
    v_cvt_pk_bf16_f32 v48, v116, v117
    v_lshlrev_b32 v116, 16, v49
    v_and_b32 v117, 0xffff0000, v49
    v_mul_f32 v116, v116, v240
    v_mul_f32 v117, v117, v240
    v_cvt_pk_bf16_f32 v49, v116, v117
    v_lshlrev_b32 v116, 16, v50
    v_and_b32 v117, 0xffff0000, v50
    v_mul_f32 v116, v116, v240
    v_mul_f32 v117, v117, v240
    v_cvt_pk_bf16_f32 v50, v116, v117
    v_lshlrev_b32 v116, 16, v51
    v_and_b32 v117, 0xffff0000, v51
    v_mul_f32 v116, v116, v240
    v_mul_f32 v117, v117, v240
    v_cvt_pk_bf16_f32 v51, v116, v117
    s_nop 1
    v_mfma_f32_16x16x32_bf16 v[128:131], v[16:19], v[48:51], v[128:131]
    v_mfma_f32_16x16x32_bf16 v[144:147], v[20:23], v[48:51], v[144:147]
    s_nop 7
    ds_read_b128 v[48:51], v26 offset:1024
    s_waitcnt lgkmcnt(0)
    v_lshlrev_b32 v116, 16, v48
    v_and_b32 v117, 0xffff0000, v48
    v_mul_f32 v116, v116, v241
    v_mul_f32 v117, v117, v241
    v_cvt_pk_bf16_f32 v48, v116, v117
    v_lshlrev_b32 v116, 16, v49
    v_and_b32 v117, 0xffff0000, v49
    v_mul_f32 v116, v116, v241
    v_mul_f32 v117, v117, v241
    v_cvt_pk_bf16_f32 v49, v116, v117
    v_lshlrev_b32 v116, 16, v50
    v_and_b32 v117, 0xffff0000, v50
    v_mul_f32 v116, v116, v241
    v_mul_f32 v117, v117, v241
    v_cvt_pk_bf16_f32 v50, v116, v117
    v_lshlrev_b32 v116, 16, v51
    v_and_b32 v117, 0xffff0000, v51
    v_mul_f32 v116, v116, v241
    v_mul_f32 v117, v117, v241
    v_cvt_pk_bf16_f32 v51, v116, v117
    s_nop 1
    v_mfma_f32_16x16x32_bf16 v[132:135], v[16:19], v[48:51], v[132:135]
    v_mfma_f32_16x16x32_bf16 v[148:151], v[20:23], v[48:51], v[148:151]
    s_nop 7
    ds_read_b128 v[48:51], v27 offset:6144
    s_waitcnt lgkmcnt(0)
    v_lshlrev_b32 v116, 16, v48
    v_and_b32 v117, 0xffff0000, v48
    v_mul_f32 v116, v116, v242
    v_mul_f32 v117, v117, v242
    v_cvt_pk_bf16_f32 v48, v116, v117
    v_lshlrev_b32 v116, 16, v49
    v_and_b32 v117, 0xffff0000, v49
    v_mul_f32 v116, v116, v242
    v_mul_f32 v117, v117, v242
    v_cvt_pk_bf16_f32 v49, v116, v117
    v_lshlrev_b32 v116, 16, v50
    v_and_b32 v117, 0xffff0000, v50
    v_mul_f32 v116, v116, v242
    v_mul_f32 v117, v117, v242
    v_cvt_pk_bf16_f32 v50, v116, v117
    v_lshlrev_b32 v116, 16, v51
    v_and_b32 v117, 0xffff0000, v51
    v_mul_f32 v116, v116, v242
    v_mul_f32 v117, v117, v242
    v_cvt_pk_bf16_f32 v51, v116, v117
    s_nop 1
    v_mfma_f32_16x16x32_bf16 v[168:171], v[16:19], v[48:51], v[168:171]
    v_mfma_f32_16x16x32_bf16 v[184:187], v[20:23], v[48:51], v[184:187]
    s_nop 7
    ds_read_b128 v[48:51], v27 offset:7168
    s_waitcnt lgkmcnt(0)
    v_lshlrev_b32 v116, 16, v48
    v_and_b32 v117, 0xffff0000, v48
    v_mul_f32 v116, v116, v243
    v_mul_f32 v117, v117, v243
    v_cvt_pk_bf16_f32 v48, v116, v117
    v_lshlrev_b32 v116, 16, v49
    v_and_b32 v117, 0xffff0000, v49
    v_mul_f32 v116, v116, v243
    v_mul_f32 v117, v117, v243
    v_cvt_pk_bf16_f32 v49, v116, v117
    v_lshlrev_b32 v116, 16, v50
    v_and_b32 v117, 0xffff0000, v50
    v_mul_f32 v116, v116, v243
    v_mul_f32 v117, v117, v243
    v_cvt_pk_bf16_f32 v50, v116, v117
    v_lshlrev_b32 v116, 16, v51
    v_and_b32 v117, 0xffff0000, v51
    v_mul_f32 v116, v116, v243
    v_mul_f32 v117, v117, v243
    v_cvt_pk_bf16_f32 v51, v116, v117
    s_nop 1
    v_mfma_f32_16x16x32_bf16 v[172:175], v[16:19], v[48:51], v[172:175]
    v_mfma_f32_16x16x32_bf16 v[188:191], v[20:23], v[48:51], v[188:191]
    s_nop 7
    ds_read_b128 v[48:51], v26 offset:4096
    s_waitcnt lgkmcnt(0)
    v_lshlrev_b32 v116, 16, v48
    v_and_b32 v117, 0xffff0000, v48
    v_mul_f32 v116, v116, v240
    v_mul_f32 v117, v117, v240
    v_cvt_pk_bf16_f32 v48, v116, v117
    v_lshlrev_b32 v116, 16, v49
    v_and_b32 v117, 0xffff0000, v49
    v_mul_f32 v116, v116, v240
    v_mul_f32 v117, v117, v240
    v_cvt_pk_bf16_f32 v49, v116, v117
    v_lshlrev_b32 v116, 16, v50
    v_and_b32 v117, 0xffff0000, v50
    v_mul_f32 v116, v116, v240
    v_mul_f32 v117, v117, v240
    v_cvt_pk_bf16_f32 v50, v116, v117
    v_lshlrev_b32 v116, 16, v51
    v_and_b32 v117, 0xffff0000, v51
    v_mul_f32 v116, v116, v240
    v_mul_f32 v117, v117, v240
    v_cvt_pk_bf16_f32 v51, v116, v117
    s_nop 1
    v_mfma_f32_16x16x32_bf16 v[160:163], v[16:19], v[48:51], v[160:163]
    v_mfma_f32_16x16x32_bf16 v[176:179], v[20:23], v[48:51], v[176:179]
    s_nop 7
    ds_read_b128 v[48:51], v26 offset:5120
    s_waitcnt lgkmcnt(0)
    v_lshlrev_b32 v116, 16, v48
    v_and_b32 v117, 0xffff0000, v48
    v_mul_f32 v116, v116, v241
    v_mul_f32 v117, v117, v241
    v_cvt_pk_bf16_f32 v48, v116, v117
    v_lshlrev_b32 v116, 16, v49
    v_and_b32 v117, 0xffff0000, v49
    v_mul_f32 v116, v116, v241
    v_mul_f32 v117, v117, v241
    v_cvt_pk_bf16_f32 v49, v116, v117
    v_lshlrev_b32 v116, 16, v50
    v_and_b32 v117, 0xffff0000, v50
    v_mul_f32 v116, v116, v241
    v_mul_f32 v117, v117, v241
    v_cvt_pk_bf16_f32 v50, v116, v117
    v_lshlrev_b32 v116, 16, v51
    v_and_b32 v117, 0xffff0000, v51
    v_mul_f32 v116, v116, v241
    v_mul_f32 v117, v117, v241
    v_cvt_pk_bf16_f32 v51, v116, v117
    s_nop 1
    v_mfma_f32_16x16x32_bf16 v[164:167], v[16:19], v[48:51], v[164:167]
    v_mfma_f32_16x16x32_bf16 v[180:183], v[20:23], v[48:51], v[180:183]
    s_nop 7
    buffer_load_dwordx4 v[192:195], v10, s[8:11], s80 offen
    buffer_load_dwordx4 v[196:199], v10, s[8:11], s80 offen offset:1024
    buffer_load_dwordx4 v[200:203], v10, s[8:11], s80 offen offset:2048
    buffer_load_dwordx4 v[204:207], v10, s[8:11], s80 offen offset:3072
    s_add_u32 s80, s80, 4096
    buffer_load_dwordx4 v[208:211], v10, s[8:11], s80 offen
    buffer_load_dwordx4 a[40:43], v1, s[8:11], s79 offen offset:2048
    buffer_load_dwordx4 a[44:47], v1, s[8:11], s79 offen offset:3072
    s_add_u32 s79, s79, 4096
    buffer_load_dwordx4 a[48:51], v1, s[8:11], s79 offen
    buffer_load_dwordx4 a[52:55], v1, s[8:11], s79 offen offset:1024
    buffer_load_dwordx4 a[56:59], v1, s[8:11], s79 offen offset:2048
    buffer_load_dwordx4 a[60:63], v1, s[8:11], s79 offen offset:3072
    s_add_u32 s79, s79, 4096
    buffer_load_dwordx4 a[64:67], v1, s[8:11], s79 offen
    buffer_load_dwordx4 a[68:71], v1, s[8:11], s79 offen offset:1024
    buffer_load_dwordx4 a[72:75], v1, s[8:11], s79 offen offset:2048
    buffer_load_dwordx4 a[76:79], v1, s[8:11], s79 offen offset:3072
    s_add_u32 s79, s79, 4096
    buffer_load_dwordx4 a[80:83], v1, s[8:11], s79 offen
    s_nop 7
    s_branch K2_RJOIN
K2_FSTUB0:
    s_mov_b32 s15, 0
K2_FSPIN0:
    buffer_load_dword v15, v1, s[8:11], s21 offen sc0 sc1
    s_waitcnt vmcnt(0)
    v_cmp_eq_u32 vcc, 0, v15
    s_nop 1
    s_and_b32 s14, vcc_lo, 0xff
    s_cbranch_scc0 K2_FBACK0
    s_add_u32 s15, s15, 1
    s_cmp_gt_u32 s15, 0x40000
    s_cbranch_scc1 K2_FBACK0
    s_sleep 8
    s_branch K2_FSPIN0
K2_FSTUB1:
    s_mov_b32 s15, 0
K2_FSPIN1:
    buffer_load_dword v15, v1, s[8:11], s21 offen sc0 sc1
    s_waitcnt vmcnt(0)
    v_cmp_eq_u32 vcc, 0, v15
    s_nop 1
    s_and_b32 s14, vcc_lo, 0xff
    s_cbranch_scc0 K2_FBACK1
    s_add_u32 s15, s15, 1
    s_cmp_gt_u32 s15, 0x40000
    s_cbranch_scc1 K2_FBACK1
    s_sleep 8
    s_branch K2_FSPIN1
K2_STUB_L0:
    s_call_b64 s[40:41], K2_SLOW0
    s_branch K2_BACK_L0
K2_STUB_L1:
    s_call_b64 s[40:41], K2_SLOW1
    s_branch K2_BACK_L1
K2_STUB_T0:
    s_call_b64 s[40:41], K2_SLOW0
    s_branch K2_BACK_T0
K2_STUB_T1:
    s_call_b64 s[40:41], K2_SLOW1
    s_branch K2_BACK_T1
K2_SLOW0:
    s_waitcnt vmcnt(0) lgkmcnt(0)
    v_lshrrev_b32 v9, 4, v0
    v_and_b32 v10, 1, v9
    v_mul_u32_u24 v10, 12, v10
    v_and_b32 v11, 15, v0
    v_xor_b32 v10, v10, v11
    v_lshlrev_b32 v10, 4, v10
    v_lshl_add_u32 v14, v9, 9, v10
    s_add_u32 s31, s20, s26
    v_add_u32 v14, s31, v14
    s_add_u32 s32, s20, s22
    s_cmp_eq_u32 s32, s24
    s_cselect_b32 s32, s23, s22
    v_add_u32 v15, s32, v14
    s_nop 15
    ds_read_b128 v[48:51], v14
    ds_read_b128 v[52:55], v14 offset:256
    ds_read_b128 v[56:59], v14 offset:2048
    ds_read_b128 v[60:63], v14 offset:2304
    s_waitcnt lgkmcnt(3)
    v_mfma_f32_16x16x32_bf16 v[64:67], v[48:51], a[128:131], v[16:19]
    v_mfma_f32_16x16x32_bf16 v[68:71], v[48:51], a[132:135], v[20:23]
    v_mfma_f32_16x16x32_bf16 v[72:75], v[48:51], a[136:139], v[24:27]
    v_mfma_f32_16x16x32_bf16 v[76:79], v[48:51], a[140:143], v[28:31]
    ds_read_b128 v[48:51], v14 offset:4096
    s_waitcnt lgkmcnt(3)
    v_mfma_f32_16x16x32_bf16 v[80:83], v[52:55], a[128:131], v[16:19]
    v_mfma_f32_16x16x32_bf16 v[84:87], v[52:55], a[132:135], v[20:23]
    v_mfma_f32_16x16x32_bf16 v[88:91], v[52:55], a[136:139], v[24:27]
    v_mfma_f32_16x16x32_bf16 v[92:95], v[52:55], a[140:143], v[28:31]
    ds_read_b128 v[52:55], v14 offset:4352
    s_waitcnt lgkmcnt(3)
    v_mfma_f32_16x16x32_bf16 v[64:67], v[56:59], a[144:147], v[64:67]
    v_mfma_f32_16x16x32_bf16 v[68:71], v[56:59], a[148:151], v[68:71]
    v_mfma_f32_16x16x32_bf16 v[72:75], v[56:59], a[152:155], v[72:75]
    v_mfma_f32_16x16x32_bf16 v[76:79], v[56:59], a[156:159], v[76:79]
    ds_read_b128 v[56:59], v14 offset:6144
    s_waitcnt lgkmcnt(3)
    v_mfma_f32_16x16x32_bf16 v[80:83], v[60:63], a[144:147], v[80:83]
    v_mfma_f32_16x16x32_bf16 v[84:87], v[60:63], a[148:151], v[84:87]
    v_mfma_f32_16x16x32_bf16 v[88:91], v[60:63], a[152:155], v[88:91]
    v_mfma_f32_16x16x32_bf16 v[92:95], v[60:63], a[156:159], v[92:95]
    ds_read_b128 v[60:63], v14 offset:6400
    s_waitcnt lgkmcnt(3)
    v_mfma_f32_16x16x32_bf16 v[64:67], v[48:51], a[160:163], v[64:67]
    v_mfma_f32_16x16x32_bf16 v[68:71], v[48:51], a[164:167], v[68:71]
    v_mfma_f32_16x16x32_bf16 v[72:75], v[48:51], a[168:171], v[72:75]
    v_mfma_f32_16x16x32_bf16 v[76:79], v[48:51], a[172:175], v[76:79]
    ds_read_b128 v[48:51], v15
    s_waitcnt lgkmcnt(3)
    v_mfma_f32_16x16x32_bf16 v[80:83], v[52:55], a[160:163], v[80:83]
    v_mfma_f32_16x16x32_bf16 v[84:87], v[52:55], a[164:167], v[84:87]
    v_mfma_f32_16x16x32_bf16 v[88:91], v[52:55], a[168:171], v[88:91]
    v_mfma_f32_16x16x32_bf16 v[92:95], v[52:55], a[172:175], v[92:95]
    ds_read_b128 v[52:55], v15 offset:256
    s_waitcnt lgkmcnt(3)
    v_mfma_f32_16x16x32_bf16 v[64:67], v[56:59], a[176:179], v[64:67]
    v_mfma_f32_16x16x32_bf16 v[68:71], v[56:59], a[180:183], v[68:71]
    v_mfma_f32_16x16x32_bf16 v[72:75], v[56:59], a[184:187], v[72:75]
    v_mfma_f32_16x16x32_bf16 v[76:79], v[56:59], a[188:191], v[76:79]
    ds_read_b128 v[56:59], v15 offset:2048
    s_waitcnt lgkmcnt(3)
    v_mfma_f32_16x16x32_bf16 v[80:83], v[60:63], a[176:179], v[80:83]
    v_mfma_f32_16x16x32_bf16 v[84:87], v[60:63], a[180:183], v[84:87]
    v_mfma_f32_16x16x32_bf16 v[88:91], v[60:63], a[184:187], v[88:91]
    v_mfma_f32_16x16x32_bf16 v[92:95], v[60:63], a[188:191], v[92:95]
    ds_read_b128 v[60:63], v15 offset:2304
    s_waitcnt lgkmcnt(3)
    v_mfma_f32_16x16x32_bf16 v[64:67], v[48:51], a[192:195], v[64:67]
    v_mfma_f32_16x16x32_bf16 v[68:71], v[48:51], a[196:199], v[68:71]
    v_mfma_f32_16x16x32_bf16 v[72:75], v[48:51], a[200:203], v[72:75]
    v_mfma_f32_16x16x32_bf16 v[76:79], v[48:51], a[204:207], v[76:79]
    ds_read_b128 v[48:51], v15 offset:4096
    s_waitcnt lgkmcnt(3)
    v_mfma_f32_16x16x32_bf16 v[80:83], v[52:55], a[192:195], v[80:83]
    v_mfma_f32_16x16x32_bf16 v[84:87], v[52:55], a[196:199], v[84:87]
    v_mfma_f32_16x16x32_bf16 v[88:91], v[52:55], a[200:203], v[88:91]
    v_mfma_f32_16x16x32_bf16 v[92:95], v[52:55], a[204:207], v[92:95]
    ds_read_b128 v[52:55], v15 offset:4352
    s_waitcnt lgkmcnt(3)
    v_mfma_f32_16x16x32_bf16 v[64:67], v[56:59], a[208:211], v[64:67]
    v_mfma_f32_16x16x32_bf16 v[68:71], v[56:59], a[212:215], v[68:71]
    v_mfma_f32_16x16x32_bf16 v[72:75], v[56:59], a[216:219], v[72:75]
    v_mfma_f32_16x16x32_bf16 v[76:79], v[56:59], a[220:223], v[76:79]
    ds_read_b128 v[56:59], v15 offset:6144
    s_waitcnt lgkmcnt(3)
    v_mfma_f32_16x16x32_bf16 v[80:83], v[60:63], a[208:211], v[80:83]
    v_mfma_f32_16x16x32_bf16 v[84:87], v[60:63], a[212:215], v[84:87]
    v_mfma_f32_16x16x32_bf16 v[88:91], v[60:63], a[216:219], v[88:91]
    v_mfma_f32_16x16x32_bf16 v[92:95], v[60:63], a[220:223], v[92:95]
    ds_read_b128 v[60:63], v15 offset:6400
    s_waitcnt lgkmcnt(3)
    v_mfma_f32_16x16x32_bf16 v[64:67], v[48:51], a[224:227], v[64:67]
    v_mfma_f32_16x16x32_bf16 v[68:71], v[48:51], a[228:231], v[68:71]
    v_mfma_f32_16x16x32_bf16 v[72:75], v[48:51], a[232:235], v[72:75]
    v_mfma_f32_16x16x32_bf16 v[76:79], v[48:51], a[236:239], v[76:79]
    s_waitcnt lgkmcnt(2)
    v_mfma_f32_16x16x32_bf16 v[80:83], v[52:55], a[224:227], v[80:83]
    v_mfma_f32_16x16x32_bf16 v[84:87], v[52:55], a[228:231], v[84:87]
    v_mfma_f32_16x16x32_bf16 v[88:91], v[52:55], a[232:235], v[88:91]
    v_mfma_f32_16x16x32_bf16 v[92:95], v[52:55], a[236:239], v[92:95]
    s_waitcnt lgkmcnt(1)
    v_mfma_f32_16x16x32_bf16 v[64:67], v[56:59], a[240:243], v[64:67]
    v_mfma_f32_16x16x32_bf16 v[68:71], v[56:59], a[244:247], v[68:71]
    v_mfma_f32_16x16x32_bf16 v[72:75], v[56:59], a[248:251], v[72:75]
    v_mfma_f32_16x16x32_bf16 v[76:79], v[56:59], a[252:255], v[76:79]
    s_waitcnt lgkmcnt(0)
    v_mfma_f32_16x16x32_bf16 v[80:83], v[60:63], a[240:243], v[80:83]
    v_mfma_f32_16x16x32_bf16 v[84:87], v[60:63], a[244:247], v[84:87]
    v_mfma_f32_16x16x32_bf16 v[88:91], v[60:63], a[248:251], v[88:91]
    v_mfma_f32_16x16x32_bf16 v[92:95], v[60:63], a[252:255], v[92:95]
    s_nop 15
    v_max3_f32 v9, v64, v65, v66
    v_max3_f32 v9, v9, v67, v80
    v_max3_f32 v9, v9, v81, v82
    v_max_f32 v9, v9, v83
    v_max3_f32 v10, v68, v69, v70
    v_max3_f32 v10, v10, v71, v84
    v_max3_f32 v10, v10, v85, v86
    v_max_f32 v10, v10, v87
    v_max3_f32 v11, v72, v73, v74
    v_max3_f32 v11, v11, v75, v88
    v_max3_f32 v11, v11, v89, v90
    v_max_f32 v11, v11, v91
    v_max3_f32 v12, v76, v77, v78
    v_max3_f32 v12, v12, v79, v92
    v_max3_f32 v12, v12, v93, v94
    v_max_f32 v12, v12, v95
    v_mov_b32 v13, v9
    s_nop 1
    v_permlane16_swap_b32 v13, v9
    v_max_f32 v9, v9, v13
    v_mov_b32 v13, v9
    s_nop 1
    v_permlane32_swap_b32 v13, v9
    v_max_f32 v9, v9, v13
    v_mov_b32 v13, v10
    s_nop 1
    v_permlane16_swap_b32 v13, v10
    v_max_f32 v10, v10, v13
    v_mov_b32 v13, v10
    s_nop 1
    v_permlane32_swap_b32 v13, v10
    v_max_f32 v10, v10, v13
    v_mov_b32 v13, v11
    s_nop 1
    v_permlane16_swap_b32 v13, v11
    v_max_f32 v11, v11, v13
    v_mov_b32 v13, v11
    s_nop 1
    v_permlane32_swap_b32 v13, v11
    v_max_f32 v11, v11, v13
    v_mov_b32 v13, v12
    s_nop 1
    v_permlane16_swap_b32 v13, v12
    v_max_f32 v12, v12, v13
    v_mov_b32 v13, v12
    s_nop 1
    v_permlane32_swap_b32 v13, v12
    v_max_f32 v12, v12, v13
    v_add_f32 v9, 0x42200000, v9
    v_max_f32 v9, 0, v9
    v_add_f32 v10, 0x42200000, v10
    v_max_f32 v10, 0, v10
    v_add_f32 v11, 0x42200000, v11
    v_max_f32 v11, 0, v11
    v_add_f32 v12, 0x42200000, v12
    v_max_f32 v12, 0, v12
    v_sub_f32 v16, v16, v9
    v_sub_f32 v17, v17, v9
    v_sub_f32 v18, v18, v9
    v_sub_f32 v19, v19, v9
    v_sub_f32 v64, v64, v9
    v_sub_f32 v96, v96, v9
    v_sub_f32 v65, v65, v9
    v_sub_f32 v97, v97, v9
    v_sub_f32 v66, v66, v9
    v_sub_f32 v98, v98, v9
    v_sub_f32 v67, v67, v9
    v_sub_f32 v99, v99, v9
    v_sub_f32 v80, v80, v9
    v_sub_f32 v112, v112, v9
    v_sub_f32 v81, v81, v9
    v_sub_f32 v113, v113, v9
    v_sub_f32 v82, v82, v9
    v_sub_f32 v114, v114, v9
    v_sub_f32 v83, v83, v9
    v_sub_f32 v115, v115, v9
    v_sub_f32 v20, v20, v10
    v_sub_f32 v21, v21, v10
    v_sub_f32 v22, v22, v10
    v_sub_f32 v23, v23, v10
    v_sub_f32 v68, v68, v10
    v_sub_f32 v100, v100, v10
    v_sub_f32 v69, v69, v10
    v_sub_f32 v101, v101, v10
    v_sub_f32 v70, v70, v10
    v_sub_f32 v102, v102, v10
    v_sub_f32 v71, v71, v10
    v_sub_f32 v103, v103, v10
    v_sub_f32 v84, v84, v10
    v_sub_f32 v116, v116, v10
    v_sub_f32 v85, v85, v10
    v_sub_f32 v117, v117, v10
    v_sub_f32 v86, v86, v10
    v_sub_f32 v118, v118, v10
    v_sub_f32 v87, v87, v10
    v_sub_f32 v119, v119, v10
    v_sub_f32 v24, v24, v11
    v_sub_f32 v25, v25, v11
    v_sub_f32 v26, v26, v11
    v_sub_f32 v27, v27, v11
    v_sub_f32 v72, v72, v11
    v_sub_f32 v104, v104, v11
    v_sub_f32 v73, v73, v11
    v_sub_f32 v105, v105, v11
    v_sub_f32 v74, v74, v11
    v_sub_f32 v106, v106, v11
    v_sub_f32 v75, v75, v11
    v_sub_f32 v107, v107, v11
    v_sub_f32 v88, v88, v11
    v_sub_f32 v120, v120, v11
    v_sub_f32 v89, v89, v11
    v_sub_f32 v121, v121, v11
    v_sub_f32 v90, v90, v11
    v_sub_f32 v122, v122, v11
    v_sub_f32 v91, v91, v11
    v_sub_f32 v123, v123, v11
    v_sub_f32 v28, v28, v12
    v_sub_f32 v29, v29, v12
    v_sub_f32 v30, v30, v12
    v_sub_f32 v31, v31, v12
    v_sub_f32 v76, v76, v12
    v_sub_f32 v108, v108, v12
    v_sub_f32 v77, v77, v12
    v_sub_f32 v109, v109, v12
    v_sub_f32 v78, v78, v12
    v_sub_f32 v110, v110, v12
    v_sub_f32 v79, v79, v12
    v_sub_f32 v111, v111, v12
    v_sub_f32 v92, v92, v12
    v_sub_f32 v124, v124, v12
    v_sub_f32 v93, v93, v12
    v_sub_f32 v125, v125, v12
    v_sub_f32 v94, v94, v12
    v_sub_f32 v126, v126, v12
    v_sub_f32 v95, v95, v12
    v_sub_f32 v127, v127, v12
    v_sub_f32 v9, 0, v9
    v_exp_f32 v9, v9
    v_sub_f32 v10, 0, v10
    v_exp_f32 v10, v10
    v_sub_f32 v11, 0, v11
    v_exp_f32 v11, v11
    v_sub_f32 v12, 0, v12
    v_exp_f32 v12, v12
    v_mul_f32 v4, v4, v9
    v_mul_f32 v5, v5, v10
    v_mul_f32 v6, v6, v11
    v_mul_f32 v7, v7, v12
    s_call_b64 s[42:43], K2_SCALE_O
    v_exp_f32 v64, v64
    v_exp_f32 v65, v65
    v_exp_f32 v66, v66
    v_exp_f32 v67, v67
    v_exp_f32 v68, v68
    v_exp_f32 v69, v69
    v_exp_f32 v70, v70
    v_exp_f32 v71, v71
    v_exp_f32 v72, v72
    v_exp_f32 v73, v73
    v_exp_f32 v74, v74
    v_exp_f32 v75, v75
    v_exp_f32 v76, v76
    v_exp_f32 v77, v77
    v_exp_f32 v78, v78
    v_exp_f32 v79, v79
    v_exp_f32 v80, v80
    v_exp_f32 v81, v81
    v_exp_f32 v82, v82
    v_exp_f32 v83, v83
    v_exp_f32 v84, v84
    v_exp_f32 v85, v85
    v_exp_f32 v86, v86
    v_exp_f32 v87, v87
    v_exp_f32 v88, v88
    v_exp_f32 v89, v89
    v_exp_f32 v90, v90
    v_exp_f32 v91, v91
    v_exp_f32 v92, v92
    v_exp_f32 v93, v93
    v_exp_f32 v94, v94
    v_exp_f32 v95, v95
    v_cvt_pk_bf16_f32 v48, v64, v65
    v_cvt_pk_bf16_f32 v49, v66, v67
    v_cvt_pk_bf16_f32 v52, v68, v69
    v_cvt_pk_bf16_f32 v53, v70, v71
    v_cvt_pk_bf16_f32 v56, v72, v73
    v_cvt_pk_bf16_f32 v57, v74, v75
    v_cvt_pk_bf16_f32 v60, v76, v77
    v_cvt_pk_bf16_f32 v61, v78, v79
    v_cvt_pk_bf16_f32 v50, v80, v81
    v_cvt_pk_bf16_f32 v51, v82, v83
    v_cvt_pk_bf16_f32 v54, v84, v85
    v_cvt_pk_bf16_f32 v55, v86, v87
    v_cvt_pk_bf16_f32 v58, v88, v89
    v_cvt_pk_bf16_f32 v59, v90, v91
    v_cvt_pk_bf16_f32 v62, v92, v93
    v_cvt_pk_bf16_f32 v63, v94, v95
    v_mov_b32 v15, 0
    s_nop 3
    s_setpc_b64 s[40:41]
K2_SLOW1:
    s_waitcnt vmcnt(0) lgkmcnt(0)
    v_lshrrev_b32 v9, 4, v0
    v_and_b32 v10, 1, v9
    v_mul_u32_u24 v10, 12, v10
    v_and_b32 v11, 15, v0
    v_xor_b32 v10, v10, v11
    v_lshlrev_b32 v10, 4, v10
    v_lshl_add_u32 v14, v9, 9, v10
    s_add_u32 s31, s20, s26
    v_add_u32 v14, s31, v14
    s_add_u32 s32, s20, s22
    s_cmp_eq_u32 s32, s24
    s_cselect_b32 s32, s23, s22
    v_add_u32 v15, s32, v14
    s_nop 15
    ds_read_b128 v[48:51], v14
    ds_read_b128 v[52:55], v14 offset:256
    ds_read_b128 v[56:59], v14 offset:2048
    ds_read_b128 v[60:63], v14 offset:2304
    s_waitcnt lgkmcnt(3)
    v_mfma_f32_16x16x32_bf16 v[96:99], v[48:51], a[128:131], v[16:19]
    v_mfma_f32_16x16x32_bf16 v[100:103], v[48:51], a[132:135], v[20:23]
    v_mfma_f32_16x16x32_bf16 v[104:107], v[48:51], a[136:139], v[24:27]
    v_mfma_f32_16x16x32_bf16 v[108:111], v[48:51], a[140:143], v[28:31]
    ds_read_b128 v[48:51], v14 offset:4096
    s_waitcnt lgkmcnt(3)
    v_mfma_f32_16x16x32_bf16 v[112:115], v[52:55], a[128:131], v[16:19]
    v_mfma_f32_16x16x32_bf16 v[116:119], v[52:55], a[132:135], v[20:23]
    v_mfma_f32_16x16x32_bf16 v[120:123], v[52:55], a[136:139], v[24:27]
    v_mfma_f32_16x16x32_bf16 v[124:127], v[52:55], a[140:143], v[28:31]
    ds_read_b128 v[52:55], v14 offset:4352
    s_waitcnt lgkmcnt(3)
    v_mfma_f32_16x16x32_bf16 v[96:99], v[56:59], a[144:147], v[96:99]
    v_mfma_f32_16x16x32_bf16 v[100:103], v[56:59], a[148:151], v[100:103]
    v_mfma_f32_16x16x32_bf16 v[104:107], v[56:59], a[152:155], v[104:107]
    v_mfma_f32_16x16x32_bf16 v[108:111], v[56:59], a[156:159], v[108:111]
    ds_read_b128 v[56:59], v14 offset:6144
    s_waitcnt lgkmcnt(3)
    v_mfma_f32_16x16x32_bf16 v[112:115], v[60:63], a[144:147], v[112:115]
    v_mfma_f32_16x16x32_bf16 v[116:119], v[60:63], a[148:151], v[116:119]
    v_mfma_f32_16x16x32_bf16 v[120:123], v[60:63], a[152:155], v[120:123]
    v_mfma_f32_16x16x32_bf16 v[124:127], v[60:63], a[156:159], v[124:127]
    ds_read_b128 v[60:63], v14 offset:6400
    s_waitcnt lgkmcnt(3)
    v_mfma_f32_16x16x32_bf16 v[96:99], v[48:51], a[160:163], v[96:99]
    v_mfma_f32_16x16x32_bf16 v[100:103], v[48:51], a[164:167], v[100:103]
    v_mfma_f32_16x16x32_bf16 v[104:107], v[48:51], a[168:171], v[104:107]
    v_mfma_f32_16x16x32_bf16 v[108:111], v[48:51], a[172:175], v[108:111]
    ds_read_b128 v[48:51], v15
    s_waitcnt lgkmcnt(3)
    v_mfma_f32_16x16x32_bf16 v[112:115], v[52:55], a[160:163], v[112:115]
    v_mfma_f32_16x16x32_bf16 v[116:119], v[52:55], a[164:167], v[116:119]
    v_mfma_f32_16x16x32_bf16 v[120:123], v[52:55], a[168:171], v[120:123]
    v_mfma_f32_16x16x32_bf16 v[124:127], v[52:55], a[172:175], v[124:127]
    ds_read_b128 v[52:55], v15 offset:256
    s_waitcnt lgkmcnt(3)
    v_mfma_f32_16x16x32_bf16 v[96:99], v[56:59], a[176:179], v[96:99]
    v_mfma_f32_16x16x32_bf16 v[100:103], v[56:59], a[180:183], v[100:103]
    v_mfma_f32_16x16x32_bf16 v[104:107], v[56:59], a[184:187], v[104:107]
    v_mfma_f32_16x16x32_bf16 v[108:111], v[56:59], a[188:191], v[108:111]
    ds_read_b128 v[56:59], v15 offset:2048
    s_waitcnt lgkmcnt(3)
    v_mfma_f32_16x16x32_bf16 v[112:115], v[60:63], a[176:179], v[112:115]
    v_mfma_f32_16x16x32_bf16 v[116:119], v[60:63], a[180:183], v[116:119]
    v_mfma_f32_16x16x32_bf16 v[120:123], v[60:63], a[184:187], v[120:123]
    v_mfma_f32_16x16x32_bf16 v[124:127], v[60:63], a[188:191], v[124:127]
    ds_read_b128 v[60:63], v15 offset:2304
    s_waitcnt lgkmcnt(3)
    v_mfma_f32_16x16x32_bf16 v[96:99], v[48:51], a[192:195], v[96:99]
    v_mfma_f32_16x16x32_bf16 v[100:103], v[48:51], a[196:199], v[100:103]
    v_mfma_f32_16x16x32_bf16 v[104:107], v[48:51], a[200:203], v[104:107]
    v_mfma_f32_16x16x32_bf16 v[108:111], v[48:51], a[204:207], v[108:111]
    ds_read_b128 v[48:51], v15 offset:4096
    s_waitcnt lgkmcnt(3)
    v_mfma_f32_16x16x32_bf16 v[112:115], v[52:55], a[192:195], v[112:115]
    v_mfma_f32_16x16x32_bf16 v[116:119], v[52:55], a[196:199], v[116:119]
    v_mfma_f32_16x16x32_bf16 v[120:123], v[52:55], a[200:203], v[120:123]
    v_mfma_f32_16x16x32_bf16 v[124:127], v[52:55], a[204:207], v[124:127]
    ds_read_b128 v[52:55], v15 offset:4352
    s_waitcnt lgkmcnt(3)
    v_mfma_f32_16x16x32_bf16 v[96:99], v[56:59], a[208:211], v[96:99]
    v_mfma_f32_16x16x32_bf16 v[100:103], v[56:59], a[212:215], v[100:103]
    v_mfma_f32_16x16x32_bf16 v[104:107], v[56:59], a[216:219], v[104:107]
    v_mfma_f32_16x16x32_bf16 v[108:111], v[56:59], a[220:223], v[108:111]
    ds_read_b128 v[56:59], v15 offset:6144
    s_waitcnt lgkmcnt(3)
    v_mfma_f32_16x16x32_bf16 v[112:115], v[60:63], a[208:211], v[112:115]
    v_mfma_f32_16x16x32_bf16 v[116:119], v[60:63], a[212:215], v[116:119]
    v_mfma_f32_16x16x32_bf16 v[120:123], v[60:63], a[216:219], v[120:123]
    v_mfma_f32_16x16x32_bf16 v[124:127], v[60:63], a[220:223], v[124:127]
    ds_read_b128 v[60:63], v15 offset:6400
    s_waitcnt lgkmcnt(3)
    v_mfma_f32_16x16x32_bf16 v[96:99], v[48:51], a[224:227], v[96:99]
    v_mfma_f32_16x16x32_bf16 v[100:103], v[48:51], a[228:231], v[100:103]
    v_mfma_f32_16x16x32_bf16 v[104:107], v[48:51], a[232:235], v[104:107]
    v_mfma_f32_16x16x32_bf16 v[108:111], v[48:51], a[236:239], v[108:111]
    s_waitcnt lgkmcnt(2)
    v_mfma_f32_16x16x32_bf16 v[112:115], v[52:55], a[224:227], v[112:115]
    v_mfma_f32_16x16x32_bf16 v[116:119], v[52:55], a[228:231], v[116:119]
    v_mfma_f32_16x16x32_bf16 v[120:123], v[52:55], a[232:235], v[120:123]
    v_mfma_f32_16x16x32_bf16 v[124:127], v[52:55], a[236:239], v[124:127]
    s_waitcnt lgkmcnt(1)
    v_mfma_f32_16x16x32_bf16 v[96:99], v[56:59], a[240:243], v[96:99]
    v_mfma_f32_16x16x32_bf16 v[100:103], v[56:59], a[244:247], v[100:103]
    v_mfma_f32_16x16x32_bf16 v[104:107], v[56:59], a[248:251], v[104:107]
    v_mfma_f32_16x16x32_bf16 v[108:111], v[56:59], a[252:255], v[108:111]
    s_waitcnt lgkmcnt(0)
    v_mfma_f32_16x16x32_bf16 v[112:115], v[60:63], a[240:243], v[112:115]
    v_mfma_f32_16x16x32_bf16 v[116:119], v[60:63], a[244:247], v[116:119]
    v_mfma_f32_16x16x32_bf16 v[120:123], v[60:63], a[248:251], v[120:123]
    v_mfma_f32_16x16x32_bf16 v[124:127], v[60:63], a[252:255], v[124:127]
    s_nop 15
    v_max3_f32 v9, v96, v97, v98
    v_max3_f32 v9, v9, v99, v112
    v_max3_f32 v9, v9, v113, v114
    v_max_f32 v9, v9, v115
    v_max3_f32 v10, v100, v101, v102
    v_max3_f32 v10, v10, v103, v116
    v_max3_f32 v10, v10, v117, v118
    v_max_f32 v10, v10, v119
    v_max3_f32 v11, v104, v105, v106
    v_max3_f32 v11, v11, v107, v120
    v_max3_f32 v11, v11, v121, v122
    v_max_f32 v11, v11, v123
    v_max3_f32 v12, v108, v109, v110
    v_max3_f32 v12, v12, v111, v124
    v_max3_f32 v12, v12, v125, v126
    v_max_f32 v12, v12, v127
    v_mov_b32 v13, v9
    s_nop 1
    v_permlane16_swap_b32 v13, v9
    v_max_f32 v9, v9, v13
    v_mov_b32 v13, v9
    s_nop 1
    v_permlane32_swap_b32 v13, v9
    v_max_f32 v9, v9, v13
    v_mov_b32 v13, v10
    s_nop 1
    v_permlane16_swap_b32 v13, v10
    v_max_f32 v10, v10, v13
    v_mov_b32 v13, v10
    s_nop 1
    v_permlane32_swap_b32 v13, v10
    v_max_f32 v10, v10, v13
    v_mov_b32 v13, v11
    s_nop 1
    v_permlane16_swap_b32 v13, v11
    v_max_f32 v11, v11, v13
    v_mov_b32 v13, v11
    s_nop 1
    v_permlane32_swap_b32 v13, v11
    v_max_f32 v11, v11, v13
    v_mov_b32 v13, v12
    s_nop 1
    v_permlane16_swap_b32 v13, v12
    v_max_f32 v12, v12, v13
    v_mov_b32 v13, v12
    s_nop 1
    v_permlane32_swap_b32 v13, v12
    v_max_f32 v12, v12, v13
    v_add_f32 v9, 0x42200000, v9
    v_max_f32 v9, 0, v9
    v_add_f32 v10, 0x42200000, v10
    v_max_f32 v10, 0, v10
    v_add_f32 v11, 0x42200000, v11
    v_max_f32 v11, 0, v11
    v_add_f32 v12, 0x42200000, v12
    v_max_f32 v12, 0, v12
    v_sub_f32 v16, v16, v9
    v_sub_f32 v17, v17, v9
    v_sub_f32 v18, v18, v9
    v_sub_f32 v19, v19, v9
    v_sub_f32 v96, v96, v9
    v_sub_f32 v64, v64, v9
    v_sub_f32 v97, v97, v9
    v_sub_f32 v65, v65, v9
    v_sub_f32 v98, v98, v9
    v_sub_f32 v66, v66, v9
    v_sub_f32 v99, v99, v9
    v_sub_f32 v67, v67, v9
    v_sub_f32 v112, v112, v9
    v_sub_f32 v80, v80, v9
    v_sub_f32 v113, v113, v9
    v_sub_f32 v81, v81, v9
    v_sub_f32 v114, v114, v9
    v_sub_f32 v82, v82, v9
    v_sub_f32 v115, v115, v9
    v_sub_f32 v83, v83, v9
    v_sub_f32 v20, v20, v10
    v_sub_f32 v21, v21, v10
    v_sub_f32 v22, v22, v10
    v_sub_f32 v23, v23, v10
    v_sub_f32 v100, v100, v10
    v_sub_f32 v68, v68, v10
    v_sub_f32 v101, v101, v10
    v_sub_f32 v69, v69, v10
    v_sub_f32 v102, v102, v10
    v_sub_f32 v70, v70, v10
    v_sub_f32 v103, v103, v10
    v_sub_f32 v71, v71, v10
    v_sub_f32 v116, v116, v10
    v_sub_f32 v84, v84, v10
    v_sub_f32 v117, v117, v10
    v_sub_f32 v85, v85, v10
    v_sub_f32 v118, v118, v10
    v_sub_f32 v86, v86, v10
    v_sub_f32 v119, v119, v10
    v_sub_f32 v87, v87, v10
    v_sub_f32 v24, v24, v11
    v_sub_f32 v25, v25, v11
    v_sub_f32 v26, v26, v11
    v_sub_f32 v27, v27, v11
    v_sub_f32 v104, v104, v11
    v_sub_f32 v72, v72, v11
    v_sub_f32 v105, v105, v11
    v_sub_f32 v73, v73, v11
    v_sub_f32 v106, v106, v11
    v_sub_f32 v74, v74, v11
    v_sub_f32 v107, v107, v11
    v_sub_f32 v75, v75, v11
    v_sub_f32 v120, v120, v11
    v_sub_f32 v88, v88, v11
    v_sub_f32 v121, v121, v11
    v_sub_f32 v89, v89, v11
    v_sub_f32 v122, v122, v11
    v_sub_f32 v90, v90, v11
    v_sub_f32 v123, v123, v11
    v_sub_f32 v91, v91, v11
    v_sub_f32 v28, v28, v12
    v_sub_f32 v29, v29, v12
    v_sub_f32 v30, v30, v12
    v_sub_f32 v31, v31, v12
    v_sub_f32 v108, v108, v12
    v_sub_f32 v76, v76, v12
    v_sub_f32 v109, v109, v12
    v_sub_f32 v77, v77, v12
    v_sub_f32 v110, v110, v12
    v_sub_f32 v78, v78, v12
    v_sub_f32 v111, v111, v12
    v_sub_f32 v79, v79, v12
    v_sub_f32 v124, v124, v12
    v_sub_f32 v92, v92, v12
    v_sub_f32 v125, v125, v12
    v_sub_f32 v93, v93, v12
    v_sub_f32 v126, v126, v12
    v_sub_f32 v94, v94, v12
    v_sub_f32 v127, v127, v12
    v_sub_f32 v95, v95, v12
    v_sub_f32 v9, 0, v9
    v_exp_f32 v9, v9
    v_sub_f32 v10, 0, v10
    v_exp_f32 v10, v10
    v_sub_f32 v11, 0, v11
    v_exp_f32 v11, v11
    v_sub_f32 v12, 0, v12
    v_exp_f32 v12, v12
    v_mul_f32 v4, v4, v9
    v_mul_f32 v5, v5, v10
    v_mul_f32 v6, v6, v11
    v_mul_f32 v7, v7, v12
    s_call_b64 s[42:43], K2_SCALE_O
    v_exp_f32 v96, v96
    v_exp_f32 v97, v97
    v_exp_f32 v98, v98
    v_exp_f32 v99, v99
    v_exp_f32 v100, v100
    v_exp_f32 v101, v101
    v_exp_f32 v102, v102
    v_exp_f32 v103, v103
    v_exp_f32 v104, v104
    v_exp_f32 v105, v105
    v_exp_f32 v106, v106
    v_exp_f32 v107, v107
    v_exp_f32 v108, v108
    v_exp_f32 v109, v109
    v_exp_f32 v110, v110
    v_exp_f32 v111, v111
    v_exp_f32 v112, v112
    v_exp_f32 v113, v113
    v_exp_f32 v114, v114
    v_exp_f32 v115, v115
    v_exp_f32 v116, v116
    v_exp_f32 v117, v117
    v_exp_f32 v118, v118
    v_exp_f32 v119, v119
    v_exp_f32 v120, v120
    v_exp_f32 v121, v121
    v_exp_f32 v122, v122
    v_exp_f32 v123, v123
    v_exp_f32 v124, v124
    v_exp_f32 v125, v125
    v_exp_f32 v126, v126
    v_exp_f32 v127, v127
    v_cvt_pk_bf16_f32 v48, v96, v97
    v_cvt_pk_bf16_f32 v49, v98, v99
    v_cvt_pk_bf16_f32 v52, v100, v101
    v_cvt_pk_bf16_f32 v53, v102, v103
    v_cvt_pk_bf16_f32 v56, v104, v105
    v_cvt_pk_bf16_f32 v57, v106, v107
    v_cvt_pk_bf16_f32 v60, v108, v109
    v_cvt_pk_bf16_f32 v61, v110, v111
    v_cvt_pk_bf16_f32 v50, v112, v113
    v_cvt_pk_bf16_f32 v51, v114, v115
    v_cvt_pk_bf16_f32 v54, v116, v117
    v_cvt_pk_bf16_f32 v55, v118, v119
    v_cvt_pk_bf16_f32 v58, v120, v121
    v_cvt_pk_bf16_f32 v59, v122, v123
    v_cvt_pk_bf16_f32 v62, v124, v125
    v_cvt_pk_bf16_f32 v63, v126, v127
    v_mov_b32 v15, 0
    s_nop 3
    s_setpc_b64 s[40:41]
K2_SCALE_O:
    s_nop 15
    v_accvgpr_read_b32 v48, a0
    v_accvgpr_read_b32 v49, a1
    v_accvgpr_read_b32 v50, a2
    v_accvgpr_read_b32 v51, a3
    v_mul_f32 v48, v48, v9
    v_mul_f32 v49, v49, v9
    v_mul_f32 v50, v50, v9
    v_mul_f32 v51, v51, v9
    v_accvgpr_write_b32 a0, v48
    v_accvgpr_write_b32 a1, v49
    v_accvgpr_write_b32 a2, v50
    v_accvgpr_write_b32 a3, v51
    v_accvgpr_read_b32 v48, a4
    v_accvgpr_read_b32 v49, a5
    v_accvgpr_read_b32 v50, a6
    v_accvgpr_read_b32 v51, a7
    v_mul_f32 v48, v48, v10
    v_mul_f32 v49, v49, v10
    v_mul_f32 v50, v50, v10
    v_mul_f32 v51, v51, v10
    v_accvgpr_write_b32 a4, v48
    v_accvgpr_write_b32 a5, v49
    v_accvgpr_write_b32 a6, v50
    v_accvgpr_write_b32 a7, v51
    v_accvgpr_read_b32 v48, a8
    v_accvgpr_read_b32 v49, a9
    v_accvgpr_read_b32 v50, a10
    v_accvgpr_read_b32 v51, a11
    v_mul_f32 v48, v48, v11
    v_mul_f32 v49, v49, v11
    v_mul_f32 v50, v50, v11
    v_mul_f32 v51, v51, v11
    v_accvgpr_write_b32 a8, v48
    v_accvgpr_write_b32 a9, v49
    v_accvgpr_write_b32 a10, v50
    v_accvgpr_write_b32 a11, v51
    v_accvgpr_read_b32 v48, a12
    v_accvgpr_read_b32 v49, a13
    v_accvgpr_read_b32 v50, a14
    v_accvgpr_read_b32 v51, a15
    v_mul_f32 v48, v48, v12
    v_mul_f32 v49, v49, v12
    v_mul_f32 v50, v50, v12
    v_mul_f32 v51, v51, v12
    v_accvgpr_write_b32 a12, v48
    v_accvgpr_write_b32 a13, v49
    v_accvgpr_write_b32 a14, v50
    v_accvgpr_write_b32 a15, v51
    v_accvgpr_read_b32 v48, a16
    v_accvgpr_read_b32 v49, a17
    v_accvgpr_read_b32 v50, a18
    v_accvgpr_read_b32 v51, a19
    v_mul_f32 v48, v48, v9
    v_mul_f32 v49, v49, v9
    v_mul_f32 v50, v50, v9
    v_mul_f32 v51, v51, v9
    v_accvgpr_write_b32 a16, v48
    v_accvgpr_write_b32 a17, v49
    v_accvgpr_write_b32 a18, v50
    v_accvgpr_write_b32 a19, v51
    v_accvgpr_read_b32 v48, a20
    v_accvgpr_read_b32 v49, a21
    v_accvgpr_read_b32 v50, a22
    v_accvgpr_read_b32 v51, a23
    v_mul_f32 v48, v48, v10
    v_mul_f32 v49, v49, v10
    v_mul_f32 v50, v50, v10
    v_mul_f32 v51, v51, v10
    v_accvgpr_write_b32 a20, v48
    v_accvgpr_write_b32 a21, v49
    v_accvgpr_write_b32 a22, v50
    v_accvgpr_write_b32 a23, v51
    v_accvgpr_read_b32 v48, a24
    v_accvgpr_read_b32 v49, a25
    v_accvgpr_read_b32 v50, a26
    v_accvgpr_read_b32 v51, a27
    v_mul_f32 v48, v48, v11
    v_mul_f32 v49, v49, v11
    v_mul_f32 v50, v50, v11
    v_mul_f32 v51, v51, v11
    v_accvgpr_write_b32 a24, v48
    v_accvgpr_write_b32 a25, v49
    v_accvgpr_write_b32 a26, v50
    v_accvgpr_write_b32 a27, v51
    v_accvgpr_read_b32 v48, a28
    v_accvgpr_read_b32 v49, a29
    v_accvgpr_read_b32 v50, a30
    v_accvgpr_read_b32 v51, a31
    v_mul_f32 v48, v48, v12
    v_mul_f32 v49, v49, v12
    v_mul_f32 v50, v50, v12
    v_mul_f32 v51, v51, v12
    v_accvgpr_write_b32 a28, v48
    v_accvgpr_write_b32 a29, v49
    v_accvgpr_write_b32 a30, v50
    v_accvgpr_write_b32 a31, v51
    v_accvgpr_read_b32 v48, a32
    v_accvgpr_read_b32 v49, a33
    v_accvgpr_read_b32 v50, a34
    v_accvgpr_read_b32 v51, a35
    v_mul_f32 v48, v48, v9
    v_mul_f32 v49, v49, v9
    v_mul_f32 v50, v50, v9
    v_mul_f32 v51, v51, v9
    v_accvgpr_write_b32 a32, v48
    v_accvgpr_write_b32 a33, v49
    v_accvgpr_write_b32 a34, v50
    v_accvgpr_write_b32 a35, v51
    v_accvgpr_read_b32 v48, a36
    v_accvgpr_read_b32 v49, a37
    v_accvgpr_read_b32 v50, a38
    v_accvgpr_read_b32 v51, a39
    v_mul_f32 v48, v48, v10
    v_mul_f32 v49, v49, v10
    v_mul_f32 v50, v50, v10
    v_mul_f32 v51, v51, v10
    v_accvgpr_write_b32 a36, v48
    v_accvgpr_write_b32 a37, v49
    v_accvgpr_write_b32 a38, v50
    v_accvgpr_write_b32 a39, v51
    v_accvgpr_read_b32 v48, a40
    v_accvgpr_read_b32 v49, a41
    v_accvgpr_read_b32 v50, a42
    v_accvgpr_read_b32 v51, a43
    v_mul_f32 v48, v48, v11
    v_mul_f32 v49, v49, v11
    v_mul_f32 v50, v50, v11
    v_mul_f32 v51, v51, v11
    v_accvgpr_write_b32 a40, v48
    v_accvgpr_write_b32 a41, v49
    v_accvgpr_write_b32 a42, v50
    v_accvgpr_write_b32 a43, v51
    v_accvgpr_read_b32 v48, a44
    v_accvgpr_read_b32 v49, a45
    v_accvgpr_read_b32 v50, a46
    v_accvgpr_read_b32 v51, a47
    v_mul_f32 v48, v48, v12
    v_mul_f32 v49, v49, v12
    v_mul_f32 v50, v50, v12
    v_mul_f32 v51, v51, v12
    v_accvgpr_write_b32 a44, v48
    v_accvgpr_write_b32 a45, v49
    v_accvgpr_write_b32 a46, v50
    v_accvgpr_write_b32 a47, v51
    v_accvgpr_read_b32 v48, a48
    v_accvgpr_read_b32 v49, a49
    v_accvgpr_read_b32 v50, a50
    v_accvgpr_read_b32 v51, a51
    v_mul_f32 v48, v48, v9
    v_mul_f32 v49, v49, v9
    v_mul_f32 v50, v50, v9
    v_mul_f32 v51, v51, v9
    v_accvgpr_write_b32 a48, v48
    v_accvgpr_write_b32 a49, v49
    v_accvgpr_write_b32 a50, v50
    v_accvgpr_write_b32 a51, v51
    v_accvgpr_read_b32 v48, a52
    v_accvgpr_read_b32 v49, a53
    v_accvgpr_read_b32 v50, a54
    v_accvgpr_read_b32 v51, a55
    v_mul_f32 v48, v48, v10
    v_mul_f32 v49, v49, v10
    v_mul_f32 v50, v50, v10
    v_mul_f32 v51, v51, v10
    v_accvgpr_write_b32 a52, v48
    v_accvgpr_write_b32 a53, v49
    v_accvgpr_write_b32 a54, v50
    v_accvgpr_write_b32 a55, v51
    v_accvgpr_read_b32 v48, a56
    v_accvgpr_read_b32 v49, a57
    v_accvgpr_read_b32 v50, a58
    v_accvgpr_read_b32 v51, a59
    v_mul_f32 v48, v48, v11
    v_mul_f32 v49, v49, v11
    v_mul_f32 v50, v50, v11
    v_mul_f32 v51, v51, v11
    v_accvgpr_write_b32 a56, v48
    v_accvgpr_write_b32 a57, v49
    v_accvgpr_write_b32 a58, v50
    v_accvgpr_write_b32 a59, v51
    v_accvgpr_read_b32 v48, a60
    v_accvgpr_read_b32 v49, a61
    v_accvgpr_read_b32 v50, a62
    v_accvgpr_read_b32 v51, a63
    v_mul_f32 v48, v48, v12
    v_mul_f32 v49, v49, v12
    v_mul_f32 v50, v50, v12
    v_mul_f32 v51, v51, v12
    v_accvgpr_write_b32 a60, v48
    v_accvgpr_write_b32 a61, v49
    v_accvgpr_write_b32 a62, v50
    v_accvgpr_write_b32 a63, v51
    v_accvgpr_read_b32 v48, a64
    v_accvgpr_read_b32 v49, a65
    v_accvgpr_read_b32 v50, a66
    v_accvgpr_read_b32 v51, a67
    v_mul_f32 v48, v48, v9
    v_mul_f32 v49, v49, v9
    v_mul_f32 v50, v50, v9
    v_mul_f32 v51, v51, v9
    v_accvgpr_write_b32 a64, v48
    v_accvgpr_write_b32 a65, v49
    v_accvgpr_write_b32 a66, v50
    v_accvgpr_write_b32 a67, v51
    v_accvgpr_read_b32 v48, a68
    v_accvgpr_read_b32 v49, a69
    v_accvgpr_read_b32 v50, a70
    v_accvgpr_read_b32 v51, a71
    v_mul_f32 v48, v48, v10
    v_mul_f32 v49, v49, v10
    v_mul_f32 v50, v50, v10
    v_mul_f32 v51, v51, v10
    v_accvgpr_write_b32 a68, v48
    v_accvgpr_write_b32 a69, v49
    v_accvgpr_write_b32 a70, v50
    v_accvgpr_write_b32 a71, v51
    v_accvgpr_read_b32 v48, a72
    v_accvgpr_read_b32 v49, a73
    v_accvgpr_read_b32 v50, a74
    v_accvgpr_read_b32 v51, a75
    v_mul_f32 v48, v48, v11
    v_mul_f32 v49, v49, v11
    v_mul_f32 v50, v50, v11
    v_mul_f32 v51, v51, v11
    v_accvgpr_write_b32 a72, v48
    v_accvgpr_write_b32 a73, v49
    v_accvgpr_write_b32 a74, v50
    v_accvgpr_write_b32 a75, v51
    v_accvgpr_read_b32 v48, a76
    v_accvgpr_read_b32 v49, a77
    v_accvgpr_read_b32 v50, a78
    v_accvgpr_read_b32 v51, a79
    v_mul_f32 v48, v48, v12
    v_mul_f32 v49, v49, v12
    v_mul_f32 v50, v50, v12
    v_mul_f32 v51, v51, v12
    v_accvgpr_write_b32 a76, v48
    v_accvgpr_write_b32 a77, v49
    v_accvgpr_write_b32 a78, v50
    v_accvgpr_write_b32 a79, v51
    v_accvgpr_read_b32 v48, a80
    v_accvgpr_read_b32 v49, a81
    v_accvgpr_read_b32 v50, a82
    v_accvgpr_read_b32 v51, a83
    v_mul_f32 v48, v48, v9
    v_mul_f32 v49, v49, v9
    v_mul_f32 v50, v50, v9
    v_mul_f32 v51, v51, v9
    v_accvgpr_write_b32 a80, v48
    v_accvgpr_write_b32 a81, v49
    v_accvgpr_write_b32 a82, v50
    v_accvgpr_write_b32 a83, v51
    v_accvgpr_read_b32 v48, a84
    v_accvgpr_read_b32 v49, a85
    v_accvgpr_read_b32 v50, a86
    v_accvgpr_read_b32 v51, a87
    v_mul_f32 v48, v48, v10
    v_mul_f32 v49, v49, v10
    v_mul_f32 v50, v50, v10
    v_mul_f32 v51, v51, v10
    v_accvgpr_write_b32 a84, v48
    v_accvgpr_write_b32 a85, v49
    v_accvgpr_write_b32 a86, v50
    v_accvgpr_write_b32 a87, v51
    v_accvgpr_read_b32 v48, a88
    v_accvgpr_read_b32 v49, a89
    v_accvgpr_read_b32 v50, a90
    v_accvgpr_read_b32 v51, a91
    v_mul_f32 v48, v48, v11
    v_mul_f32 v49, v49, v11
    v_mul_f32 v50, v50, v11
    v_mul_f32 v51, v51, v11
    v_accvgpr_write_b32 a88, v48
    v_accvgpr_write_b32 a89, v49
    v_accvgpr_write_b32 a90, v50
    v_accvgpr_write_b32 a91, v51
    v_accvgpr_read_b32 v48, a92
    v_accvgpr_read_b32 v49, a93
    v_accvgpr_read_b32 v50, a94
    v_accvgpr_read_b32 v51, a95
    v_mul_f32 v48, v48, v12
    v_mul_f32 v49, v49, v12
    v_mul_f32 v50, v50, v12
    v_mul_f32 v51, v51, v12
    v_accvgpr_write_b32 a92, v48
    v_accvgpr_write_b32 a93, v49
    v_accvgpr_write_b32 a94, v50
    v_accvgpr_write_b32 a95, v51
    v_accvgpr_read_b32 v48, a96
    v_accvgpr_read_b32 v49, a97
    v_accvgpr_read_b32 v50, a98
    v_accvgpr_read_b32 v51, a99
    v_mul_f32 v48, v48, v9
    v_mul_f32 v49, v49, v9
    v_mul_f32 v50, v50, v9
    v_mul_f32 v51, v51, v9
    v_accvgpr_write_b32 a96, v48
    v_accvgpr_write_b32 a97, v49
    v_accvgpr_write_b32 a98, v50
    v_accvgpr_write_b32 a99, v51
    v_accvgpr_read_b32 v48, a100
    v_accvgpr_read_b32 v49, a101
    v_accvgpr_read_b32 v50, a102
    v_accvgpr_read_b32 v51, a103
    v_mul_f32 v48, v48, v10
    v_mul_f32 v49, v49, v10
    v_mul_f32 v50, v50, v10
    v_mul_f32 v51, v51, v10
    v_accvgpr_write_b32 a100, v48
    v_accvgpr_write_b32 a101, v49
    v_accvgpr_write_b32 a102, v50
    v_accvgpr_write_b32 a103, v51
    v_accvgpr_read_b32 v48, a104
    v_accvgpr_read_b32 v49, a105
    v_accvgpr_read_b32 v50, a106
    v_accvgpr_read_b32 v51, a107
    v_mul_f32 v48, v48, v11
    v_mul_f32 v49, v49, v11
    v_mul_f32 v50, v50, v11
    v_mul_f32 v51, v51, v11
    v_accvgpr_write_b32 a104, v48
    v_accvgpr_write_b32 a105, v49
    v_accvgpr_write_b32 a106, v50
    v_accvgpr_write_b32 a107, v51
    v_accvgpr_read_b32 v48, a108
    v_accvgpr_read_b32 v49, a109
    v_accvgpr_read_b32 v50, a110
    v_accvgpr_read_b32 v51, a111
    v_mul_f32 v48, v48, v12
    v_mul_f32 v49, v49, v12
    v_mul_f32 v50, v50, v12
    v_mul_f32 v51, v51, v12
    v_accvgpr_write_b32 a108, v48
    v_accvgpr_write_b32 a109, v49
    v_accvgpr_write_b32 a110, v50
    v_accvgpr_write_b32 a111, v51
    v_accvgpr_read_b32 v48, a112
    v_accvgpr_read_b32 v49, a113
    v_accvgpr_read_b32 v50, a114
    v_accvgpr_read_b32 v51, a115
    v_mul_f32 v48, v48, v9
    v_mul_f32 v49, v49, v9
    v_mul_f32 v50, v50, v9
    v_mul_f32 v51, v51, v9
    v_accvgpr_write_b32 a112, v48
    v_accvgpr_write_b32 a113, v49
    v_accvgpr_write_b32 a114, v50
    v_accvgpr_write_b32 a115, v51
    v_accvgpr_read_b32 v48, a116
    v_accvgpr_read_b32 v49, a117
    v_accvgpr_read_b32 v50, a118
    v_accvgpr_read_b32 v51, a119
    v_mul_f32 v48, v48, v10
    v_mul_f32 v49, v49, v10
    v_mul_f32 v50, v50, v10
    v_mul_f32 v51, v51, v10
    v_accvgpr_write_b32 a116, v48
    v_accvgpr_write_b32 a117, v49
    v_accvgpr_write_b32 a118, v50
    v_accvgpr_write_b32 a119, v51
    v_accvgpr_read_b32 v48, a120
    v_accvgpr_read_b32 v49, a121
    v_accvgpr_read_b32 v50, a122
    v_accvgpr_read_b32 v51, a123
    v_mul_f32 v48, v48, v11
    v_mul_f32 v49, v49, v11
    v_mul_f32 v50, v50, v11
    v_mul_f32 v51, v51, v11
    v_accvgpr_write_b32 a120, v48
    v_accvgpr_write_b32 a121, v49
    v_accvgpr_write_b32 a122, v50
    v_accvgpr_write_b32 a123, v51
    v_accvgpr_read_b32 v48, a124
    v_accvgpr_read_b32 v49, a125
    v_accvgpr_read_b32 v50, a126
    v_accvgpr_read_b32 v51, a127
    v_mul_f32 v48, v48, v12
    v_mul_f32 v49, v49, v12
    v_mul_f32 v50, v50, v12
    v_mul_f32 v51, v51, v12
    v_accvgpr_write_b32 a124, v48
    v_accvgpr_write_b32 a125, v49
    v_accvgpr_write_b32 a126, v50
    v_accvgpr_write_b32 a127, v51
    v_mul_f32 v128, v128, v9
    v_mul_f32 v129, v129, v9
    v_mul_f32 v130, v130, v9
    v_mul_f32 v131, v131, v9
    v_mul_f32 v132, v132, v10
    v_mul_f32 v133, v133, v10
    v_mul_f32 v134, v134, v10
    v_mul_f32 v135, v135, v10
    v_mul_f32 v136, v136, v11
    v_mul_f32 v137, v137, v11
    v_mul_f32 v138, v138, v11
    v_mul_f32 v139, v139, v11
    v_mul_f32 v140, v140, v12
    v_mul_f32 v141, v141, v12
    v_mul_f32 v142, v142, v12
    v_mul_f32 v143, v143, v12
    v_mul_f32 v144, v144, v9
    v_mul_f32 v145, v145, v9
    v_mul_f32 v146, v146, v9
    v_mul_f32 v147, v147, v9
    v_mul_f32 v148, v148, v10
    v_mul_f32 v149, v149, v10
    v_mul_f32 v150, v150, v10
    v_mul_f32 v151, v151, v10
    v_mul_f32 v152, v152, v11
    v_mul_f32 v153, v153, v11
    v_mul_f32 v154, v154, v11
    v_mul_f32 v155, v155, v11
    v_mul_f32 v156, v156, v12
    v_mul_f32 v157, v157, v12
    v_mul_f32 v158, v158, v12
    v_mul_f32 v159, v159, v12
    v_mul_f32 v160, v160, v9
    v_mul_f32 v161, v161, v9
    v_mul_f32 v162, v162, v9
    v_mul_f32 v163, v163, v9
    v_mul_f32 v164, v164, v10
    v_mul_f32 v165, v165, v10
    v_mul_f32 v166, v166, v10
    v_mul_f32 v167, v167, v10
    v_mul_f32 v168, v168, v11
    v_mul_f32 v169, v169, v11
    v_mul_f32 v170, v170, v11
    v_mul_f32 v171, v171, v11
    v_mul_f32 v172, v172, v12
    v_mul_f32 v173, v173, v12
    v_mul_f32 v174, v174, v12
    v_mul_f32 v175, v175, v12
    v_mul_f32 v176, v176, v9
    v_mul_f32 v177, v177, v9
    v_mul_f32 v178, v178, v9
    v_mul_f32 v179, v179, v9
    v_mul_f32 v180, v180, v10
    v_mul_f32 v181, v181, v10
    v_mul_f32 v182, v182, v10
    v_mul_f32 v183, v183, v10
    v_mul_f32 v184, v184, v11
    v_mul_f32 v185, v185, v11
    v_mul_f32 v186, v186, v11
    v_mul_f32 v187, v187, v11
    v_mul_f32 v188, v188, v12
    v_mul_f32 v189, v189, v12
    v_mul_f32 v190, v190, v12
    v_mul_f32 v191, v191, v12
    v_mul_f32 v192, v192, v9
    v_mul_f32 v193, v193, v9
    v_mul_f32 v194, v194, v9
    v_mul_f32 v195, v195, v9
    v_mul_f32 v196, v196, v10
    v_mul_f32 v197, v197, v10
    v_mul_f32 v198, v198, v10
    v_mul_f32 v199, v199, v10
    v_mul_f32 v200, v200, v11
    v_mul_f32 v201, v201, v11
    v_mul_f32 v202, v202, v11
    v_mul_f32 v203, v203, v11
    v_mul_f32 v204, v204, v12
    v_mul_f32 v205, v205, v12
    v_mul_f32 v206, v206, v12
    v_mul_f32 v207, v207, v12
    v_mul_f32 v208, v208, v9
    v_mul_f32 v209, v209, v9
    v_mul_f32 v210, v210, v9
    v_mul_f32 v211, v211, v9
    v_mul_f32 v212, v212, v10
    v_mul_f32 v213, v213, v10
    v_mul_f32 v214, v214, v10
    v_mul_f32 v215, v215, v10
    v_mul_f32 v216, v216, v11
    v_mul_f32 v217, v217, v11
    v_mul_f32 v218, v218, v11
    v_mul_f32 v219, v219, v11
    v_mul_f32 v220, v220, v12
    v_mul_f32 v221, v221, v12
    v_mul_f32 v222, v222, v12
    v_mul_f32 v223, v223, v12
    v_mul_f32 v224, v224, v9
    v_mul_f32 v225, v225, v9
    v_mul_f32 v226, v226, v9
    v_mul_f32 v227, v227, v9
    v_mul_f32 v228, v228, v10
    v_mul_f32 v229, v229, v10
    v_mul_f32 v230, v230, v10
    v_mul_f32 v231, v231, v10
    v_mul_f32 v232, v232, v11
    v_mul_f32 v233, v233, v11
    v_mul_f32 v234, v234, v11
    v_mul_f32 v235, v235, v11
    v_mul_f32 v236, v236, v12
    v_mul_f32 v237, v237, v12
    v_mul_f32 v238, v238, v12
    v_mul_f32 v239, v239, v12
    v_mul_f32 v240, v240, v9
    v_mul_f32 v241, v241, v9
    v_mul_f32 v242, v242, v9
    v_mul_f32 v243, v243, v9
    v_mul_f32 v244, v244, v10
    v_mul_f32 v245, v245, v10
    v_mul_f32 v246, v246, v10
    v_mul_f32 v247, v247, v10
    v_mul_f32 v248, v248, v11
    v_mul_f32 v249, v249, v11
    v_mul_f32 v250, v250, v11
    v_mul_f32 v251, v251, v11
    v_mul_f32 v252, v252, v12
    v_mul_f32 v253, v253, v12
    v_mul_f32 v254, v254, v12
    v_mul_f32 v255, v255, v12
    s_nop 3
    s_setpc_b64 s[42:43]
K2_CODE_END:
K2_WPREP:
    s_load_dwordx4 s[44:47], s[0:1], 24
    s_load_dwordx4 s[48:51], s[0:1], 56
    s_load_dwordx2 s[52:53], s[0:1], 48
    s_load_dwordx2 s[4:5], s[0:1], 88
    v_lshrrev_b32 v12, 6, v0
    s_nop 0
    v_readfirstlane_b32 s30, v12
    v_and_b32 v0, 63, v0
    v_lshlrev_b32 v27, 4, v0
    s_mov_b32 s31, s2
    s_lshl_b32 s35, s30, 1
    s_add_u32 s32, s35, 12
    s_cmp_lt_u32 s30, 2
    s_cselect_b32 s35, s35, s32
    v_lshrrev_b32 v12, 5, v0
    s_lshl_b32 s32, s30, 1
    v_add_u32 v13, s32, v12
    v_bfe_u32 v14, v0, 1, 4
    v_xor_b32 v14, v14, v13
    v_lshlrev_b32 v14, 5, v14
    v_and_b32 v13, 1, v0
    v_lshl_add_u32 v14, v13, 4, v14
    v_lshl_add_u32 v1, v12, 9, v14
    v_lshrrev_b32 v12, 5, v0
    s_lshl_b32 s32, s30, 1
    v_add_u32 v13, s32, v12
    v_and_b32 v13, 15, v13
    v_and_b32 v14, 31, v0
    v_xor_b32 v14, v14, v13
    v_lshlrev_b32 v14, 4, v14
    v_lshl_add_u32 v2, v12, 9, v14
    v_lshrrev_b32 v12, 5, v0
    s_lshl_b32 s32, s30, 1
    v_add_u32 v13, s32, v12
    v_add_u32 v13, 8, v13
    v_and_b32 v13, 15, v13
    v_and_b32 v14, 31, v0
    v_xor_b32 v14, v14, v13
    v_lshlrev_b32 v14, 4, v14
    v_lshl_add_u32 v3, v12, 9, v14
    v_and_b32 v12, 15, v0
    v_lshrrev_b32 v13, 4, v0
    v_lshrrev_b32 v14, 1, v13
    v_xor_b32 v14, v14, v12
    v_lshlrev_b32 v14, 4, v14
    v_lshl_add_u32 v26, v12, 9, v14
    v_and_b32 v14, 1, v13
    v_lshl_add_u32 v26, v14, 3, v26
    v_add_u32 v26, 0x20000, v26
    v_bfe_u32 v14, v0, 2, 2
    v_and_b32 v15, 3, v0
    v_lshl_add_u32 v14, v13, 2, v14
    v_and_b32 v16, 7, v14
    s_lshl_b32 s32, s30, 2
    v_xor_b32 v17, s32, v16
    v_lshlrev_b32 v17, 5, v17
    v_lshl_add_u32 v4, v14, 9, v17
    v_lshl_add_u32 v4, v15, 3, v4
    v_xor_b32 v5, 32, v4
    v_xor_b32 v6, 64, v4
    v_xor_b32 v7, 96, v4
    v_add_u32 v8, 65536, v4
    v_add_u32 v9, 65536, v5
    v_add_u32 v10, 65536, v6
    v_add_u32 v11, 65536, v7
    v_add_u32 v17, s32, v15
    v_xor_b32 v17, v17, v16
    v_lshlrev_b32 v17, 5, v17
    v_lshl_add_u32 v28, v14, 9, v17
    v_add_u32 v29, 65536, v28
    s_waitcnt lgkmcnt(0)
    s_mov_b32 s8, s4
    s_mov_b32 s9, s5
    s_mov_b32 s10, 0x4000000
    s_mov_b32 s11, 0x00020000
    s_mov_b32 s12, s48
    s_mov_b32 s13, s49
    s_mov_b32 s14, 0x20000
    s_mov_b32 s15, 0x00020000
    s_lshl_b32 s32, s31, 15
    s_lshl_b32 s33, s30, 10
    s_mov_b32 s34, s33
    s_add_u32 s32, s32, s34
    s_add_u32 m0, s33, 131072
    s_add_u32 s34, s32, 0
    buffer_load_dwordx4 v2, s[12:15], s34 offen lds
    s_add_u32 m0, s33, 135168
    s_add_u32 s34, s32, 4096
    buffer_load_dwordx4 v3, s[12:15], s34 offen lds
    s_add_u32 m0, s33, 139264
    s_add_u32 s34, s32, 8192
    buffer_load_dwordx4 v2, s[12:15], s34 offen lds
    s_add_u32 m0, s33, 143360
    s_add_u32 s34, s32, 12288
    buffer_load_dwordx4 v3, s[12:15], s34 offen lds
    s_add_u32 m0, s33, 147456
    s_add_u32 s34, s32, 16384
    buffer_load_dwordx4 v2, s[12:15], s34 offen lds
    s_add_u32 m0, s33, 151552
    s_add_u32 s34, s32, 20480
    buffer_load_dwordx4 v3, s[12:15], s34 offen lds
    s_add_u32 m0, s33, 155648
    s_add_u32 s34, s32, 24576
    buffer_load_dwordx4 v2, s[12:15], s34 offen lds
    s_add_u32 m0, s33, 159744
    s_add_u32 s34, s32, 28672
    buffer_load_dwordx4 v3, s[12:15], s34 offen lds
    s_mov_b32 s16, s50
    s_mov_b32 s17, s51
    s_mov_b32 s18, 0x40000
    s_mov_b32 s19, 0x00020000
    s_lshl_b32 s32, s30, 10
    s_add_u32 m0, s32, 0
    s_add_u32 s33, s32, 131072
    buffer_load_dwordx4 v1, s[16:19], s33 offen lds
    s_add_u32 m0, s32, 4096
    s_add_u32 s33, s32, 135168
    buffer_load_dwordx4 v1, s[16:19], s33 offen lds
    s_add_u32 m0, s32, 8192
    s_add_u32 s33, s32, 139264
    buffer_load_dwordx4 v1, s[16:19], s33 offen lds
    s_add_u32 m0, s32, 12288
    s_add_u32 s33, s32, 143360
    buffer_load_dwordx4 v1, s[16:19], s33 offen lds
    s_add_u32 m0, s32, 16384
    s_add_u32 s33, s32, 147456
    buffer_load_dwordx4 v1, s[16:19], s33 offen lds
    s_add_u32 m0, s32, 20480
    s_add_u32 s33, s32, 151552
    buffer_load_dwordx4 v1, s[16:19], s33 offen lds
    s_add_u32 m0, s32, 24576
    s_add_u32 s33, s32, 155648
    buffer_load_dwordx4 v1, s[16:19], s33 offen lds
    s_add_u32 m0, s32, 28672
    s_add_u32 s33, s32, 159744
    buffer_load_dwordx4 v1, s[16:19], s33 offen lds
    s_add_u32 m0, s32, 32768
    s_add_u32 s33, s32, 163840
    buffer_load_dwordx4 v1, s[16:19], s33 offen lds
    s_add_u32 m0, s32, 36864
    s_add_u32 s33, s32, 167936
    buffer_load_dwordx4 v1, s[16:19], s33 offen lds
    s_add_u32 m0, s32, 40960
    s_add_u32 s33, s32, 172032
    buffer_load_dwordx4 v1, s[16:19], s33 offen lds
    s_add_u32 m0, s32, 45056
    s_add_u32 s33, s32, 176128
    buffer_load_dwordx4 v1, s[16:19], s33 offen lds
    s_add_u32 m0, s32, 49152
    s_add_u32 s33, s32, 180224
    buffer_load_dwordx4 v1, s[16:19], s33 offen lds
    s_add_u32 m0, s32, 53248
    s_add_u32 s33, s32, 184320
    buffer_load_dwordx4 v1, s[16:19], s33 offen lds
    s_add_u32 m0, s32, 57344
    s_add_u32 s33, s32, 188416
    buffer_load_dwordx4 v1, s[16:19], s33 offen lds
    s_add_u32 m0, s32, 61440
    s_add_u32 s33, s32, 192512
    buffer_load_dwordx4 v1, s[16:19], s33 offen lds
    s_add_u32 m0, s32, 65536
    s_add_u32 s33, s32, 196608
    buffer_load_dwordx4 v1, s[16:19], s33 offen lds
    s_add_u32 m0, s32, 69632
    s_add_u32 s33, s32, 200704
    buffer_load_dwordx4 v1, s[16:19], s33 offen lds
    s_add_u32 m0, s32, 73728
    s_add_u32 s33, s32, 204800
    buffer_load_dwordx4 v1, s[16:19], s33 offen lds
    s_add_u32 m0, s32, 77824
    s_add_u32 s33, s32, 208896
    buffer_load_dwordx4 v1, s[16:19], s33 offen lds
    s_add_u32 m0, s32, 81920
    s_add_u32 s33, s32, 212992
    buffer_load_dwordx4 v1, s[16:19], s33 offen lds
    s_add_u32 m0, s32, 86016
    s_add_u32 s33, s32, 217088
    buffer_load_dwordx4 v1, s[16:19], s33 offen lds
    s_add_u32 m0, s32, 90112
    s_add_u32 s33, s32, 221184
    buffer_load_dwordx4 v1, s[16:19], s33 offen lds
    s_add_u32 m0, s32, 94208
    s_add_u32 s33, s32, 225280
    buffer_load_dwordx4 v1, s[16:19], s33 offen lds
    s_add_u32 m0, s32, 98304
    s_add_u32 s33, s32, 229376
    buffer_load_dwordx4 v1, s[16:19], s33 offen lds
    s_add_u32 m0, s32, 102400
    s_add_u32 s33, s32, 233472
    buffer_load_dwordx4 v1, s[16:19], s33 offen lds
    s_add_u32 m0, s32, 106496
    s_add_u32 s33, s32, 237568
    buffer_load_dwordx4 v1, s[16:19], s33 offen lds
    s_add_u32 m0, s32, 110592
    s_add_u32 s33, s32, 241664
    buffer_load_dwordx4 v1, s[16:19], s33 offen lds
    s_add_u32 m0, s32, 114688
    s_add_u32 s33, s32, 245760
    buffer_load_dwordx4 v1, s[16:19], s33 offen lds
    s_add_u32 m0, s32, 118784
    s_add_u32 s33, s32, 249856
    buffer_load_dwordx4 v1, s[16:19], s33 offen lds
    s_add_u32 m0, s32, 122880
    s_add_u32 s33, s32, 253952
    buffer_load_dwordx4 v1, s[16:19], s33 offen lds
    s_add_u32 m0, s32, 126976
    s_add_u32 s33, s32, 258048
    buffer_load_dwordx4 v1, s[16:19], s33 offen lds
    s_mov_b32 s12, s52
    s_mov_b32 s13, s53
    s_mov_b32 s14, 2560
    s_mov_b32 s15, 0x00020000
    s_lshl_b32 s32, s31, 2
    s_add_u32 s32, s32, s30
    s_mul_i32 s32, s32, 80
    v_lshlrev_b32 v12, 1, v0
    v_add_u32 v12, s32, v12
    v_lshlrev_b32 v16, 1, v12
    v_cmp_gt_u32 vcc, 40, v0
    v_mov_b32 v13, 0x7ff00000
    s_nop 0
    v_cndmask_b32 v16, v13, v16, vcc
    buffer_load_dword v14, v16, s[12:15], 0 offen
    v_lshrrev_b32 v17, 6, v12
    v_lshlrev_b32 v17, 4, v17
    v_and_b32 v18, 15, v12
    v_add_u32 v17, v17, v18
    v_lshlrev_b32 v17, 2, v17
    v_bfe_u32 v18, v12, 4, 2
    v_add_u32 v17, v17, v18
    v_lshlrev_b32 v17, 2, v17
    v_cndmask_b32 v17, v13, v17, vcc
    s_waitcnt vmcnt(0)
    v_and_b32 v20, 0xffff, v14
    v_lshl_or_b32 v20, v20, 16, v20
    v_and_b32 v21, 0xffff0000, v14
    v_lshrrev_b32 v15, 16, v14
    v_or_b32 v21, v21, v15
    s_mov_b32 s32, 0x1a90000
    buffer_store_dword v20, v17, s[8:11], s32 offen sc0 sc1
    buffer_store_dword v21, v17, s[8:11], s32 offen offset:16 sc0 sc1
    s_waitcnt vmcnt(0)
    s_barrier
    v_xor_b32 v12, 0, v26
    v_xor_b32 v13, 32, v26
    ds_read_b64 v[128:129], v12
    ds_read_b64 v[130:131], v13
    ds_read_b64 v[132:133], v12 offset:8192
    ds_read_b64 v[134:135], v13 offset:8192
    ds_read_b64 v[136:137], v12 offset:16384
    ds_read_b64 v[138:139], v13 offset:16384
    ds_read_b64 v[140:141], v12 offset:24576
    ds_read_b64 v[142:143], v13 offset:24576
    v_xor_b32 v12, 64, v26
    v_xor_b32 v13, 96, v26
    ds_read_b64 v[144:145], v12
    ds_read_b64 v[146:147], v13
    ds_read_b64 v[148:149], v12 offset:8192
    ds_read_b64 v[150:151], v13 offset:8192
    ds_read_b64 v[152:153], v12 offset:16384
    ds_read_b64 v[154:155], v13 offset:16384
    ds_read_b64 v[156:157], v12 offset:24576
    s_waitcnt lgkmcnt(12)
    ds_read_b64 v[158:159], v13 offset:24576
    v_xor_b32 v12, 128, v26
    v_xor_b32 v13, 160, v26
    ds_read_b64 v[160:161], v12
    ds_read_b64 v[162:163], v13
    s_waitcnt lgkmcnt(12)
    ds_read_b64 v[164:165], v12 offset:8192
    ds_read_b64 v[166:167], v13 offset:8192
    ds_read_b64 v[168:169], v12 offset:16384
    s_waitcnt lgkmcnt(12)
    ds_read_b64 v[170:171], v13 offset:16384
    ds_read_b64 v[172:173], v12 offset:24576
    ds_read_b64 v[174:175], v13 offset:24576
    v_xor_b32 v12, 192, v26
    v_xor_b32 v13, 224, v26
    s_waitcnt lgkmcnt(12)
    ds_read_b64 v[176:177], v12
    ds_read_b64 v[178:179], v13
    ds_read_b64 v[180:181], v12 offset:8192
    s_waitcnt lgkmcnt(12)
    ds_read_b64 v[182:183], v13 offset:8192
    ds_read_b64 v[184:185], v12 offset:16384
    ds_read_b64 v[186:187], v13 offset:16384
    s_waitcnt lgkmcnt(12)
    ds_read_b64 v[188:189], v12 offset:24576
    ds_read_b64 v[190:191], v13 offset:24576
    v_xor_b32 v12, 256, v26
    v_xor_b32 v13, 288, v26
    ds_read_b64 v[192:193], v12
    s_waitcnt lgkmcnt(12)
    ds_read_b64 v[194:195], v13
    ds_read_b64 v[196:197], v12 offset:8192
    ds_read_b64 v[198:199], v13 offset:8192
    s_waitcnt lgkmcnt(12)
    ds_read_b64 v[200:201], v12 offset:16384
    ds_read_b64 v[202:203], v13 offset:16384
    ds_read_b64 v[204:205], v12 offset:24576
    s_waitcnt lgkmcnt(12)
    ds_read_b64 v[206:207], v13 offset:24576
    v_xor_b32 v12, 320, v26
    v_xor_b32 v13, 352, v26
    ds_read_b64 v[208:209], v12
    ds_read_b64 v[210:211], v13
    s_waitcnt lgkmcnt(12)
    ds_read_b64 v[212:213], v12 offset:8192
    ds_read_b64 v[214:215], v13 offset:8192
    ds_read_b64 v[216:217], v12 offset:16384
    s_waitcnt lgkmcnt(12)
    ds_read_b64 v[218:219], v13 offset:16384
    ds_read_b64 v[220:221], v12 offset:24576
    ds_read_b64 v[222:223], v13 offset:24576
    v_xor_b32 v12, 384, v26
    v_xor_b32 v13, 416, v26
    s_waitcnt lgkmcnt(12)
    ds_read_b64 v[224:225], v12
    ds_read_b64 v[226:227], v13
    ds_read_b64 v[228:229], v12 offset:8192
    s_waitcnt lgkmcnt(12)
    ds_read_b64 v[230:231], v13 offset:8192
    ds_read_b64 v[232:233], v12 offset:16384
    ds_read_b64 v[234:235], v13 offset:16384
    s_waitcnt lgkmcnt(12)
    ds_read_b64 v[236:237], v12 offset:24576
    ds_read_b64 v[238:239], v13 offset:24576
    v_xor_b32 v12, 448, v26
    v_xor_b32 v13, 480, v26
    ds_read_b64 v[240:241], v12
    s_waitcnt lgkmcnt(12)
    ds_read_b64 v[242:243], v13
    ds_read_b64 v[244:245], v12 offset:8192
    ds_read_b64 v[246:247], v13 offset:8192
    s_waitcnt lgkmcnt(12)
    ds_read_b64 v[248:249], v12 offset:16384
    ds_read_b64 v[250:251], v13 offset:16384
    ds_read_b64 v[252:253], v12 offset:24576
    s_waitcnt lgkmcnt(12)
    ds_read_b64 v[254:255], v13 offset:24576
    s_waitcnt lgkmcnt(0)
    s_barrier
    ds_read_b64_tr_b16 v[96:97], v28
    ds_read_b64_tr_b16 v[98:99], v28 offset:8192
    ds_read_b64_tr_b16 v[100:101], v28 offset:8
    ds_read_b64_tr_b16 v[102:103], v28 offset:8200
    ds_read_b64_tr_b16 v[104:105], v28 offset:16
    ds_read_b64_tr_b16 v[106:107], v28 offset:8208
    ds_read_b64_tr_b16 v[108:109], v28 offset:24
    ds_read_b64_tr_b16 v[110:111], v28 offset:8216
    s_waitcnt lgkmcnt(6)
    v_mfma_f32_16x16x32_bf16 v[32:35], v[128:131], v[96:99], 0
    ds_read_b64_tr_b16 v[112:113], v28 offset:16384
    v_mfma_f32_16x16x32_bf16 v[36:39], v[132:135], v[96:99], 0
    ds_read_b64_tr_b16 v[114:115], v28 offset:24576
    v_mfma_f32_16x16x32_bf16 v[40:43], v[136:139], v[96:99], 0
    ds_read_b64_tr_b16 v[116:117], v28 offset:16392
    v_mfma_f32_16x16x32_bf16 v[44:47], v[140:143], v[96:99], 0
    ds_read_b64_tr_b16 v[118:119], v28 offset:24584
    s_waitcnt lgkmcnt(8)
    v_mfma_f32_16x16x32_bf16 v[48:51], v[128:131], v[100:103], 0
    ds_read_b64_tr_b16 v[120:121], v28 offset:16400
    v_mfma_f32_16x16x32_bf16 v[52:55], v[132:135], v[100:103], 0
    ds_read_b64_tr_b16 v[122:123], v28 offset:24592
    v_mfma_f32_16x16x32_bf16 v[56:59], v[136:139], v[100:103], 0
    ds_read_b64_tr_b16 v[124:125], v28 offset:16408
    v_mfma_f32_16x16x32_bf16 v[60:63], v[140:143], v[100:103], 0
    ds_read_b64_tr_b16 v[126:127], v28 offset:24600
    s_waitcnt lgkmcnt(10)
    v_mfma_f32_16x16x32_bf16 v[64:67], v[128:131], v[104:107], 0
    v_mfma_f32_16x16x32_bf16 v[68:71], v[132:135], v[104:107], 0
    v_mfma_f32_16x16x32_bf16 v[72:75], v[136:139], v[104:107], 0
    v_mfma_f32_16x16x32_bf16 v[76:79], v[140:143], v[104:107], 0
    s_waitcnt lgkmcnt(8)
    v_mfma_f32_16x16x32_bf16 v[80:83], v[128:131], v[108:111], 0
    v_mfma_f32_16x16x32_bf16 v[84:87], v[132:135], v[108:111], 0
    v_mfma_f32_16x16x32_bf16 v[88:91], v[136:139], v[108:111], 0
    v_mfma_f32_16x16x32_bf16 v[92:95], v[140:143], v[108:111], 0
    s_waitcnt lgkmcnt(6)
    v_mfma_f32_16x16x32_bf16 v[32:35], v[144:147], v[112:115], v[32:35]
    ds_read_b64_tr_b16 v[96:97], v28 offset:32768
    v_mfma_f32_16x16x32_bf16 v[36:39], v[148:151], v[112:115], v[36:39]
    ds_read_b64_tr_b16 v[98:99], v28 offset:40960
    v_mfma_f32_16x16x32_bf16 v[40:43], v[152:155], v[112:115], v[40:43]
    ds_read_b64_tr_b16 v[100:101], v28 offset:32776
    v_mfma_f32_16x16x32_bf16 v[44:47], v[156:159], v[112:115], v[44:47]
    ds_read_b64_tr_b16 v[102:103], v28 offset:40968
    s_waitcnt lgkmcnt(8)
    v_mfma_f32_16x16x32_bf16 v[48:51], v[144:147], v[116:119], v[48:51]
    ds_read_b64_tr_b16 v[104:105], v28 offset:32784
    v_mfma_f32_16x16x32_bf16 v[52:55], v[148:151], v[116:119], v[52:55]
    ds_read_b64_tr_b16 v[106:107], v28 offset:40976
    v_mfma_f32_16x16x32_bf16 v[56:59], v[152:155], v[116:119], v[56:59]
    ds_read_b64_tr_b16 v[108:109], v28 offset:32792
    v_mfma_f32_16x16x32_bf16 v[60:63], v[156:159], v[116:119], v[60:63]
    ds_read_b64_tr_b16 v[110:111], v28 offset:40984
    s_waitcnt lgkmcnt(10)
    v_mfma_f32_16x16x32_bf16 v[64:67], v[144:147], v[120:123], v[64:67]
    v_mfma_f32_16x16x32_bf16 v[68:71], v[148:151], v[120:123], v[68:71]
    v_mfma_f32_16x16x32_bf16 v[72:75], v[152:155], v[120:123], v[72:75]
    v_mfma_f32_16x16x32_bf16 v[76:79], v[156:159], v[120:123], v[76:79]
    s_waitcnt lgkmcnt(8)
    v_mfma_f32_16x16x32_bf16 v[80:83], v[144:147], v[124:127], v[80:83]
    v_mfma_f32_16x16x32_bf16 v[84:87], v[148:151], v[124:127], v[84:87]
    v_mfma_f32_16x16x32_bf16 v[88:91], v[152:155], v[124:127], v[88:91]
    v_mfma_f32_16x16x32_bf16 v[92:95], v[156:159], v[124:127], v[92:95]
    s_waitcnt lgkmcnt(6)
    v_mfma_f32_16x16x32_bf16 v[32:35], v[160:163], v[96:99], v[32:35]
    ds_read_b64_tr_b16 v[112:113], v28 offset:49152
    v_mfma_f32_16x16x32_bf16 v[36:39], v[164:167], v[96:99], v[36:39]
    ds_read_b64_tr_b16 v[114:115], v28 offset:57344
    v_mfma_f32_16x16x32_bf16 v[40:43], v[168:171], v[96:99], v[40:43]
    ds_read_b64_tr_b16 v[116:117], v28 offset:49160
    v_mfma_f32_16x16x32_bf16 v[44:47], v[172:175], v[96:99], v[44:47]
    ds_read_b64_tr_b16 v[118:119], v28 offset:57352
    s_waitcnt lgkmcnt(8)
    v_mfma_f32_16x16x32_bf16 v[48:51], v[160:163], v[100:103], v[48:51]
    ds_read_b64_tr_b16 v[120:121], v28 offset:49168
    v_mfma_f32_16x16x32_bf16 v[52:55], v[164:167], v[100:103], v[52:55]
    ds_read_b64_tr_b16 v[122:123], v28 offset:57360
    v_mfma_f32_16x16x32_bf16 v[56:59], v[168:171], v[100:103], v[56:59]
    ds_read_b64_tr_b16 v[124:125], v28 offset:49176
    v_mfma_f32_16x16x32_bf16 v[60:63], v[172:175], v[100:103], v[60:63]
    ds_read_b64_tr_b16 v[126:127], v28 offset:57368
    s_waitcnt lgkmcnt(10)
    v_mfma_f32_16x16x32_bf16 v[64:67], v[160:163], v[104:107], v[64:67]
    v_mfma_f32_16x16x32_bf16 v[68:71], v[164:167], v[104:107], v[68:71]
    v_mfma_f32_16x16x32_bf16 v[72:75], v[168:171], v[104:107], v[72:75]
    v_mfma_f32_16x16x32_bf16 v[76:79], v[172:175], v[104:107], v[76:79]
    s_waitcnt lgkmcnt(8)
    v_mfma_f32_16x16x32_bf16 v[80:83], v[160:163], v[108:111], v[80:83]
    v_mfma_f32_16x16x32_bf16 v[84:87], v[164:167], v[108:111], v[84:87]
    v_mfma_f32_16x16x32_bf16 v[88:91], v[168:171], v[108:111], v[88:91]
    v_mfma_f32_16x16x32_bf16 v[92:95], v[172:175], v[108:111], v[92:95]
    s_waitcnt lgkmcnt(6)
    v_mfma_f32_16x16x32_bf16 v[32:35], v[176:179], v[112:115], v[32:35]
    ds_read_b64_tr_b16 v[96:97], v29
    v_mfma_f32_16x16x32_bf16 v[36:39], v[180:183], v[112:115], v[36:39]
    ds_read_b64_tr_b16 v[98:99], v29 offset:8192
    v_mfma_f32_16x16x32_bf16 v[40:43], v[184:187], v[112:115], v[40:43]
    ds_read_b64_tr_b16 v[100:101], v29 offset:8
    v_mfma_f32_16x16x32_bf16 v[44:47], v[188:191], v[112:115], v[44:47]
    ds_read_b64_tr_b16 v[102:103], v29 offset:8200
    s_waitcnt lgkmcnt(8)
    v_mfma_f32_16x16x32_bf16 v[48:51], v[176:179], v[116:119], v[48:51]
    ds_read_b64_tr_b16 v[104:105], v29 offset:16
    v_mfma_f32_16x16x32_bf16 v[52:55], v[180:183], v[116:119], v[52:55]
    ds_read_b64_tr_b16 v[106:107], v29 offset:8208
    v_mfma_f32_16x16x32_bf16 v[56:59], v[184:187], v[116:119], v[56:59]
    ds_read_b64_tr_b16 v[108:109], v29 offset:24
    v_mfma_f32_16x16x32_bf16 v[60:63], v[188:191], v[116:119], v[60:63]
    ds_read_b64_tr_b16 v[110:111], v29 offset:8216
    s_waitcnt lgkmcnt(10)
    v_mfma_f32_16x16x32_bf16 v[64:67], v[176:179], v[120:123], v[64:67]
    v_mfma_f32_16x16x32_bf16 v[68:71], v[180:183], v[120:123], v[68:71]
    v_mfma_f32_16x16x32_bf16 v[72:75], v[184:187], v[120:123], v[72:75]
    v_mfma_f32_16x16x32_bf16 v[76:79], v[188:191], v[120:123], v[76:79]
    s_waitcnt lgkmcnt(8)
    v_mfma_f32_16x16x32_bf16 v[80:83], v[176:179], v[124:127], v[80:83]
    v_mfma_f32_16x16x32_bf16 v[84:87], v[180:183], v[124:127], v[84:87]
    v_mfma_f32_16x16x32_bf16 v[88:91], v[184:187], v[124:127], v[88:91]
    v_mfma_f32_16x16x32_bf16 v[92:95], v[188:191], v[124:127], v[92:95]
    s_waitcnt lgkmcnt(6)
    v_mfma_f32_16x16x32_bf16 v[32:35], v[192:195], v[96:99], v[32:35]
    ds_read_b64_tr_b16 v[112:113], v29 offset:16384
    v_mfma_f32_16x16x32_bf16 v[36:39], v[196:199], v[96:99], v[36:39]
    ds_read_b64_tr_b16 v[114:115], v29 offset:24576
    v_mfma_f32_16x16x32_bf16 v[40:43], v[200:203], v[96:99], v[40:43]
    ds_read_b64_tr_b16 v[116:117], v29 offset:16392
    v_mfma_f32_16x16x32_bf16 v[44:47], v[204:207], v[96:99], v[44:47]
    ds_read_b64_tr_b16 v[118:119], v29 offset:24584
    s_waitcnt lgkmcnt(8)
    v_mfma_f32_16x16x32_bf16 v[48:51], v[192:195], v[100:103], v[48:51]
    ds_read_b64_tr_b16 v[120:121], v29 offset:16400
    v_mfma_f32_16x16x32_bf16 v[52:55], v[196:199], v[100:103], v[52:55]
    ds_read_b64_tr_b16 v[122:123], v29 offset:24592
    v_mfma_f32_16x16x32_bf16 v[56:59], v[200:203], v[100:103], v[56:59]
    ds_read_b64_tr_b16 v[124:125], v29 offset:16408
    v_mfma_f32_16x16x32_bf16 v[60:63], v[204:207], v[100:103], v[60:63]
    ds_read_b64_tr_b16 v[126:127], v29 offset:24600
    s_waitcnt lgkmcnt(10)
    v_mfma_f32_16x16x32_bf16 v[64:67], v[192:195], v[104:107], v[64:67]
    v_mfma_f32_16x16x32_bf16 v[68:71], v[196:199], v[104:107], v[68:71]
    v_mfma_f32_16x16x32_bf16 v[72:75], v[200:203], v[104:107], v[72:75]
    v_mfma_f32_16x16x32_bf16 v[76:79], v[204:207], v[104:107], v[76:79]
    s_waitcnt lgkmcnt(8)
    v_mfma_f32_16x16x32_bf16 v[80:83], v[192:195], v[108:111], v[80:83]
    v_mfma_f32_16x16x32_bf16 v[84:87], v[196:199], v[108:111], v[84:87]
    v_mfma_f32_16x16x32_bf16 v[88:91], v[200:203], v[108:111], v[88:91]
    v_mfma_f32_16x16x32_bf16 v[92:95], v[204:207], v[108:111], v[92:95]
    s_waitcnt lgkmcnt(6)
    v_mfma_f32_16x16x32_bf16 v[32:35], v[208:211], v[112:115], v[32:35]
    ds_read_b64_tr_b16 v[96:97], v29 offset:32768
    v_mfma_f32_16x16x32_bf16 v[36:39], v[212:215], v[112:115], v[36:39]
    ds_read_b64_tr_b16 v[98:99], v29 offset:40960
    v_mfma_f32_16x16x32_bf16 v[40:43], v[216:219], v[112:115], v[40:43]
    ds_read_b64_tr_b16 v[100:101], v29 offset:32776
    v_mfma_f32_16x16x32_bf16 v[44:47], v[220:223], v[112:115], v[44:47]
    ds_read_b64_tr_b16 v[102:103], v29 offset:40968
    s_waitcnt lgkmcnt(8)
    v_mfma_f32_16x16x32_bf16 v[48:51], v[208:211], v[116:119], v[48:51]
    ds_read_b64_tr_b16 v[104:105], v29 offset:32784
    v_mfma_f32_16x16x32_bf16 v[52:55], v[212:215], v[116:119], v[52:55]
    ds_read_b64_tr_b16 v[106:107], v29 offset:40976
    v_mfma_f32_16x16x32_bf16 v[56:59], v[216:219], v[116:119], v[56:59]
    ds_read_b64_tr_b16 v[108:109], v29 offset:32792
    v_mfma_f32_16x16x32_bf16 v[60:63], v[220:223], v[116:119], v[60:63]
    ds_read_b64_tr_b16 v[110:111], v29 offset:40984
    s_waitcnt lgkmcnt(10)
    v_mfma_f32_16x16x32_bf16 v[64:67], v[208:211], v[120:123], v[64:67]
    v_mfma_f32_16x16x32_bf16 v[68:71], v[212:215], v[120:123], v[68:71]
    v_mfma_f32_16x16x32_bf16 v[72:75], v[216:219], v[120:123], v[72:75]
    v_mfma_f32_16x16x32_bf16 v[76:79], v[220:223], v[120:123], v[76:79]
    s_waitcnt lgkmcnt(8)
    v_mfma_f32_16x16x32_bf16 v[80:83], v[208:211], v[124:127], v[80:83]
    v_mfma_f32_16x16x32_bf16 v[84:87], v[212:215], v[124:127], v[84:87]
    v_mfma_f32_16x16x32_bf16 v[88:91], v[216:219], v[124:127], v[88:91]
    v_mfma_f32_16x16x32_bf16 v[92:95], v[220:223], v[124:127], v[92:95]
    s_waitcnt lgkmcnt(6)
    v_mfma_f32_16x16x32_bf16 v[32:35], v[224:227], v[96:99], v[32:35]
    ds_read_b64_tr_b16 v[112:113], v29 offset:49152
    v_mfma_f32_16x16x32_bf16 v[36:39], v[228:231], v[96:99], v[36:39]
    ds_read_b64_tr_b16 v[114:115], v29 offset:57344
    v_mfma_f32_16x16x32_bf16 v[40:43], v[232:235], v[96:99], v[40:43]
    ds_read_b64_tr_b16 v[116:117], v29 offset:49160
    v_mfma_f32_16x16x32_bf16 v[44:47], v[236:239], v[96:99], v[44:47]
    ds_read_b64_tr_b16 v[118:119], v29 offset:57352
    s_waitcnt lgkmcnt(8)
    v_mfma_f32_16x16x32_bf16 v[48:51], v[224:227], v[100:103], v[48:51]
    ds_read_b64_tr_b16 v[120:121], v29 offset:49168
    v_mfma_f32_16x16x32_bf16 v[52:55], v[228:231], v[100:103], v[52:55]
    ds_read_b64_tr_b16 v[122:123], v29 offset:57360
    v_mfma_f32_16x16x32_bf16 v[56:59], v[232:235], v[100:103], v[56:59]
    ds_read_b64_tr_b16 v[124:125], v29 offset:49176
    v_mfma_f32_16x16x32_bf16 v[60:63], v[236:239], v[100:103], v[60:63]
    ds_read_b64_tr_b16 v[126:127], v29 offset:57368
    s_waitcnt lgkmcnt(10)
    v_mfma_f32_16x16x32_bf16 v[64:67], v[224:227], v[104:107], v[64:67]
    v_mfma_f32_16x16x32_bf16 v[68:71], v[228:231], v[104:107], v[68:71]
    v_mfma_f32_16x16x32_bf16 v[72:75], v[232:235], v[104:107], v[72:75]
    v_mfma_f32_16x16x32_bf16 v[76:79], v[236:239], v[104:107], v[76:79]
    s_waitcnt lgkmcnt(8)
    v_mfma_f32_16x16x32_bf16 v[80:83], v[224:227], v[108:111], v[80:83]
    v_mfma_f32_16x16x32_bf16 v[84:87], v[228:231], v[108:111], v[84:87]
    v_mfma_f32_16x16x32_bf16 v[88:91], v[232:235], v[108:111], v[88:91]
    v_mfma_f32_16x16x32_bf16 v[92:95], v[236:239], v[108:111], v[92:95]
    s_waitcnt lgkmcnt(6)
    v_mfma_f32_16x16x32_bf16 v[32:35], v[240:243], v[112:115], v[32:35]
    v_mfma_f32_16x16x32_bf16 v[36:39], v[244:247], v[112:115], v[36:39]
    v_mfma_f32_16x16x32_bf16 v[40:43], v[248:251], v[112:115], v[40:43]
    v_mfma_f32_16x16x32_bf16 v[44:47], v[252:255], v[112:115], v[44:47]
    s_waitcnt lgkmcnt(4)
    v_mfma_f32_16x16x32_bf16 v[48:51], v[240:243], v[116:119], v[48:51]
    v_mfma_f32_16x16x32_bf16 v[52:55], v[244:247], v[116:119], v[52:55]
    v_mfma_f32_16x16x32_bf16 v[56:59], v[248:251], v[116:119], v[56:59]
    v_mfma_f32_16x16x32_bf16 v[60:63], v[252:255], v[116:119], v[60:63]
    s_waitcnt lgkmcnt(2)
    v_mfma_f32_16x16x32_bf16 v[64:67], v[240:243], v[120:123], v[64:67]
    v_mfma_f32_16x16x32_bf16 v[68:71], v[244:247], v[120:123], v[68:71]
    v_mfma_f32_16x16x32_bf16 v[72:75], v[248:251], v[120:123], v[72:75]
    v_mfma_f32_16x16x32_bf16 v[76:79], v[252:255], v[120:123], v[76:79]
    s_waitcnt lgkmcnt(0)
    v_mfma_f32_16x16x32_bf16 v[80:83], v[240:243], v[124:127], v[80:83]
    v_mfma_f32_16x16x32_bf16 v[84:87], v[244:247], v[124:127], v[84:87]
    v_mfma_f32_16x16x32_bf16 v[88:91], v[248:251], v[124:127], v[88:91]
    v_mfma_f32_16x16x32_bf16 v[92:95], v[252:255], v[124:127], v[92:95]
    s_barrier
    s_mov_b32 s16, s46
    s_mov_b32 s17, s47
    s_mov_b32 s18, 0x20000
    s_mov_b32 s19, 0x00020000
    s_lshl_b32 s32, s30, 10
    s_add_u32 m0, s32, 0
    s_add_u32 s33, s32, 0
    buffer_load_dwordx4 v1, s[16:19], s33 offen lds
    s_add_u32 m0, s32, 4096
    s_add_u32 s33, s32, 4096
    buffer_load_dwordx4 v1, s[16:19], s33 offen lds
    s_add_u32 m0, s32, 8192
    s_add_u32 s33, s32, 8192
    buffer_load_dwordx4 v1, s[16:19], s33 offen lds
    s_add_u32 m0, s32, 12288
    s_add_u32 s33, s32, 12288
    buffer_load_dwordx4 v1, s[16:19], s33 offen lds
    s_add_u32 m0, s32, 16384
    s_add_u32 s33, s32, 16384
    buffer_load_dwordx4 v1, s[16:19], s33 offen lds
    s_add_u32 m0, s32, 20480
    s_add_u32 s33, s32, 20480
    buffer_load_dwordx4 v1, s[16:19], s33 offen lds
    s_add_u32 m0, s32, 24576
    s_add_u32 s33, s32, 24576
    buffer_load_dwordx4 v1, s[16:19], s33 offen lds
    s_add_u32 m0, s32, 28672
    s_add_u32 s33, s32, 28672
    buffer_load_dwordx4 v1, s[16:19], s33 offen lds
    s_add_u32 m0, s32, 32768
    s_add_u32 s33, s32, 32768
    buffer_load_dwordx4 v1, s[16:19], s33 offen lds
    s_add_u32 m0, s32, 36864
    s_add_u32 s33, s32, 36864
    buffer_load_dwordx4 v1, s[16:19], s33 offen lds
    s_add_u32 m0, s32, 40960
    s_add_u32 s33, s32, 40960
    buffer_load_dwordx4 v1, s[16:19], s33 offen lds
    s_add_u32 m0, s32, 45056
    s_add_u32 s33, s32, 45056
    buffer_load_dwordx4 v1, s[16:19], s33 offen lds
    s_add_u32 m0, s32, 49152
    s_add_u32 s33, s32, 49152
    buffer_load_dwordx4 v1, s[16:19], s33 offen lds
    s_add_u32 m0, s32, 53248
    s_add_u32 s33, s32, 53248
    buffer_load_dwordx4 v1, s[16:19], s33 offen lds
    s_add_u32 m0, s32, 57344
    s_add_u32 s33, s32, 57344
    buffer_load_dwordx4 v1, s[16:19], s33 offen lds
    s_add_u32 m0, s32, 61440
    s_add_u32 s33, s32, 61440
    buffer_load_dwordx4 v1, s[16:19], s33 offen lds
    s_add_u32 m0, s32, 65536
    s_add_u32 s33, s32, 65536
    buffer_load_dwordx4 v1, s[16:19], s33 offen lds
    s_add_u32 m0, s32, 69632
    s_add_u32 s33, s32, 69632
    buffer_load_dwordx4 v1, s[16:19], s33 offen lds
    s_add_u32 m0, s32, 73728
    s_add_u32 s33, s32, 73728
    buffer_load_dwordx4 v1, s[16:19], s33 offen lds
    s_add_u32 m0, s32, 77824
    s_add_u32 s33, s32, 77824
    buffer_load_dwordx4 v1, s[16:19], s33 offen lds
    s_add_u32 m0, s32, 81920
    s_add_u32 s33, s32, 81920
    buffer_load_dwordx4 v1, s[16:19], s33 offen lds
    s_add_u32 m0, s32, 86016
    s_add_u32 s33, s32, 86016
    buffer_load_dwordx4 v1, s[16:19], s33 offen lds
    s_add_u32 m0, s32, 90112
    s_add_u32 s33, s32, 90112
    buffer_load_dwordx4 v1, s[16:19], s33 offen lds
    s_add_u32 m0, s32, 94208
    s_add_u32 s33, s32, 94208
    buffer_load_dwordx4 v1, s[16:19], s33 offen lds
    s_add_u32 m0, s32, 98304
    s_add_u32 s33, s32, 98304
    buffer_load_dwordx4 v1, s[16:19], s33 offen lds
    s_add_u32 m0, s32, 102400
    s_add_u32 s33, s32, 102400
    buffer_load_dwordx4 v1, s[16:19], s33 offen lds
    s_add_u32 m0, s32, 106496
    s_add_u32 s33, s32, 106496
    buffer_load_dwordx4 v1, s[16:19], s33 offen lds
    s_add_u32 m0, s32, 110592
    s_add_u32 s33, s32, 110592
    buffer_load_dwordx4 v1, s[16:19], s33 offen lds
    s_add_u32 m0, s32, 114688
    s_add_u32 s33, s32, 114688
    buffer_load_dwordx4 v1, s[16:19], s33 offen lds
    s_add_u32 m0, s32, 118784
    s_add_u32 s33, s32, 118784
    buffer_load_dwordx4 v1, s[16:19], s33 offen lds
    s_add_u32 m0, s32, 122880
    s_add_u32 s33, s32, 122880
    buffer_load_dwordx4 v1, s[16:19], s33 offen lds
    s_add_u32 m0, s32, 126976
    s_add_u32 s33, s32, 126976
    buffer_load_dwordx4 v1, s[16:19], s33 offen lds
    s_lshl_b32 s32, s30, 15
    s_lshl_b32 s33, s31, 11
    s_add_u32 s32, s32, s33
    s_add_u32 s32, s32, 0x1040000
    v_cvt_pk_bf16_f32 v96, v32, v33
    v_cvt_pk_bf16_f32 v97, v34, v35
    v_cvt_pk_bf16_f32 v98, v36, v37
    v_cvt_pk_bf16_f32 v99, v38, v39
    buffer_store_dwordx4 v[96:99], v27, s[8:11], s32 offen sc0 sc1
    v_cvt_pk_bf16_f32 v100, v40, v41
    v_cvt_pk_bf16_f32 v101, v42, v43
    v_cvt_pk_bf16_f32 v102, v44, v45
    v_cvt_pk_bf16_f32 v103, v46, v47
    buffer_store_dwordx4 v[100:103], v27, s[8:11], s32 offen offset:1024 sc0 sc1
    s_add_u32 s32, s32, 8192
    v_cvt_pk_bf16_f32 v104, v48, v49
    v_cvt_pk_bf16_f32 v105, v50, v51
    v_cvt_pk_bf16_f32 v106, v52, v53
    v_cvt_pk_bf16_f32 v107, v54, v55
    buffer_store_dwordx4 v[104:107], v27, s[8:11], s32 offen sc0 sc1
    v_cvt_pk_bf16_f32 v108, v56, v57
    v_cvt_pk_bf16_f32 v109, v58, v59
    v_cvt_pk_bf16_f32 v110, v60, v61
    v_cvt_pk_bf16_f32 v111, v62, v63
    buffer_store_dwordx4 v[108:111], v27, s[8:11], s32 offen offset:1024 sc0 sc1
    s_add_u32 s32, s32, 8192
    v_cvt_pk_bf16_f32 v112, v64, v65
    v_cvt_pk_bf16_f32 v113, v66, v67
    v_cvt_pk_bf16_f32 v114, v68, v69
    v_cvt_pk_bf16_f32 v115, v70, v71
    buffer_store_dwordx4 v[112:115], v27, s[8:11], s32 offen sc0 sc1
    v_cvt_pk_bf16_f32 v116, v72, v73
    v_cvt_pk_bf16_f32 v117, v74, v75
    v_cvt_pk_bf16_f32 v118, v76, v77
    v_cvt_pk_bf16_f32 v119, v78, v79
    buffer_store_dwordx4 v[116:119], v27, s[8:11], s32 offen offset:1024 sc0 sc1
    s_add_u32 s32, s32, 8192
    v_cvt_pk_bf16_f32 v120, v80, v81
    v_cvt_pk_bf16_f32 v121, v82, v83
    v_cvt_pk_bf16_f32 v122, v84, v85
    v_cvt_pk_bf16_f32 v123, v86, v87
    buffer_store_dwordx4 v[120:123], v27, s[8:11], s32 offen sc0 sc1
    v_cvt_pk_bf16_f32 v124, v88, v89
    v_cvt_pk_bf16_f32 v125, v90, v91
    v_cvt_pk_bf16_f32 v126, v92, v93
    v_cvt_pk_bf16_f32 v127, v94, v95
    buffer_store_dwordx4 v[124:127], v27, s[8:11], s32 offen offset:1024 sc0 sc1
    s_mov_b32 s12, s44
    s_mov_b32 s13, s45
    s_mov_b32 s14, 0x20000
    s_mov_b32 s15, 0x00020000
    s_lshl_b32 s32, s31, 15
    s_lshl_b32 s33, s30, 10
    s_lshl_b32 s34, s35, 9
    s_add_u32 s32, s32, s34
    s_add_u32 m0, s33, 131072
    s_add_u32 s34, s32, 0
    buffer_load_dwordx4 v2, s[12:15], s34 offen lds
    s_add_u32 m0, s33, 135168
    s_add_u32 s34, s32, 2048
    buffer_load_dwordx4 v3, s[12:15], s34 offen lds
    s_add_u32 m0, s33, 139264
    s_add_u32 s34, s32, 4096
    buffer_load_dwordx4 v2, s[12:15], s34 offen lds
    s_add_u32 m0, s33, 143360
    s_add_u32 s34, s32, 6144
    buffer_load_dwordx4 v3, s[12:15], s34 offen lds
    s_add_u32 m0, s33, 147456
    s_add_u32 s34, s32, 16384
    buffer_load_dwordx4 v2, s[12:15], s34 offen lds
    s_add_u32 m0, s33, 151552
    s_add_u32 s34, s32, 18432
    buffer_load_dwordx4 v3, s[12:15], s34 offen lds
    s_add_u32 m0, s33, 155648
    s_add_u32 s34, s32, 20480
    buffer_load_dwordx4 v2, s[12:15], s34 offen lds
    s_add_u32 m0, s33, 159744
    s_add_u32 s34, s32, 22528
    buffer_load_dwordx4 v3, s[12:15], s34 offen lds
    s_waitcnt vmcnt(0)
    s_barrier
    s_lshl_b32 s32, s31, 4
    s_add_u32 s32, s32, 0x1a80000
    s_cmp_eq_u32 s30, 0
    s_cselect_b32 s32, s32, 0x7fff0000
    v_mov_b32 v14, 1
    v_mov_b32 v15, 0
    buffer_store_dword v14, v15, s[8:11], s32 offen sc0 sc1
    s_waitcnt vmcnt(0)
    s_barrier
    v_xor_b32 v12, 0, v26
    v_xor_b32 v13, 32, v26
    ds_read_b64 v[128:129], v12
    ds_read_b64 v[130:131], v13
    ds_read_b64 v[132:133], v12 offset:8192
    ds_read_b64 v[134:135], v13 offset:8192
    ds_read_b64 v[136:137], v12 offset:16384
    ds_read_b64 v[138:139], v13 offset:16384
    ds_read_b64 v[140:141], v12 offset:24576
    ds_read_b64 v[142:143], v13 offset:24576
    v_xor_b32 v12, 64, v26
    v_xor_b32 v13, 96, v26
    ds_read_b64 v[144:145], v12
    ds_read_b64 v[146:147], v13
    ds_read_b64 v[148:149], v12 offset:8192
    ds_read_b64 v[150:151], v13 offset:8192
    ds_read_b64 v[152:153], v12 offset:16384
    ds_read_b64 v[154:155], v13 offset:16384
    ds_read_b64 v[156:157], v12 offset:24576
    s_waitcnt lgkmcnt(12)
    ds_read_b64 v[158:159], v13 offset:24576
    v_xor_b32 v12, 128, v26
    v_xor_b32 v13, 160, v26
    ds_read_b64 v[160:161], v12
    ds_read_b64 v[162:163], v13
    s_waitcnt lgkmcnt(12)
    ds_read_b64 v[164:165], v12 offset:8192
    ds_read_b64 v[166:167], v13 offset:8192
    ds_read_b64 v[168:169], v12 offset:16384
    s_waitcnt lgkmcnt(12)
    ds_read_b64 v[170:171], v13 offset:16384
    ds_read_b64 v[172:173], v12 offset:24576
    ds_read_b64 v[174:175], v13 offset:24576
    v_xor_b32 v12, 192, v26
    v_xor_b32 v13, 224, v26
    s_waitcnt lgkmcnt(12)
    ds_read_b64 v[176:177], v12
    ds_read_b64 v[178:179], v13
    ds_read_b64 v[180:181], v12 offset:8192
    s_waitcnt lgkmcnt(12)
    ds_read_b64 v[182:183], v13 offset:8192
    ds_read_b64 v[184:185], v12 offset:16384
    ds_read_b64 v[186:187], v13 offset:16384
    s_waitcnt lgkmcnt(12)
    ds_read_b64 v[188:189], v12 offset:24576
    ds_read_b64 v[190:191], v13 offset:24576
    v_xor_b32 v12, 256, v26
    v_xor_b32 v13, 288, v26
    ds_read_b64 v[192:193], v12
    s_waitcnt lgkmcnt(12)
    ds_read_b64 v[194:195], v13
    ds_read_b64 v[196:197], v12 offset:8192
    ds_read_b64 v[198:199], v13 offset:8192
    s_waitcnt lgkmcnt(12)
    ds_read_b64 v[200:201], v12 offset:16384
    ds_read_b64 v[202:203], v13 offset:16384
    ds_read_b64 v[204:205], v12 offset:24576
    s_waitcnt lgkmcnt(12)
    ds_read_b64 v[206:207], v13 offset:24576
    v_xor_b32 v12, 320, v26
    v_xor_b32 v13, 352, v26
    ds_read_b64 v[208:209], v12
    ds_read_b64 v[210:211], v13
    s_waitcnt lgkmcnt(12)
    ds_read_b64 v[212:213], v12 offset:8192
    ds_read_b64 v[214:215], v13 offset:8192
    ds_read_b64 v[216:217], v12 offset:16384
    s_waitcnt lgkmcnt(12)
    ds_read_b64 v[218:219], v13 offset:16384
    ds_read_b64 v[220:221], v12 offset:24576
    ds_read_b64 v[222:223], v13 offset:24576
    v_xor_b32 v12, 384, v26
    v_xor_b32 v13, 416, v26
    s_waitcnt lgkmcnt(12)
    ds_read_b64 v[224:225], v12
    ds_read_b64 v[226:227], v13
    ds_read_b64 v[228:229], v12 offset:8192
    s_waitcnt lgkmcnt(12)
    ds_read_b64 v[230:231], v13 offset:8192
    ds_read_b64 v[232:233], v12 offset:16384
    ds_read_b64 v[234:235], v13 offset:16384
    s_waitcnt lgkmcnt(12)
    ds_read_b64 v[236:237], v12 offset:24576
    ds_read_b64 v[238:239], v13 offset:24576
    v_xor_b32 v12, 448, v26
    v_xor_b32 v13, 480, v26
    ds_read_b64 v[240:241], v12
    s_waitcnt lgkmcnt(12)
    ds_read_b64 v[242:243], v13
    ds_read_b64 v[244:245], v12 offset:8192
    ds_read_b64 v[246:247], v13 offset:8192
    s_waitcnt lgkmcnt(12)
    ds_read_b64 v[248:249], v12 offset:16384
    ds_read_b64 v[250:251], v13 offset:16384
    ds_read_b64 v[252:253], v12 offset:24576
    s_waitcnt lgkmcnt(12)
    ds_read_b64 v[254:255], v13 offset:24576
    s_waitcnt lgkmcnt(0)
    s_barrier
    ds_read_b64_tr_b16 v[96:97], v4
    ds_read_b64_tr_b16 v[98:99], v4 offset:8192
    ds_read_b64_tr_b16 v[100:101], v5
    ds_read_b64_tr_b16 v[102:103], v5 offset:8192
    ds_read_b64_tr_b16 v[104:105], v6
    ds_read_b64_tr_b16 v[106:107], v6 offset:8192
    ds_read_b64_tr_b16 v[108:109], v7
    ds_read_b64_tr_b16 v[110:111], v7 offset:8192
    s_waitcnt lgkmcnt(6)
    v_mfma_f32_16x16x32_bf16 v[32:35], v[96:99], v[128:131], 0
    ds_read_b64_tr_b16 v[112:113], v4 offset:16384
    v_mfma_f32_16x16x32_bf16 v[36:39], v[96:99], v[132:135], 0
    ds_read_b64_tr_b16 v[114:115], v4 offset:24576
    v_mfma_f32_16x16x32_bf16 v[40:43], v[96:99], v[136:139], 0
    ds_read_b64_tr_b16 v[116:117], v5 offset:16384
    v_mfma_f32_16x16x32_bf16 v[44:47], v[96:99], v[140:143], 0
    ds_read_b64_tr_b16 v[118:119], v5 offset:24576
    s_waitcnt lgkmcnt(8)
    v_mfma_f32_16x16x32_bf16 v[48:51], v[100:103], v[128:131], 0
    ds_read_b64_tr_b16 v[120:121], v6 offset:16384
    v_mfma_f32_16x16x32_bf16 v[52:55], v[100:103], v[132:135], 0
    ds_read_b64_tr_b16 v[122:123], v6 offset:24576
    v_mfma_f32_16x16x32_bf16 v[56:59], v[100:103], v[136:139], 0
    ds_read_b64_tr_b16 v[124:125], v7 offset:16384
    v_mfma_f32_16x16x32_bf16 v[60:63], v[100:103], v[140:143], 0
    ds_read_b64_tr_b16 v[126:127], v7 offset:24576
    s_waitcnt lgkmcnt(10)
    v_mfma_f32_16x16x32_bf16 v[64:67], v[104:107], v[128:131], 0
    v_mfma_f32_16x16x32_bf16 v[68:71], v[104:107], v[132:135], 0
    v_mfma_f32_16x16x32_bf16 v[72:75], v[104:107], v[136:139], 0
    v_mfma_f32_16x16x32_bf16 v[76:79], v[104:107], v[140:143], 0
    s_waitcnt lgkmcnt(8)
    v_mfma_f32_16x16x32_bf16 v[80:83], v[108:111], v[128:131], 0
    v_mfma_f32_16x16x32_bf16 v[84:87], v[108:111], v[132:135], 0
    v_mfma_f32_16x16x32_bf16 v[88:91], v[108:111], v[136:139], 0
    v_mfma_f32_16x16x32_bf16 v[92:95], v[108:111], v[140:143], 0
    s_waitcnt lgkmcnt(6)
    v_mfma_f32_16x16x32_bf16 v[32:35], v[112:115], v[144:147], v[32:35]
    ds_read_b64_tr_b16 v[96:97], v4 offset:32768
    v_mfma_f32_16x16x32_bf16 v[36:39], v[112:115], v[148:151], v[36:39]
    ds_read_b64_tr_b16 v[98:99], v4 offset:40960
    v_mfma_f32_16x16x32_bf16 v[40:43], v[112:115], v[152:155], v[40:43]
    ds_read_b64_tr_b16 v[100:101], v5 offset:32768
    v_mfma_f32_16x16x32_bf16 v[44:47], v[112:115], v[156:159], v[44:47]
    ds_read_b64_tr_b16 v[102:103], v5 offset:40960
    s_waitcnt lgkmcnt(8)
    v_mfma_f32_16x16x32_bf16 v[48:51], v[116:119], v[144:147], v[48:51]
    ds_read_b64_tr_b16 v[104:105], v6 offset:32768
    v_mfma_f32_16x16x32_bf16 v[52:55], v[116:119], v[148:151], v[52:55]
    ds_read_b64_tr_b16 v[106:107], v6 offset:40960
    v_mfma_f32_16x16x32_bf16 v[56:59], v[116:119], v[152:155], v[56:59]
    ds_read_b64_tr_b16 v[108:109], v7 offset:32768
    v_mfma_f32_16x16x32_bf16 v[60:63], v[116:119], v[156:159], v[60:63]
    ds_read_b64_tr_b16 v[110:111], v7 offset:40960
    s_waitcnt lgkmcnt(10)
    v_mfma_f32_16x16x32_bf16 v[64:67], v[120:123], v[144:147], v[64:67]
    v_mfma_f32_16x16x32_bf16 v[68:71], v[120:123], v[148:151], v[68:71]
    v_mfma_f32_16x16x32_bf16 v[72:75], v[120:123], v[152:155], v[72:75]
    v_mfma_f32_16x16x32_bf16 v[76:79], v[120:123], v[156:159], v[76:79]
    s_waitcnt lgkmcnt(8)
    v_mfma_f32_16x16x32_bf16 v[80:83], v[124:127], v[144:147], v[80:83]
    v_mfma_f32_16x16x32_bf16 v[84:87], v[124:127], v[148:151], v[84:87]
    v_mfma_f32_16x16x32_bf16 v[88:91], v[124:127], v[152:155], v[88:91]
    v_mfma_f32_16x16x32_bf16 v[92:95], v[124:127], v[156:159], v[92:95]
    s_waitcnt lgkmcnt(6)
    v_mfma_f32_16x16x32_bf16 v[32:35], v[96:99], v[160:163], v[32:35]
    ds_read_b64_tr_b16 v[112:113], v4 offset:49152
    v_mfma_f32_16x16x32_bf16 v[36:39], v[96:99], v[164:167], v[36:39]
    ds_read_b64_tr_b16 v[114:115], v4 offset:57344
    v_mfma_f32_16x16x32_bf16 v[40:43], v[96:99], v[168:171], v[40:43]
    ds_read_b64_tr_b16 v[116:117], v5 offset:49152
    v_mfma_f32_16x16x32_bf16 v[44:47], v[96:99], v[172:175], v[44:47]
    ds_read_b64_tr_b16 v[118:119], v5 offset:57344
    s_waitcnt lgkmcnt(8)
    v_mfma_f32_16x16x32_bf16 v[48:51], v[100:103], v[160:163], v[48:51]
    ds_read_b64_tr_b16 v[120:121], v6 offset:49152
    v_mfma_f32_16x16x32_bf16 v[52:55], v[100:103], v[164:167], v[52:55]
    ds_read_b64_tr_b16 v[122:123], v6 offset:57344
    v_mfma_f32_16x16x32_bf16 v[56:59], v[100:103], v[168:171], v[56:59]
    ds_read_b64_tr_b16 v[124:125], v7 offset:49152
    v_mfma_f32_16x16x32_bf16 v[60:63], v[100:103], v[172:175], v[60:63]
    ds_read_b64_tr_b16 v[126:127], v7 offset:57344
    s_waitcnt lgkmcnt(10)
    v_mfma_f32_16x16x32_bf16 v[64:67], v[104:107], v[160:163], v[64:67]
    v_mfma_f32_16x16x32_bf16 v[68:71], v[104:107], v[164:167], v[68:71]
    v_mfma_f32_16x16x32_bf16 v[72:75], v[104:107], v[168:171], v[72:75]
    v_mfma_f32_16x16x32_bf16 v[76:79], v[104:107], v[172:175], v[76:79]
    s_waitcnt lgkmcnt(8)
    v_mfma_f32_16x16x32_bf16 v[80:83], v[108:111], v[160:163], v[80:83]
    v_mfma_f32_16x16x32_bf16 v[84:87], v[108:111], v[164:167], v[84:87]
    v_mfma_f32_16x16x32_bf16 v[88:91], v[108:111], v[168:171], v[88:91]
    v_mfma_f32_16x16x32_bf16 v[92:95], v[108:111], v[172:175], v[92:95]
    s_waitcnt lgkmcnt(6)
    v_mfma_f32_16x16x32_bf16 v[32:35], v[112:115], v[176:179], v[32:35]
    ds_read_b64_tr_b16 v[96:97], v8
    v_mfma_f32_16x16x32_bf16 v[36:39], v[112:115], v[180:183], v[36:39]
    ds_read_b64_tr_b16 v[98:99], v8 offset:8192
    v_mfma_f32_16x16x32_bf16 v[40:43], v[112:115], v[184:187], v[40:43]
    ds_read_b64_tr_b16 v[100:101], v9
    v_mfma_f32_16x16x32_bf16 v[44:47], v[112:115], v[188:191], v[44:47]
    ds_read_b64_tr_b16 v[102:103], v9 offset:8192
    s_waitcnt lgkmcnt(8)
    v_mfma_f32_16x16x32_bf16 v[48:51], v[116:119], v[176:179], v[48:51]
    ds_read_b64_tr_b16 v[104:105], v10
    v_mfma_f32_16x16x32_bf16 v[52:55], v[116:119], v[180:183], v[52:55]
    ds_read_b64_tr_b16 v[106:107], v10 offset:8192
    v_mfma_f32_16x16x32_bf16 v[56:59], v[116:119], v[184:187], v[56:59]
    ds_read_b64_tr_b16 v[108:109], v11
    v_mfma_f32_16x16x32_bf16 v[60:63], v[116:119], v[188:191], v[60:63]
    ds_read_b64_tr_b16 v[110:111], v11 offset:8192
    s_waitcnt lgkmcnt(10)
    v_mfma_f32_16x16x32_bf16 v[64:67], v[120:123], v[176:179], v[64:67]
    v_mfma_f32_16x16x32_bf16 v[68:71], v[120:123], v[180:183], v[68:71]
    v_mfma_f32_16x16x32_bf16 v[72:75], v[120:123], v[184:187], v[72:75]
    v_mfma_f32_16x16x32_bf16 v[76:79], v[120:123], v[188:191], v[76:79]
    s_waitcnt lgkmcnt(8)
    v_mfma_f32_16x16x32_bf16 v[80:83], v[124:127], v[176:179], v[80:83]
    v_mfma_f32_16x16x32_bf16 v[84:87], v[124:127], v[180:183], v[84:87]
    v_mfma_f32_16x16x32_bf16 v[88:91], v[124:127], v[184:187], v[88:91]
    v_mfma_f32_16x16x32_bf16 v[92:95], v[124:127], v[188:191], v[92:95]
    s_waitcnt lgkmcnt(6)
    v_mfma_f32_16x16x32_bf16 v[32:35], v[96:99], v[192:195], v[32:35]
    ds_read_b64_tr_b16 v[112:113], v8 offset:16384
    v_mfma_f32_16x16x32_bf16 v[36:39], v[96:99], v[196:199], v[36:39]
    ds_read_b64_tr_b16 v[114:115], v8 offset:24576
    v_mfma_f32_16x16x32_bf16 v[40:43], v[96:99], v[200:203], v[40:43]
    ds_read_b64_tr_b16 v[116:117], v9 offset:16384
    v_mfma_f32_16x16x32_bf16 v[44:47], v[96:99], v[204:207], v[44:47]
    ds_read_b64_tr_b16 v[118:119], v9 offset:24576
    s_waitcnt lgkmcnt(8)
    v_mfma_f32_16x16x32_bf16 v[48:51], v[100:103], v[192:195], v[48:51]
    ds_read_b64_tr_b16 v[120:121], v10 offset:16384
    v_mfma_f32_16x16x32_bf16 v[52:55], v[100:103], v[196:199], v[52:55]
    ds_read_b64_tr_b16 v[122:123], v10 offset:24576
    v_mfma_f32_16x16x32_bf16 v[56:59], v[100:103], v[200:203], v[56:59]
    ds_read_b64_tr_b16 v[124:125], v11 offset:16384
    v_mfma_f32_16x16x32_bf16 v[60:63], v[100:103], v[204:207], v[60:63]
    ds_read_b64_tr_b16 v[126:127], v11 offset:24576
    s_waitcnt lgkmcnt(10)
    v_mfma_f32_16x16x32_bf16 v[64:67], v[104:107], v[192:195], v[64:67]
    v_mfma_f32_16x16x32_bf16 v[68:71], v[104:107], v[196:199], v[68:71]
    v_mfma_f32_16x16x32_bf16 v[72:75], v[104:107], v[200:203], v[72:75]
    v_mfma_f32_16x16x32_bf16 v[76:79], v[104:107], v[204:207], v[76:79]
    s_waitcnt lgkmcnt(8)
    v_mfma_f32_16x16x32_bf16 v[80:83], v[108:111], v[192:195], v[80:83]
    v_mfma_f32_16x16x32_bf16 v[84:87], v[108:111], v[196:199], v[84:87]
    v_mfma_f32_16x16x32_bf16 v[88:91], v[108:111], v[200:203], v[88:91]
    v_mfma_f32_16x16x32_bf16 v[92:95], v[108:111], v[204:207], v[92:95]
    s_waitcnt lgkmcnt(6)
    v_mfma_f32_16x16x32_bf16 v[32:35], v[112:115], v[208:211], v[32:35]
    ds_read_b64_tr_b16 v[96:97], v8 offset:32768
    v_mfma_f32_16x16x32_bf16 v[36:39], v[112:115], v[212:215], v[36:39]
    ds_read_b64_tr_b16 v[98:99], v8 offset:40960
    v_mfma_f32_16x16x32_bf16 v[40:43], v[112:115], v[216:219], v[40:43]
    ds_read_b64_tr_b16 v[100:101], v9 offset:32768
    v_mfma_f32_16x16x32_bf16 v[44:47], v[112:115], v[220:223], v[44:47]
    ds_read_b64_tr_b16 v[102:103], v9 offset:40960
    s_waitcnt lgkmcnt(8)
    v_mfma_f32_16x16x32_bf16 v[48:51], v[116:119], v[208:211], v[48:51]
    ds_read_b64_tr_b16 v[104:105], v10 offset:32768
    v_mfma_f32_16x16x32_bf16 v[52:55], v[116:119], v[212:215], v[52:55]
    ds_read_b64_tr_b16 v[106:107], v10 offset:40960
    v_mfma_f32_16x16x32_bf16 v[56:59], v[116:119], v[216:219], v[56:59]
    ds_read_b64_tr_b16 v[108:109], v11 offset:32768
    v_mfma_f32_16x16x32_bf16 v[60:63], v[116:119], v[220:223], v[60:63]
    ds_read_b64_tr_b16 v[110:111], v11 offset:40960
    s_waitcnt lgkmcnt(10)
    v_mfma_f32_16x16x32_bf16 v[64:67], v[120:123], v[208:211], v[64:67]
    v_mfma_f32_16x16x32_bf16 v[68:71], v[120:123], v[212:215], v[68:71]
    v_mfma_f32_16x16x32_bf16 v[72:75], v[120:123], v[216:219], v[72:75]
    v_mfma_f32_16x16x32_bf16 v[76:79], v[120:123], v[220:223], v[76:79]
    s_waitcnt lgkmcnt(8)
    v_mfma_f32_16x16x32_bf16 v[80:83], v[124:127], v[208:211], v[80:83]
    v_mfma_f32_16x16x32_bf16 v[84:87], v[124:127], v[212:215], v[84:87]
    v_mfma_f32_16x16x32_bf16 v[88:91], v[124:127], v[216:219], v[88:91]
    v_mfma_f32_16x16x32_bf16 v[92:95], v[124:127], v[220:223], v[92:95]
    s_waitcnt lgkmcnt(6)
    v_mfma_f32_16x16x32_bf16 v[32:35], v[96:99], v[224:227], v[32:35]
    ds_read_b64_tr_b16 v[112:113], v8 offset:49152
    v_mfma_f32_16x16x32_bf16 v[36:39], v[96:99], v[228:231], v[36:39]
    ds_read_b64_tr_b16 v[114:115], v8 offset:57344
    v_mfma_f32_16x16x32_bf16 v[40:43], v[96:99], v[232:235], v[40:43]
    ds_read_b64_tr_b16 v[116:117], v9 offset:49152
    v_mfma_f32_16x16x32_bf16 v[44:47], v[96:99], v[236:239], v[44:47]
    ds_read_b64_tr_b16 v[118:119], v9 offset:57344
    s_waitcnt lgkmcnt(8)
    v_mfma_f32_16x16x32_bf16 v[48:51], v[100:103], v[224:227], v[48:51]
    ds_read_b64_tr_b16 v[120:121], v10 offset:49152
    v_mfma_f32_16x16x32_bf16 v[52:55], v[100:103], v[228:231], v[52:55]
    ds_read_b64_tr_b16 v[122:123], v10 offset:57344
    v_mfma_f32_16x16x32_bf16 v[56:59], v[100:103], v[232:235], v[56:59]
    ds_read_b64_tr_b16 v[124:125], v11 offset:49152
    v_mfma_f32_16x16x32_bf16 v[60:63], v[100:103], v[236:239], v[60:63]
    ds_read_b64_tr_b16 v[126:127], v11 offset:57344
    s_waitcnt lgkmcnt(10)
    v_mfma_f32_16x16x32_bf16 v[64:67], v[104:107], v[224:227], v[64:67]
    v_mfma_f32_16x16x32_bf16 v[68:71], v[104:107], v[228:231], v[68:71]
    v_mfma_f32_16x16x32_bf16 v[72:75], v[104:107], v[232:235], v[72:75]
    v_mfma_f32_16x16x32_bf16 v[76:79], v[104:107], v[236:239], v[76:79]
    s_waitcnt lgkmcnt(8)
    v_mfma_f32_16x16x32_bf16 v[80:83], v[108:111], v[224:227], v[80:83]
    v_mfma_f32_16x16x32_bf16 v[84:87], v[108:111], v[228:231], v[84:87]
    v_mfma_f32_16x16x32_bf16 v[88:91], v[108:111], v[232:235], v[88:91]
    v_mfma_f32_16x16x32_bf16 v[92:95], v[108:111], v[236:239], v[92:95]
    s_waitcnt lgkmcnt(6)
    v_mfma_f32_16x16x32_bf16 v[32:35], v[112:115], v[240:243], v[32:35]
    v_mfma_f32_16x16x32_bf16 v[36:39], v[112:115], v[244:247], v[36:39]
    v_mfma_f32_16x16x32_bf16 v[40:43], v[112:115], v[248:251], v[40:43]
    v_mfma_f32_16x16x32_bf16 v[44:47], v[112:115], v[252:255], v[44:47]
    s_waitcnt lgkmcnt(4)
    v_mfma_f32_16x16x32_bf16 v[48:51], v[116:119], v[240:243], v[48:51]
    v_mfma_f32_16x16x32_bf16 v[52:55], v[116:119], v[244:247], v[52:55]
    v_mfma_f32_16x16x32_bf16 v[56:59], v[116:119], v[248:251], v[56:59]
    v_mfma_f32_16x16x32_bf16 v[60:63], v[116:119], v[252:255], v[60:63]
    s_waitcnt lgkmcnt(2)
    v_mfma_f32_16x16x32_bf16 v[64:67], v[120:123], v[240:243], v[64:67]
    v_mfma_f32_16x16x32_bf16 v[68:71], v[120:123], v[244:247], v[68:71]
    v_mfma_f32_16x16x32_bf16 v[72:75], v[120:123], v[248:251], v[72:75]
    v_mfma_f32_16x16x32_bf16 v[76:79], v[120:123], v[252:255], v[76:79]
    s_waitcnt lgkmcnt(0)
    v_mfma_f32_16x16x32_bf16 v[80:83], v[124:127], v[240:243], v[80:83]
    v_mfma_f32_16x16x32_bf16 v[84:87], v[124:127], v[244:247], v[84:87]
    v_mfma_f32_16x16x32_bf16 v[88:91], v[124:127], v[248:251], v[88:91]
    v_mfma_f32_16x16x32_bf16 v[92:95], v[124:127], v[252:255], v[92:95]
    s_barrier
    s_mov_b32 s16, s50
    s_mov_b32 s17, s51
    s_mov_b32 s18, 0x40000
    s_mov_b32 s19, 0x00020000
    s_lshl_b32 s32, s30, 10
    s_add_u32 m0, s32, 0
    s_add_u32 s33, s32, 0
    buffer_load_dwordx4 v1, s[16:19], s33 offen lds
    s_add_u32 m0, s32, 4096
    s_add_u32 s33, s32, 4096
    buffer_load_dwordx4 v1, s[16:19], s33 offen lds
    s_add_u32 m0, s32, 8192
    s_add_u32 s33, s32, 8192
    buffer_load_dwordx4 v1, s[16:19], s33 offen lds
    s_add_u32 m0, s32, 12288
    s_add_u32 s33, s32, 12288
    buffer_load_dwordx4 v1, s[16:19], s33 offen lds
    s_add_u32 m0, s32, 16384
    s_add_u32 s33, s32, 16384
    buffer_load_dwordx4 v1, s[16:19], s33 offen lds
    s_add_u32 m0, s32, 20480
    s_add_u32 s33, s32, 20480
    buffer_load_dwordx4 v1, s[16:19], s33 offen lds
    s_add_u32 m0, s32, 24576
    s_add_u32 s33, s32, 24576
    buffer_load_dwordx4 v1, s[16:19], s33 offen lds
    s_add_u32 m0, s32, 28672
    s_add_u32 s33, s32, 28672
    buffer_load_dwordx4 v1, s[16:19], s33 offen lds
    s_add_u32 m0, s32, 32768
    s_add_u32 s33, s32, 32768
    buffer_load_dwordx4 v1, s[16:19], s33 offen lds
    s_add_u32 m0, s32, 36864
    s_add_u32 s33, s32, 36864
    buffer_load_dwordx4 v1, s[16:19], s33 offen lds
    s_add_u32 m0, s32, 40960
    s_add_u32 s33, s32, 40960
    buffer_load_dwordx4 v1, s[16:19], s33 offen lds
    s_add_u32 m0, s32, 45056
    s_add_u32 s33, s32, 45056
    buffer_load_dwordx4 v1, s[16:19], s33 offen lds
    s_add_u32 m0, s32, 49152
    s_add_u32 s33, s32, 49152
    buffer_load_dwordx4 v1, s[16:19], s33 offen lds
    s_add_u32 m0, s32, 53248
    s_add_u32 s33, s32, 53248
    buffer_load_dwordx4 v1, s[16:19], s33 offen lds
    s_add_u32 m0, s32, 57344
    s_add_u32 s33, s32, 57344
    buffer_load_dwordx4 v1, s[16:19], s33 offen lds
    s_add_u32 m0, s32, 61440
    s_add_u32 s33, s32, 61440
    buffer_load_dwordx4 v1, s[16:19], s33 offen lds
    s_add_u32 m0, s32, 65536
    s_add_u32 s33, s32, 65536
    buffer_load_dwordx4 v1, s[16:19], s33 offen lds
    s_add_u32 m0, s32, 69632
    s_add_u32 s33, s32, 69632
    buffer_load_dwordx4 v1, s[16:19], s33 offen lds
    s_add_u32 m0, s32, 73728
    s_add_u32 s33, s32, 73728
    buffer_load_dwordx4 v1, s[16:19], s33 offen lds
    s_add_u32 m0, s32, 77824
    s_add_u32 s33, s32, 77824
    buffer_load_dwordx4 v1, s[16:19], s33 offen lds
    s_add_u32 m0, s32, 81920
    s_add_u32 s33, s32, 81920
    buffer_load_dwordx4 v1, s[16:19], s33 offen lds
    s_add_u32 m0, s32, 86016
    s_add_u32 s33, s32, 86016
    buffer_load_dwordx4 v1, s[16:19], s33 offen lds
    s_add_u32 m0, s32, 90112
    s_add_u32 s33, s32, 90112
    buffer_load_dwordx4 v1, s[16:19], s33 offen lds
    s_add_u32 m0, s32, 94208
    s_add_u32 s33, s32, 94208
    buffer_load_dwordx4 v1, s[16:19], s33 offen lds
    s_add_u32 m0, s32, 98304
    s_add_u32 s33, s32, 98304
    buffer_load_dwordx4 v1, s[16:19], s33 offen lds
    s_add_u32 m0, s32, 102400
    s_add_u32 s33, s32, 102400
    buffer_load_dwordx4 v1, s[16:19], s33 offen lds
    s_add_u32 m0, s32, 106496
    s_add_u32 s33, s32, 106496
    buffer_load_dwordx4 v1, s[16:19], s33 offen lds
    s_add_u32 m0, s32, 110592
    s_add_u32 s33, s32, 110592
    buffer_load_dwordx4 v1, s[16:19], s33 offen lds
    s_add_u32 m0, s32, 114688
    s_add_u32 s33, s32, 114688
    buffer_load_dwordx4 v1, s[16:19], s33 offen lds
    s_add_u32 m0, s32, 118784
    s_add_u32 s33, s32, 118784
    buffer_load_dwordx4 v1, s[16:19], s33 offen lds
    s_add_u32 m0, s32, 122880
    s_add_u32 s33, s32, 122880
    buffer_load_dwordx4 v1, s[16:19], s33 offen lds
    s_add_u32 m0, s32, 126976
    s_add_u32 s33, s32, 126976
    buffer_load_dwordx4 v1, s[16:19], s33 offen lds
    v_add_u32 v12, 0x20000, v27
    s_lshl_b32 s32, s30, 13
    v_add_u32 v13, s32, v12
    v_cvt_pk_bf16_f32 v96, v32, v33
    v_cvt_pk_bf16_f32 v97, v34, v35
    v_cvt_pk_bf16_f32 v98, v48, v49
    v_cvt_pk_bf16_f32 v99, v50, v51
    ds_write_b128 v13, v[96:99]
    v_cvt_pk_bf16_f32 v100, v36, v37
    v_cvt_pk_bf16_f32 v101, v38, v39
    v_cvt_pk_bf16_f32 v102, v52, v53
    v_cvt_pk_bf16_f32 v103, v54, v55
    ds_write_b128 v13, v[100:103] offset:1024
    v_cvt_pk_bf16_f32 v104, v40, v41
    v_cvt_pk_bf16_f32 v105, v42, v43
    v_cvt_pk_bf16_f32 v106, v56, v57
    v_cvt_pk_bf16_f32 v107, v58, v59
    ds_write_b128 v13, v[104:107] offset:2048
    v_cvt_pk_bf16_f32 v108, v44, v45
    v_cvt_pk_bf16_f32 v109, v46, v47
    v_cvt_pk_bf16_f32 v110, v60, v61
    v_cvt_pk_bf16_f32 v111, v62, v63
    ds_write_b128 v13, v[108:111] offset:3072
    v_cvt_pk_bf16_f32 v112, v64, v65
    v_cvt_pk_bf16_f32 v113, v66, v67
    v_cvt_pk_bf16_f32 v114, v80, v81
    v_cvt_pk_bf16_f32 v115, v82, v83
    ds_write_b128 v13, v[112:115] offset:4096
    v_cvt_pk_bf16_f32 v116, v68, v69
    v_cvt_pk_bf16_f32 v117, v70, v71
    v_cvt_pk_bf16_f32 v118, v84, v85
    v_cvt_pk_bf16_f32 v119, v86, v87
    ds_write_b128 v13, v[116:119] offset:5120
    v_cvt_pk_bf16_f32 v120, v72, v73
    v_cvt_pk_bf16_f32 v121, v74, v75
    v_cvt_pk_bf16_f32 v122, v88, v89
    v_cvt_pk_bf16_f32 v123, v90, v91
    ds_write_b128 v13, v[120:123] offset:6144
    v_cvt_pk_bf16_f32 v124, v76, v77
    v_cvt_pk_bf16_f32 v125, v78, v79
    v_cvt_pk_bf16_f32 v126, v92, v93
    v_cvt_pk_bf16_f32 v127, v94, v95
    ds_write_b128 v13, v[124:127] offset:7168
    s_waitcnt lgkmcnt(0)
    s_barrier
    ds_read_b128 v[128:131], v12
    ds_read_b128 v[132:135], v12 offset:1024
    ds_read_b128 v[136:139], v12 offset:2048
    ds_read_b128 v[140:143], v12 offset:3072
    ds_read_b128 v[144:147], v12 offset:4096
    ds_read_b128 v[148:151], v12 offset:5120
    ds_read_b128 v[152:155], v12 offset:6144
    ds_read_b128 v[156:159], v12 offset:7168
    ds_read_b128 v[160:163], v12 offset:8192
    ds_read_b128 v[164:167], v12 offset:9216
    ds_read_b128 v[168:171], v12 offset:10240
    ds_read_b128 v[172:175], v12 offset:11264
    ds_read_b128 v[176:179], v12 offset:12288
    ds_read_b128 v[180:183], v12 offset:13312
    ds_read_b128 v[184:187], v12 offset:14336
    s_waitcnt lgkmcnt(12)
    ds_read_b128 v[188:191], v12 offset:15360
    ds_read_b128 v[192:195], v12 offset:16384
    ds_read_b128 v[196:199], v12 offset:17408
    s_waitcnt lgkmcnt(12)
    ds_read_b128 v[200:203], v12 offset:18432
    ds_read_b128 v[204:207], v12 offset:19456
    ds_read_b128 v[208:211], v12 offset:20480
    s_waitcnt lgkmcnt(12)
    ds_read_b128 v[212:215], v12 offset:21504
    ds_read_b128 v[216:219], v12 offset:22528
    ds_read_b128 v[220:223], v12 offset:23552
    s_waitcnt lgkmcnt(12)
    ds_read_b128 v[224:227], v12 offset:24576
    ds_read_b128 v[228:231], v12 offset:25600
    ds_read_b128 v[232:235], v12 offset:26624
    s_waitcnt lgkmcnt(12)
    ds_read_b128 v[236:239], v12 offset:27648
    ds_read_b128 v[240:243], v12 offset:28672
    ds_read_b128 v[244:247], v12 offset:29696
    s_waitcnt lgkmcnt(12)
    ds_read_b128 v[248:251], v12 offset:30720
    ds_read_b128 v[252:255], v12 offset:31744
    s_waitcnt vmcnt(0)
    s_barrier
    ds_read_b64_tr_b16 v[96:97], v28
    s_waitcnt lgkmcnt(12)
    ds_read_b64_tr_b16 v[98:99], v28 offset:8192
    ds_read_b64_tr_b16 v[100:101], v28 offset:8
    ds_read_b64_tr_b16 v[102:103], v28 offset:8200
    s_waitcnt lgkmcnt(12)
    ds_read_b64_tr_b16 v[104:105], v28 offset:16
    ds_read_b64_tr_b16 v[106:107], v28 offset:8208
    ds_read_b64_tr_b16 v[108:109], v28 offset:24
    s_waitcnt lgkmcnt(12)
    ds_read_b64_tr_b16 v[110:111], v28 offset:8216
    s_waitcnt lgkmcnt(6)
    v_mfma_f32_16x16x32_bf16 v[32:35], v[128:131], v[96:99], 0
    ds_read_b64_tr_b16 v[112:113], v28 offset:16384
    v_mfma_f32_16x16x32_bf16 v[36:39], v[132:135], v[96:99], 0
    ds_read_b64_tr_b16 v[114:115], v28 offset:24576
    v_mfma_f32_16x16x32_bf16 v[40:43], v[136:139], v[96:99], 0
    ds_read_b64_tr_b16 v[116:117], v28 offset:16392
    v_mfma_f32_16x16x32_bf16 v[44:47], v[140:143], v[96:99], 0
    ds_read_b64_tr_b16 v[118:119], v28 offset:24584
    s_waitcnt lgkmcnt(8)
    v_mfma_f32_16x16x32_bf16 v[48:51], v[128:131], v[100:103], 0
    ds_read_b64_tr_b16 v[120:121], v28 offset:16400
    v_mfma_f32_16x16x32_bf16 v[52:55], v[132:135], v[100:103], 0
    ds_read_b64_tr_b16 v[122:123], v28 offset:24592
    v_mfma_f32_16x16x32_bf16 v[56:59], v[136:139], v[100:103], 0
    ds_read_b64_tr_b16 v[124:125], v28 offset:16408
    v_mfma_f32_16x16x32_bf16 v[60:63], v[140:143], v[100:103], 0
    ds_read_b64_tr_b16 v[126:127], v28 offset:24600
    s_waitcnt lgkmcnt(10)
    v_mfma_f32_16x16x32_bf16 v[64:67], v[128:131], v[104:107], 0
    v_mfma_f32_16x16x32_bf16 v[68:71], v[132:135], v[104:107], 0
    v_mfma_f32_16x16x32_bf16 v[72:75], v[136:139], v[104:107], 0
    v_mfma_f32_16x16x32_bf16 v[76:79], v[140:143], v[104:107], 0
    s_waitcnt lgkmcnt(8)
    v_mfma_f32_16x16x32_bf16 v[80:83], v[128:131], v[108:111], 0
    v_mfma_f32_16x16x32_bf16 v[84:87], v[132:135], v[108:111], 0
    v_mfma_f32_16x16x32_bf16 v[88:91], v[136:139], v[108:111], 0
    v_mfma_f32_16x16x32_bf16 v[92:95], v[140:143], v[108:111], 0
    s_waitcnt lgkmcnt(6)
    v_mfma_f32_16x16x32_bf16 v[32:35], v[144:147], v[112:115], v[32:35]
    ds_read_b64_tr_b16 v[96:97], v28 offset:32768
    v_mfma_f32_16x16x32_bf16 v[36:39], v[148:151], v[112:115], v[36:39]
    ds_read_b64_tr_b16 v[98:99], v28 offset:40960
    v_mfma_f32_16x16x32_bf16 v[40:43], v[152:155], v[112:115], v[40:43]
    ds_read_b64_tr_b16 v[100:101], v28 offset:32776
    v_mfma_f32_16x16x32_bf16 v[44:47], v[156:159], v[112:115], v[44:47]
    ds_read_b64_tr_b16 v[102:103], v28 offset:40968
    s_waitcnt lgkmcnt(8)
    v_mfma_f32_16x16x32_bf16 v[48:51], v[144:147], v[116:119], v[48:51]
    ds_read_b64_tr_b16 v[104:105], v28 offset:32784
    v_mfma_f32_16x16x32_bf16 v[52:55], v[148:151], v[116:119], v[52:55]
    ds_read_b64_tr_b16 v[106:107], v28 offset:40976
    v_mfma_f32_16x16x32_bf16 v[56:59], v[152:155], v[116:119], v[56:59]
    ds_read_b64_tr_b16 v[108:109], v28 offset:32792
    v_mfma_f32_16x16x32_bf16 v[60:63], v[156:159], v[116:119], v[60:63]
    ds_read_b64_tr_b16 v[110:111], v28 offset:40984
    s_waitcnt lgkmcnt(10)
    v_mfma_f32_16x16x32_bf16 v[64:67], v[144:147], v[120:123], v[64:67]
    v_mfma_f32_16x16x32_bf16 v[68:71], v[148:151], v[120:123], v[68:71]
    v_mfma_f32_16x16x32_bf16 v[72:75], v[152:155], v[120:123], v[72:75]
    v_mfma_f32_16x16x32_bf16 v[76:79], v[156:159], v[120:123], v[76:79]
    s_waitcnt lgkmcnt(8)
    v_mfma_f32_16x16x32_bf16 v[80:83], v[144:147], v[124:127], v[80:83]
    v_mfma_f32_16x16x32_bf16 v[84:87], v[148:151], v[124:127], v[84:87]
    v_mfma_f32_16x16x32_bf16 v[88:91], v[152:155], v[124:127], v[88:91]
    v_mfma_f32_16x16x32_bf16 v[92:95], v[156:159], v[124:127], v[92:95]
    s_waitcnt lgkmcnt(6)
    v_mfma_f32_16x16x32_bf16 v[32:35], v[160:163], v[96:99], v[32:35]
    ds_read_b64_tr_b16 v[112:113], v28 offset:49152
    v_mfma_f32_16x16x32_bf16 v[36:39], v[164:167], v[96:99], v[36:39]
    ds_read_b64_tr_b16 v[114:115], v28 offset:57344
    v_mfma_f32_16x16x32_bf16 v[40:43], v[168:171], v[96:99], v[40:43]
    ds_read_b64_tr_b16 v[116:117], v28 offset:49160
    v_mfma_f32_16x16x32_bf16 v[44:47], v[172:175], v[96:99], v[44:47]
    ds_read_b64_tr_b16 v[118:119], v28 offset:57352
    s_waitcnt lgkmcnt(8)
    v_mfma_f32_16x16x32_bf16 v[48:51], v[160:163], v[100:103], v[48:51]
    ds_read_b64_tr_b16 v[120:121], v28 offset:49168
    v_mfma_f32_16x16x32_bf16 v[52:55], v[164:167], v[100:103], v[52:55]
    ds_read_b64_tr_b16 v[122:123], v28 offset:57360
    v_mfma_f32_16x16x32_bf16 v[56:59], v[168:171], v[100:103], v[56:59]
    ds_read_b64_tr_b16 v[124:125], v28 offset:49176
    v_mfma_f32_16x16x32_bf16 v[60:63], v[172:175], v[100:103], v[60:63]
    ds_read_b64_tr_b16 v[126:127], v28 offset:57368
    s_waitcnt lgkmcnt(10)
    v_mfma_f32_16x16x32_bf16 v[64:67], v[160:163], v[104:107], v[64:67]
    v_mfma_f32_16x16x32_bf16 v[68:71], v[164:167], v[104:107], v[68:71]
    v_mfma_f32_16x16x32_bf16 v[72:75], v[168:171], v[104:107], v[72:75]
    v_mfma_f32_16x16x32_bf16 v[76:79], v[172:175], v[104:107], v[76:79]
    s_waitcnt lgkmcnt(8)
    v_mfma_f32_16x16x32_bf16 v[80:83], v[160:163], v[108:111], v[80:83]
    v_mfma_f32_16x16x32_bf16 v[84:87], v[164:167], v[108:111], v[84:87]
    v_mfma_f32_16x16x32_bf16 v[88:91], v[168:171], v[108:111], v[88:91]
    v_mfma_f32_16x16x32_bf16 v[92:95], v[172:175], v[108:111], v[92:95]
    s_waitcnt lgkmcnt(6)
    v_mfma_f32_16x16x32_bf16 v[32:35], v[176:179], v[112:115], v[32:35]
    ds_read_b64_tr_b16 v[96:97], v29
    v_mfma_f32_16x16x32_bf16 v[36:39], v[180:183], v[112:115], v[36:39]
    ds_read_b64_tr_b16 v[98:99], v29 offset:8192
    v_mfma_f32_16x16x32_bf16 v[40:43], v[184:187], v[112:115], v[40:43]
    ds_read_b64_tr_b16 v[100:101], v29 offset:8
    v_mfma_f32_16x16x32_bf16 v[44:47], v[188:191], v[112:115], v[44:47]
    ds_read_b64_tr_b16 v[102:103], v29 offset:8200
    s_waitcnt lgkmcnt(8)
    v_mfma_f32_16x16x32_bf16 v[48:51], v[176:179], v[116:119], v[48:51]
    ds_read_b64_tr_b16 v[104:105], v29 offset:16
    v_mfma_f32_16x16x32_bf16 v[52:55], v[180:183], v[116:119], v[52:55]
    ds_read_b64_tr_b16 v[106:107], v29 offset:8208
    v_mfma_f32_16x16x32_bf16 v[56:59], v[184:187], v[116:119], v[56:59]
    ds_read_b64_tr_b16 v[108:109], v29 offset:24
    v_mfma_f32_16x16x32_bf16 v[60:63], v[188:191], v[116:119], v[60:63]
    ds_read_b64_tr_b16 v[110:111], v29 offset:8216
    s_waitcnt lgkmcnt(10)
    v_mfma_f32_16x16x32_bf16 v[64:67], v[176:179], v[120:123], v[64:67]
    v_mfma_f32_16x16x32_bf16 v[68:71], v[180:183], v[120:123], v[68:71]
    v_mfma_f32_16x16x32_bf16 v[72:75], v[184:187], v[120:123], v[72:75]
    v_mfma_f32_16x16x32_bf16 v[76:79], v[188:191], v[120:123], v[76:79]
    s_waitcnt lgkmcnt(8)
    v_mfma_f32_16x16x32_bf16 v[80:83], v[176:179], v[124:127], v[80:83]
    v_mfma_f32_16x16x32_bf16 v[84:87], v[180:183], v[124:127], v[84:87]
    v_mfma_f32_16x16x32_bf16 v[88:91], v[184:187], v[124:127], v[88:91]
    v_mfma_f32_16x16x32_bf16 v[92:95], v[188:191], v[124:127], v[92:95]
    s_waitcnt lgkmcnt(6)
    v_mfma_f32_16x16x32_bf16 v[32:35], v[192:195], v[96:99], v[32:35]
    ds_read_b64_tr_b16 v[112:113], v29 offset:16384
    v_mfma_f32_16x16x32_bf16 v[36:39], v[196:199], v[96:99], v[36:39]
    ds_read_b64_tr_b16 v[114:115], v29 offset:24576
    v_mfma_f32_16x16x32_bf16 v[40:43], v[200:203], v[96:99], v[40:43]
    ds_read_b64_tr_b16 v[116:117], v29 offset:16392
    v_mfma_f32_16x16x32_bf16 v[44:47], v[204:207], v[96:99], v[44:47]
    ds_read_b64_tr_b16 v[118:119], v29 offset:24584
    s_waitcnt lgkmcnt(8)
    v_mfma_f32_16x16x32_bf16 v[48:51], v[192:195], v[100:103], v[48:51]
    ds_read_b64_tr_b16 v[120:121], v29 offset:16400
    v_mfma_f32_16x16x32_bf16 v[52:55], v[196:199], v[100:103], v[52:55]
    ds_read_b64_tr_b16 v[122:123], v29 offset:24592
    v_mfma_f32_16x16x32_bf16 v[56:59], v[200:203], v[100:103], v[56:59]
    ds_read_b64_tr_b16 v[124:125], v29 offset:16408
    v_mfma_f32_16x16x32_bf16 v[60:63], v[204:207], v[100:103], v[60:63]
    ds_read_b64_tr_b16 v[126:127], v29 offset:24600
    s_waitcnt lgkmcnt(10)
    v_mfma_f32_16x16x32_bf16 v[64:67], v[192:195], v[104:107], v[64:67]
    v_mfma_f32_16x16x32_bf16 v[68:71], v[196:199], v[104:107], v[68:71]
    v_mfma_f32_16x16x32_bf16 v[72:75], v[200:203], v[104:107], v[72:75]
    v_mfma_f32_16x16x32_bf16 v[76:79], v[204:207], v[104:107], v[76:79]
    s_waitcnt lgkmcnt(8)
    v_mfma_f32_16x16x32_bf16 v[80:83], v[192:195], v[108:111], v[80:83]
    v_mfma_f32_16x16x32_bf16 v[84:87], v[196:199], v[108:111], v[84:87]
    v_mfma_f32_16x16x32_bf16 v[88:91], v[200:203], v[108:111], v[88:91]
    v_mfma_f32_16x16x32_bf16 v[92:95], v[204:207], v[108:111], v[92:95]
    s_waitcnt lgkmcnt(6)
    v_mfma_f32_16x16x32_bf16 v[32:35], v[208:211], v[112:115], v[32:35]
    ds_read_b64_tr_b16 v[96:97], v29 offset:32768
    v_mfma_f32_16x16x32_bf16 v[36:39], v[212:215], v[112:115], v[36:39]
    ds_read_b64_tr_b16 v[98:99], v29 offset:40960
    v_mfma_f32_16x16x32_bf16 v[40:43], v[216:219], v[112:115], v[40:43]
    ds_read_b64_tr_b16 v[100:101], v29 offset:32776
    v_mfma_f32_16x16x32_bf16 v[44:47], v[220:223], v[112:115], v[44:47]
    ds_read_b64_tr_b16 v[102:103], v29 offset:40968
    s_waitcnt lgkmcnt(8)
    v_mfma_f32_16x16x32_bf16 v[48:51], v[208:211], v[116:119], v[48:51]
    ds_read_b64_tr_b16 v[104:105], v29 offset:32784
    v_mfma_f32_16x16x32_bf16 v[52:55], v[212:215], v[116:119], v[52:55]
    ds_read_b64_tr_b16 v[106:107], v29 offset:40976
    v_mfma_f32_16x16x32_bf16 v[56:59], v[216:219], v[116:119], v[56:59]
    ds_read_b64_tr_b16 v[108:109], v29 offset:32792
    v_mfma_f32_16x16x32_bf16 v[60:63], v[220:223], v[116:119], v[60:63]
    ds_read_b64_tr_b16 v[110:111], v29 offset:40984
    s_waitcnt lgkmcnt(10)
    v_mfma_f32_16x16x32_bf16 v[64:67], v[208:211], v[120:123], v[64:67]
    v_mfma_f32_16x16x32_bf16 v[68:71], v[212:215], v[120:123], v[68:71]
    v_mfma_f32_16x16x32_bf16 v[72:75], v[216:219], v[120:123], v[72:75]
    v_mfma_f32_16x16x32_bf16 v[76:79], v[220:223], v[120:123], v[76:79]
    s_waitcnt lgkmcnt(8)
    v_mfma_f32_16x16x32_bf16 v[80:83], v[208:211], v[124:127], v[80:83]
    v_mfma_f32_16x16x32_bf16 v[84:87], v[212:215], v[124:127], v[84:87]
    v_mfma_f32_16x16x32_bf16 v[88:91], v[216:219], v[124:127], v[88:91]
    v_mfma_f32_16x16x32_bf16 v[92:95], v[220:223], v[124:127], v[92:95]
    s_waitcnt lgkmcnt(6)
    v_mfma_f32_16x16x32_bf16 v[32:35], v[224:227], v[96:99], v[32:35]
    ds_read_b64_tr_b16 v[112:113], v29 offset:49152
    v_mfma_f32_16x16x32_bf16 v[36:39], v[228:231], v[96:99], v[36:39]
    ds_read_b64_tr_b16 v[114:115], v29 offset:57344
    v_mfma_f32_16x16x32_bf16 v[40:43], v[232:235], v[96:99], v[40:43]
    ds_read_b64_tr_b16 v[116:117], v29 offset:49160
    v_mfma_f32_16x16x32_bf16 v[44:47], v[236:239], v[96:99], v[44:47]
    ds_read_b64_tr_b16 v[118:119], v29 offset:57352
    s_waitcnt lgkmcnt(8)
    v_mfma_f32_16x16x32_bf16 v[48:51], v[224:227], v[100:103], v[48:51]
    ds_read_b64_tr_b16 v[120:121], v29 offset:49168
    v_mfma_f32_16x16x32_bf16 v[52:55], v[228:231], v[100:103], v[52:55]
    ds_read_b64_tr_b16 v[122:123], v29 offset:57360
    v_mfma_f32_16x16x32_bf16 v[56:59], v[232:235], v[100:103], v[56:59]
    ds_read_b64_tr_b16 v[124:125], v29 offset:49176
    v_mfma_f32_16x16x32_bf16 v[60:63], v[236:239], v[100:103], v[60:63]
    ds_read_b64_tr_b16 v[126:127], v29 offset:57368
    s_waitcnt lgkmcnt(10)
    v_mfma_f32_16x16x32_bf16 v[64:67], v[224:227], v[104:107], v[64:67]
    v_mfma_f32_16x16x32_bf16 v[68:71], v[228:231], v[104:107], v[68:71]
    v_mfma_f32_16x16x32_bf16 v[72:75], v[232:235], v[104:107], v[72:75]
    v_mfma_f32_16x16x32_bf16 v[76:79], v[236:239], v[104:107], v[76:79]
    s_waitcnt lgkmcnt(8)
    v_mfma_f32_16x16x32_bf16 v[80:83], v[224:227], v[108:111], v[80:83]
    v_mfma_f32_16x16x32_bf16 v[84:87], v[228:231], v[108:111], v[84:87]
    v_mfma_f32_16x16x32_bf16 v[88:91], v[232:235], v[108:111], v[88:91]
    v_mfma_f32_16x16x32_bf16 v[92:95], v[236:239], v[108:111], v[92:95]
    s_waitcnt lgkmcnt(6)
    v_mfma_f32_16x16x32_bf16 v[32:35], v[240:243], v[112:115], v[32:35]
    v_mfma_f32_16x16x32_bf16 v[36:39], v[244:247], v[112:115], v[36:39]
    v_mfma_f32_16x16x32_bf16 v[40:43], v[248:251], v[112:115], v[40:43]
    v_mfma_f32_16x16x32_bf16 v[44:47], v[252:255], v[112:115], v[44:47]
    s_waitcnt lgkmcnt(4)
    v_mfma_f32_16x16x32_bf16 v[48:51], v[240:243], v[116:119], v[48:51]
    v_mfma_f32_16x16x32_bf16 v[52:55], v[244:247], v[116:119], v[52:55]
    v_mfma_f32_16x16x32_bf16 v[56:59], v[248:251], v[116:119], v[56:59]
    v_mfma_f32_16x16x32_bf16 v[60:63], v[252:255], v[116:119], v[60:63]
    s_waitcnt lgkmcnt(2)
    v_mfma_f32_16x16x32_bf16 v[64:67], v[240:243], v[120:123], v[64:67]
    v_mfma_f32_16x16x32_bf16 v[68:71], v[244:247], v[120:123], v[68:71]
    v_mfma_f32_16x16x32_bf16 v[72:75], v[248:251], v[120:123], v[72:75]
    v_mfma_f32_16x16x32_bf16 v[76:79], v[252:255], v[120:123], v[76:79]
    s_waitcnt lgkmcnt(0)
    v_mfma_f32_16x16x32_bf16 v[80:83], v[240:243], v[124:127], v[80:83]
    v_mfma_f32_16x16x32_bf16 v[84:87], v[244:247], v[124:127], v[84:87]
    v_mfma_f32_16x16x32_bf16 v[88:91], v[248:251], v[124:127], v[88:91]
    v_mfma_f32_16x16x32_bf16 v[92:95], v[252:255], v[124:127], v[92:95]
    s_lshl_b32 s32, s30, 15
    s_lshl_b32 s33, s31, 11
    s_add_u32 s32, s32, s33
    s_add_u32 s32, s32, 0x1000000
    v_cvt_pk_bf16_f32 v96, v32, v33
    v_cvt_pk_bf16_f32 v97, v34, v35
    v_cvt_pk_bf16_f32 v98, v36, v37
    v_cvt_pk_bf16_f32 v99, v38, v39
    buffer_store_dwordx4 v[96:99], v27, s[8:11], s32 offen sc0 sc1
    v_cvt_pk_bf16_f32 v100, v40, v41
    v_cvt_pk_bf16_f32 v101, v42, v43
    v_cvt_pk_bf16_f32 v102, v44, v45
    v_cvt_pk_bf16_f32 v103, v46, v47
    buffer_store_dwordx4 v[100:103], v27, s[8:11], s32 offen offset:1024 sc0 sc1
    s_add_u32 s32, s32, 8192
    v_cvt_pk_bf16_f32 v104, v48, v49
    v_cvt_pk_bf16_f32 v105, v50, v51
    v_cvt_pk_bf16_f32 v106, v52, v53
    v_cvt_pk_bf16_f32 v107, v54, v55
    buffer_store_dwordx4 v[104:107], v27, s[8:11], s32 offen sc0 sc1
    v_cvt_pk_bf16_f32 v108, v56, v57
    v_cvt_pk_bf16_f32 v109, v58, v59
    v_cvt_pk_bf16_f32 v110, v60, v61
    v_cvt_pk_bf16_f32 v111, v62, v63
    buffer_store_dwordx4 v[108:111], v27, s[8:11], s32 offen offset:1024 sc0 sc1
    s_add_u32 s32, s32, 8192
    v_cvt_pk_bf16_f32 v112, v64, v65
    v_cvt_pk_bf16_f32 v113, v66, v67
    v_cvt_pk_bf16_f32 v114, v68, v69
    v_cvt_pk_bf16_f32 v115, v70, v71
    buffer_store_dwordx4 v[112:115], v27, s[8:11], s32 offen sc0 sc1
    v_cvt_pk_bf16_f32 v116, v72, v73
    v_cvt_pk_bf16_f32 v117, v74, v75
    v_cvt_pk_bf16_f32 v118, v76, v77
    v_cvt_pk_bf16_f32 v119, v78, v79
    buffer_store_dwordx4 v[116:119], v27, s[8:11], s32 offen offset:1024 sc0 sc1
    s_add_u32 s32, s32, 8192
    v_cvt_pk_bf16_f32 v120, v80, v81
    v_cvt_pk_bf16_f32 v121, v82, v83
    v_cvt_pk_bf16_f32 v122, v84, v85
    v_cvt_pk_bf16_f32 v123, v86, v87
    buffer_store_dwordx4 v[120:123], v27, s[8:11], s32 offen sc0 sc1
    v_cvt_pk_bf16_f32 v124, v88, v89
    v_cvt_pk_bf16_f32 v125, v90, v91
    v_cvt_pk_bf16_f32 v126, v92, v93
    v_cvt_pk_bf16_f32 v127, v94, v95
    buffer_store_dwordx4 v[124:127], v27, s[8:11], s32 offen offset:1024 sc0 sc1
    s_waitcnt vmcnt(0)
    s_barrier
    s_lshl_b32 s32, s31, 4
    s_add_u32 s32, s32, 0x1a80040
    s_cmp_eq_u32 s30, 0
    s_cselect_b32 s32, s32, 0x7fff0000
    v_mov_b32 v14, 1
    v_mov_b32 v15, 0
    buffer_store_dword v14, v15, s[8:11], s32 offen sc0 sc1
    s_waitcnt vmcnt(0)
K2_WEND:
    s_endpgm
.section .rodata,"a"
.p2align 6
.amdhsa_kernel k1_kernel
  .amdhsa_next_free_vgpr 256
  .amdhsa_next_free_sgpr 72
  .amdhsa_accum_offset 256
  .amdhsa_group_segment_fixed_size 0
  .amdhsa_kernarg_size 96
  .amdhsa_user_sgpr_count 2
  .amdhsa_user_sgpr_kernarg_segment_ptr 1
  .amdhsa_system_sgpr_workgroup_id_x 1
  .amdhsa_float_denorm_mode_32 3
  .amdhsa_float_denorm_mode_16_64 3
.end_amdhsa_kernel
.p2align 6
.amdhsa_kernel k2_kernel
  .amdhsa_next_free_vgpr 512
  .amdhsa_next_free_sgpr 96
  .amdhsa_accum_offset 256
  .amdhsa_group_segment_fixed_size 0
  .amdhsa_kernarg_size 96
  .amdhsa_user_sgpr_count 2
  .amdhsa_user_sgpr_kernarg_segment_ptr 1
  .amdhsa_system_sgpr_workgroup_id_x 1
  .amdhsa_float_denorm_mode_32 3
  .amdhsa_float_denorm_mode_16_64 3
.end_amdhsa_kernel
```
